```python
import torch

def _softmax(x, axis=-1):
    return torch.softmax(x, dim=axis)
def _gelu(x):
    return torch.nn.functional.gelu(x, approximate="tanh")
def _silu(x):
    return torch.nn.functional.silu(x)
def _sigmoid(x):
    return torch.sigmoid(x)
def _layernorm(x, axis=-1, eps=1e-5):
    m = x.mean(dim=axis, keepdim=True)
    v = x.var(dim=axis, keepdim=True, unbiased=False)
    return (x - m) / torch.sqrt(v + eps)
def _scatter_add(tgt, idx, src, axis=0):
    return tgt.clone().index_add_(axis, idx, src)
def _segment_sum(src, seg, n):
    out = torch.zeros((n,) + src.shape[1:], dtype=src.dtype)
    return out.index_add_(0, seg, src)
def _pad(x, pw):
    flat = tuple(v for pair in reversed(pw) for v in pair)
    return torch.nn.functional.pad(x, flat)

kernel_name = 'interleave_layers__gqa_block_cached__sliding_block_cached__decode'

def setup_inputs():

    _w = (lambda a: (lambda t: t.to(torch.bfloat16) if t.is_floating_point() else t)(torch.as_tensor(a)))
    def _A_setup():
        B, Sq, D = 2, 1, 640
        Hq, Hkv, Sk, Dh = 32, 32, 4096, 192
        assert Hq % Hkv == 0, (Hq, Hkv)
        return {
            "x": _w((lambda *s: torch.randn(*s, dtype=torch.bfloat16) * 0.1)(B, Sq, D)),
            "k_cache": _w((lambda *s: torch.randn(*s, dtype=torch.bfloat16) * 0.8)(B, Hkv, Sk, Dh)),
            "v_cache": _w((lambda *s: torch.randn(*s, dtype=torch.bfloat16) * 3.2)(B, Hkv, Sk, Dh)),
            "wq": _w((lambda *s: torch.randn(*s, dtype=torch.bfloat16) * 0.8)(D, Hq * Dh) * (D ** -0.5)),
            "wo": _w((lambda *s: torch.randn(*s, dtype=torch.bfloat16) * 3.2)(Hq * Dh, D) * ((Hq * Dh) ** -0.5)),
        }
    _A_in = _A_setup()

    def _B_setup():
        B, Sq, D = 2, 1, 640
        Hq, Hkv, Sk, Dh = 32, 32, 4096, 192
        assert Hq % Hkv == 0, (Hq, Hkv)
        return {
            "x": _w((lambda *s: torch.randn(*s, dtype=torch.bfloat16) * 0.1)(B, Sq, D)),
            "k_cache": _w((lambda *s: torch.randn(*s, dtype=torch.bfloat16) * 1.6)(B, Hkv, Sk, Dh)),
            "v_cache": _w((lambda *s: torch.randn(*s, dtype=torch.bfloat16) * 1.6)(B, Hkv, Sk, Dh)),
            "wq": _w((lambda *s: torch.randn(*s, dtype=torch.bfloat16) * 1.6)(D, Hq * Dh) * (D ** -0.5)),
            "wo": _w((lambda *s: torch.randn(*s, dtype=torch.bfloat16) * 1.6)(Hq * Dh, D) * ((Hq * Dh) ** -0.5)),
        }
    _B_in = _B_setup()

    return {
        "A_x": _A_in["x"],
        "A_k_cache": _A_in["k_cache"],
        "A_v_cache": _A_in["v_cache"],
        "A_wq": _A_in["wq"],
        "A_wo": _A_in["wo"],
        "B_x": _B_in["x"],
        "B_k_cache": _B_in["k_cache"],
        "B_v_cache": _B_in["v_cache"],
        "B_wq": _B_in["wq"],
        "B_wo": _B_in["wo"],
    }

def reference(A_x, A_k_cache, A_v_cache, A_wq, A_wo, B_x, B_k_cache, B_v_cache, B_wq, B_wo):
    def _A_ref(x, k_cache, v_cache, wq, wo):
        B, Sq, D = x.shape
        Hq, Dh = 32, 192
        Hkv = k_cache.shape[1]
        rep = Hq // Hkv
        q = (lambda x, *d: x.permute(*d))((x @ wq).reshape(B, Sq, Hq, Dh), 0, 2, 1, 3)
        k = (lambda x, n, axis: torch.repeat_interleave(x, n, dim=axis))(k_cache, rep, axis=1)
        v = (lambda x, n, axis: torch.repeat_interleave(x, n, dim=axis))(v_cache, rep, axis=1)
        scores = torch.einsum("bhqd,bhkd->bhqk", q, k) * (Dh ** -0.5)
        p = _softmax(scores, axis=-1)
        o = torch.einsum("bhqk,bhkd->bhqd", p, v)
        return (lambda x, *d: x.permute(*d))(o, 0, 2, 1, 3).reshape(B, Sq, Hq * Dh) @ wo

    def _B_ref(x, k_cache, v_cache, wq, wo):
        B, Sq, D = x.shape
        Hq, Dh = 32, 192
        Hkv, Sk = k_cache.shape[1], k_cache.shape[2]
        W = min(4096, max(256, Sk // 4))
        rep = Hq // Hkv
        q = (lambda x, *d: x.permute(*d))((x @ wq).reshape(B, Sq, Hq, Dh), 0, 2, 1, 3)
        k = (lambda x, n, axis: torch.repeat_interleave(x, n, dim=axis))(k_cache[:, :, Sk - W:, :], rep, axis=1)
        v = (lambda x, n, axis: torch.repeat_interleave(x, n, dim=axis))(v_cache[:, :, Sk - W:, :], rep, axis=1)
        scores = torch.einsum("bhqd,bhkd->bhqk", q, k) * (Dh ** -0.5)
        p = _softmax(scores, axis=-1)
        o = torch.einsum("bhqk,bhkd->bhqd", p, v)
        return (lambda x, *d: x.permute(*d))(o, 0, 2, 1, 3).reshape(B, Sq, Hq * Dh) @ wo

    x = A_x
    x = x + _A_ref(_layernorm(x, axis=-1), A_k_cache, A_v_cache, A_wq, A_wo)
    x = x + _B_ref(_layernorm(x, axis=-1), B_k_cache, B_v_cache, B_wq, B_wo)
    x = x + _A_ref(_layernorm(x, axis=-1), A_k_cache, A_v_cache, A_wq, A_wo)
    x = x + _B_ref(_layernorm(x, axis=-1), B_k_cache, B_v_cache, B_wq, B_wo)
    return x
```

```asm
; @launch grid=(256,1,1) block=(256,1,1) lds=163840
.amdgcn_target "amdgcn-amd-amdhsa--gfx950"
.text
.globl interleave_layers__gqa_block_cached__sliding_block_cached__decode_kernel
.p2align 8
.type interleave_layers__gqa_block_cached__sliding_block_cached__decode_kernel,@function
interleave_layers__gqa_block_cached__sliding_block_cached__decode_kernel:
  s_load_dwordx16 s[64:79], s[0:1], 0
  s_load_dwordx8 s[80:87], s[0:1], 64
  s_load_dwordx2 s[88:89], s[0:1], 96
  s_cmp_ge_u32 s2, 256
  s_cbranch_scc1 L_exit
  v_lshrrev_b32 v8, 6, v0
  v_and_b32 v0, 63, v0
  v_readfirstlane_b32 s56, v8
  v_lshlrev_b32 v5, 4, v0
  s_and_b32 s58, s2, 7
  s_lshr_b32 s59, s2, 3
  s_lshr_b32 s53, s59, 2
  s_and_b32 s59, s59, 3
  s_lshl_b32 s52, s58, 2
  s_add_u32 s52, s52, s59
  s_mul_i32 s58, s52, 1572864
  s_lshl_b32 s59, s53, 2
  s_add_u32 s59, s59, s56
  s_mul_i32 s60, s59, 49152
  s_add_u32 s60, s60, s58
  s_mul_i32 s61, s59, 12288
  s_add_u32 s61, s61, s58
  s_add_u32 s61, s61, 1179648
  v_lshrrev_b32 v8, 9, v5
  v_bfe_u32 v9, v5, 6, 2
  v_lshl_add_u32 v8, v8, 2, v9
  v_mul_u32_u24 v8, 384, v8
  v_bfe_u32 v9, v5, 8, 1
  v_lshl_add_u32 v8, v9, 6, v8
  v_bfe_u32 v9, v5, 4, 2
  v_lshl_add_u32 v4, v9, 4, v8
  s_getpc_b64 s[96:97]
L_pc:
  s_add_u32 s96, s96, interleave_layers__gqa_block_cached__sliding_block_cached__decode_kernel-L_pc
  s_addc_u32 s97, s97, -1
  s_mov_b32 s98, L_exit-interleave_layers__gqa_block_cached__sliding_block_cached__decode_kernel
  s_mov_b32 s99, 0x20000
  s_lshr_b32 s55, s2, 3
  s_lshl_b32 s55, s55, 2
  s_add_u32 s55, s55, s56
  s_lshl_b32 s55, s55, 9
  s_mov_b32 exec_lo, 0x1010101
  s_mov_b32 exec_hi, 0x0
  buffer_load_dword v8, v5, s[96:99], s55 offen
  s_mov_b64 exec, -1
  s_waitcnt lgkmcnt(0)
  s_add_u32 s4, s66, s60
  s_addc_u32 s5, s67, 0
  s_mov_b32 s6, 50380800
  s_mov_b32 s7, 0x20000
  s_mov_b32 s57, 0x0
  buffer_load_dwordx4 a[0:3], v4, s[4:7], s57 offen offset:0 nt
  buffer_load_dwordx4 a[4:7], v4, s[4:7], s57 offen offset:128 nt
  buffer_load_dwordx4 a[8:11], v4, s[4:7], s57 offen offset:256 nt
  buffer_load_dwordx4 a[12:15], v4, s[4:7], s57 offen offset:3072 nt
  buffer_load_dwordx4 a[16:19], v4, s[4:7], s57 offen offset:3200 nt
  buffer_load_dwordx4 a[20:23], v4, s[4:7], s57 offen offset:3328 nt
  s_mov_b32 s57, 0x1800
  buffer_load_dwordx4 a[24:27], v4, s[4:7], s57 offen offset:0 nt
  buffer_load_dwordx4 a[28:31], v4, s[4:7], s57 offen offset:128 nt
  s_mul_i32 s62, s53, 983040
  s_mul_i32 s58, s52, 384
  s_add_u32 s62, s62, s58
  s_mul_i32 s63, s52, 245760
  s_mul_i32 s58, s53, 160
  s_add_u32 s63, s63, s58
  v_lshrrev_b32 v10, 3, v0
  v_and_b32 v11, 6, v10
  v_xor_b32 v11, v11, v0
  v_and_b32 v11, 7, v11
  v_mul_u32_u24 v10, 12288, v10
  v_lshl_add_u32 v6, v11, 4, v10
  v_mul_u32_u24 v10, 205, v0
  v_lshrrev_b32 v10, 11, v10
  v_mul_u32_u24 v10, 1120, v10
  v_add_u32 v7, v10, v5
  v_lshrrev_b32 v10, 7, v5
  v_mul_u32_u24 v10, 768, v10
  v_bfe_u32 v11, v5, 4, 3
  v_lshl_add_u32 v1, v11, 4, v10
  s_add_u32 s8, s68, s60
  s_addc_u32 s9, s69, 0
  s_mov_b32 s10, 50380800
  s_mov_b32 s11, 0x20000
  s_add_u32 s12, s76, s61
  s_addc_u32 s13, s77, 0
  s_mov_b32 s14, 50343936
  s_mov_b32 s15, 0x20000
  s_add_u32 s16, s78, s61
  s_addc_u32 s17, s79, 0
  s_mov_b32 s18, 50343936
  s_mov_b32 s19, 0x20000
  s_add_u32 s20, s70, s62
  s_addc_u32 s21, s71, 0
  s_mov_b32 s22, 971136
  s_mov_b32 s23, 0x20000
  s_add_u32 s24, s72, s63
  s_addc_u32 s25, s73, 0
  s_mov_b32 s26, 244640
  s_mov_b32 s27, 0x20000
  s_add_u32 s28, s80, s62
  s_addc_u32 s29, s81, 0
  s_mov_b32 s30, 971136
  s_mov_b32 s31, 0x20000
  s_add_u32 s32, s82, s63
  s_addc_u32 s33, s83, 0
  s_mov_b32 s34, 244640
  s_mov_b32 s35, 0x20000
  s_mov_b32 s36, s88
  s_mov_b32 s37, s89
  s_mov_b32 s38, 8388608
  s_mov_b32 s39, 0x20000
  s_mov_b32 s40, s64
  s_mov_b32 s41, s65
  s_mov_b32 s42, 2560
  s_mov_b32 s43, 0x20000
  s_mov_b32 s44, s84
  s_mov_b32 s45, s85
  s_mov_b32 s46, 2560
  s_mov_b32 s47, 0x20000
  s_mov_b32 s48, s86
  s_mov_b32 s49, s87
  s_mov_b32 s50, 256
  s_mov_b32 s51, 0x20000
  s_lshl_b32 s65, s52, 12
  s_lshl_b32 s59, s53, 4
  s_add_u32 s64, s65, s59
  s_lshl_b32 s59, s53, 9
  s_add_u32 s77, s65, s59
  s_lshl_b32 s59, s53, 10
  s_lshl_b32 s58, s53, 14
  s_add_u32 s67, s58, 5242880
  s_lshl_b32 s58, s52, 9
  s_add_u32 s66, s67, s58
  s_mul_i32 s58, s52, 24576
  s_add_u32 s69, s58, 2097152
  s_add_u32 s68, s69, s59
  s_lshl_b32 s58, s2, 10
  s_add_u32 s70, s58, 6291456
  s_mul_i32 s58, s56, 9216
  s_add_u32 s71, s58, 122880
  s_mov_b32 s75, 0
  s_getreg_b32 s76, hwreg(HW_REG_XCC_ID, 0, 3)
  s_waitcnt vmcnt(6)
  s_add_u32 s58, s56, 0
  s_mul_i32 s59, s58, 43
  s_lshr_b32 s59, s59, 7
  s_mul_i32 s59, s59, 97920
  s_lshl_b32 s57, s58, 7
  s_add_u32 s57, s57, s59
  s_lshl_b32 s58, s58, 10
  s_add_u32 m0, s58, 0
  s_nop 0
  buffer_load_dwordx4 v6, s[20:23], s57 offen nt lds
  s_waitcnt vmcnt(6)
  s_add_u32 s58, s56, 4
  s_mul_i32 s59, s58, 43
  s_lshr_b32 s59, s59, 7
  s_mul_i32 s59, s59, 97920
  s_lshl_b32 s57, s58, 7
  s_add_u32 s57, s57, s59
  s_lshl_b32 s58, s58, 10
  s_add_u32 m0, s58, 0
  s_nop 0
  buffer_load_dwordx4 v6, s[20:23], s57 offen nt lds
  s_waitcnt vmcnt(6)
  s_add_u32 s58, s56, 8
  s_mul_i32 s59, s58, 43
  s_lshr_b32 s59, s59, 7
  s_mul_i32 s59, s59, 97920
  s_lshl_b32 s57, s58, 7
  s_add_u32 s57, s57, s59
  s_lshl_b32 s58, s58, 10
  s_add_u32 m0, s58, 0
  s_nop 0
  buffer_load_dwordx4 v6, s[20:23], s57 offen nt lds
  s_waitcnt vmcnt(6)
  s_add_u32 s58, s56, 12
  s_mul_i32 s59, s58, 43
  s_lshr_b32 s59, s59, 7
  s_mul_i32 s59, s59, 97920
  s_lshl_b32 s57, s58, 7
  s_add_u32 s57, s57, s59
  s_lshl_b32 s58, s58, 10
  s_add_u32 m0, s58, 0
  s_nop 0
  buffer_load_dwordx4 v6, s[20:23], s57 offen nt lds
  s_waitcnt vmcnt(6)
  s_add_u32 s58, s56, 16
  s_mul_i32 s59, s58, 43
  s_lshr_b32 s59, s59, 7
  s_mul_i32 s59, s59, 97920
  s_lshl_b32 s57, s58, 7
  s_add_u32 s57, s57, s59
  s_lshl_b32 s58, s58, 10
  s_add_u32 m0, s58, 0
  s_nop 0
  buffer_load_dwordx4 v6, s[20:23], s57 offen nt lds
  s_waitcnt vmcnt(6)
  s_add_u32 s58, s56, 20
  s_mul_i32 s59, s58, 43
  s_lshr_b32 s59, s59, 7
  s_mul_i32 s59, s59, 97920
  s_lshl_b32 s57, s58, 7
  s_add_u32 s57, s57, s59
  s_lshl_b32 s58, s58, 10
  s_add_u32 m0, s58, 0
  s_nop 0
  buffer_load_dwordx4 v6, s[20:23], s57 offen nt lds
  s_waitcnt vmcnt(6)
  s_add_u32 s58, s56, 24
  s_mul_i32 s59, s58, 43
  s_lshr_b32 s59, s59, 7
  s_mul_i32 s59, s59, 97920
  s_lshl_b32 s57, s58, 7
  s_add_u32 s57, s57, s59
  s_lshl_b32 s58, s58, 10
  s_add_u32 m0, s58, 0
  s_nop 0
  buffer_load_dwordx4 v6, s[20:23], s57 offen nt lds
  s_waitcnt vmcnt(6)
  s_add_u32 s58, s56, 28
  s_min_u32 s58, s58, 29
  s_mul_i32 s59, s58, 43
  s_lshr_b32 s59, s59, 7
  s_mul_i32 s59, s59, 97920
  s_lshl_b32 s57, s58, 7
  s_add_u32 s57, s57, s59
  s_lshl_b32 s58, s58, 10
  s_add_u32 m0, s58, 0
  s_nop 0
  buffer_load_dwordx4 v6, s[20:23], s57 offen nt lds
  s_waitcnt vmcnt(6)
  v_bfe_u32 v10, v5, 5, 3
  v_add_u32 v11, -1, v10
  v_and_b32 v11, 3, v11
  v_add_u32 v11, 1, v11
  v_min_u32 v10, v11, v10
  v_lshrrev_b32 v11, 8, v5
  v_lshl_add_u32 v10, v10, 2, v11
  v_mul_u32_u24 v10, 8, v10
  v_bfe_u32 v11, v5, 4, 1
  v_mul_u32_u24 v11, 1280, v11
  v_add_u32 v10, v10, v11
  s_mul_i32 s58, s53, 160
  buffer_load_dwordx2 v[2:3], v10, s[40:43], s58 offen
  s_waitcnt vmcnt(6)
  s_mov_b32 s57, 0x1800
  buffer_load_dwordx4 a[32:35], v4, s[4:7], s57 offen offset:256 nt
  s_waitcnt vmcnt(6)
  buffer_load_dwordx4 a[36:39], v4, s[4:7], s57 offen offset:3072 nt
  s_waitcnt vmcnt(6)
  buffer_load_dwordx4 a[40:43], v4, s[4:7], s57 offen offset:3200 nt
  s_waitcnt vmcnt(6)
  buffer_load_dwordx4 a[44:47], v4, s[4:7], s57 offen offset:3328 nt
  v_mov_b32 v12, -1
  v_mov_b32 v13, -1
  v_mov_b32 v14, -1
  v_mov_b32 v15, -1
  s_cmp_eq_u32 s56, 0
  s_cbranch_scc0 L_w_1
  s_mov_b32 exec_lo, 0xffffffff
  s_mov_b32 exec_hi, 0xffffff
  s_add_u32 s74, s68, 0
  buffer_store_dwordx4 v[12:15], v5, s[36:39], s74 offen sc1
  s_add_u32 s74, s68, 802816
  buffer_store_dwordx4 v[12:15], v5, s[36:39], s74 offen sc1
  s_mov_b32 exec_lo, 0xffffff
  s_mov_b32 exec_hi, 0x0
  s_add_u32 s74, s66, 0
  buffer_store_dwordx4 v[12:15], v5, s[36:39], s74 offen sc1
  s_mov_b64 exec, -1
L_w_1:
  s_cmp_eq_u32 s56, 1
  s_cbranch_scc0 L_w_2
  s_mov_b32 exec_lo, 0xffffffff
  s_mov_b32 exec_hi, 0xffffff
  s_add_u32 s74, s68, 8192
  buffer_store_dwordx4 v[12:15], v5, s[36:39], s74 offen sc1
  s_add_u32 s74, s68, 1572864
  buffer_store_dwordx4 v[12:15], v5, s[36:39], s74 offen sc1
  s_mov_b32 exec_lo, 0xffffff
  s_mov_b32 exec_hi, 0x0
  s_add_u32 s74, s66, 262144
  buffer_store_dwordx4 v[12:15], v5, s[36:39], s74 offen sc1
  s_mov_b64 exec, -1
L_w_2:
  s_cmp_eq_u32 s56, 2
  s_cbranch_scc0 L_w_3
  s_mov_b32 exec_lo, 0xffffffff
  s_mov_b32 exec_hi, 0xffffff
  s_add_u32 s74, s68, 16384
  buffer_store_dwordx4 v[12:15], v5, s[36:39], s74 offen sc1
  s_mov_b32 exec_lo, 0xffffffff
  s_mov_b32 exec_hi, 0x0
  s_add_u32 s74, s77, 0
  buffer_store_dwordx4 v[12:15], v5, s[36:39], s74 offen sc1
  s_mov_b32 exec_lo, 0xffffff
  s_mov_b32 exec_hi, 0x0
  s_add_u32 s74, s66, 524288
  buffer_store_dwordx4 v[12:15], v5, s[36:39], s74 offen sc1
  s_mov_b64 exec, -1
L_w_3:
  s_cmp_eq_u32 s56, 3
  s_cbranch_scc0 L_w_4
  s_mov_b32 exec_lo, 0xffffffff
  s_mov_b32 exec_hi, 0xffffff
  s_add_u32 s74, s68, 786432
  buffer_store_dwordx4 v[12:15], v5, s[36:39], s74 offen sc1
  s_mov_b32 exec_lo, 0xffffffff
  s_mov_b32 exec_hi, 0x0
  s_add_u32 s74, s77, 262144
  buffer_store_dwordx4 v[12:15], v5, s[36:39], s74 offen sc1
  s_mov_b64 exec, -1
L_w_4:
  s_waitcnt vmcnt(9)
  s_mov_b32 s57, 0x3000
  buffer_load_dwordx4 a[48:51], v4, s[4:7], s57 offen offset:0 nt
  s_waitcnt vmcnt(9)
  buffer_load_dwordx4 a[52:55], v4, s[4:7], s57 offen offset:128 nt
  s_waitcnt vmcnt(9)
  buffer_load_dwordx4 a[56:59], v4, s[4:7], s57 offen offset:256 nt
  s_waitcnt vmcnt(9)
  buffer_load_dwordx4 a[60:63], v4, s[4:7], s57 offen offset:3072 nt
  s_waitcnt vmcnt(9)
  buffer_load_dwordx4 a[64:67], v4, s[4:7], s57 offen offset:3200 nt
  s_waitcnt vmcnt(9)
  buffer_load_dwordx4 a[68:71], v4, s[4:7], s57 offen offset:3328 nt
  s_waitcnt vmcnt(9)
  s_mov_b32 s57, 0x4800
  buffer_load_dwordx4 a[72:75], v4, s[4:7], s57 offen offset:0 nt
  s_waitcnt vmcnt(6)
  buffer_load_dwordx4 a[76:79], v4, s[4:7], s57 offen offset:128 nt
  s_waitcnt vmcnt(6)
  buffer_load_dwordx4 a[80:83], v4, s[4:7], s57 offen offset:256 nt
  s_waitcnt lgkmcnt(0)
  s_barrier
  s_cmp_eq_u32 s56, 3
  s_cbranch_scc0 L_w_5
  s_lshl_b32 s62, s76, 2
  s_lshl_b32 s62, 1, s62
  s_lshl_b32 s63, s52, 3
  s_atomic_add s62, s[48:49], s63
L_w_5:
  s_mov_b32 exec_lo, 0x1010101
  s_mov_b32 exec_hi, 0x0
  buffer_load_dword v9, v5, s[96:99], s55 offen
  s_mov_b64 exec, -1
  v_lshlrev_b32 v10, 3, v5
  s_add_u32 s58, s68, 0
  s_add_u32 s59, s68, 8192
  s_cmp_eq_u32 s56, 1
  s_cselect_b32 s58, s59, s58
  s_add_u32 s59, s68, 16384
  s_cmp_eq_u32 s56, 2
  s_cselect_b32 s58, s59, s58
  s_add_u32 s59, s77, 0
  s_cmp_eq_u32 s56, 3
  s_cselect_b32 s58, s59, s58
  s_mov_b32 exec_lo, 0x7f
  s_mov_b32 exec_hi, 0x0
  buffer_load_dword v11, v10, s[36:39], s58 offen sc1
  s_mov_b64 exec, -1
  s_waitcnt vmcnt(8)
  s_mov_b32 s57, 0x4800
  buffer_load_dwordx4 a[84:87], v4, s[4:7], s57 offen offset:3072 nt
  s_waitcnt vmcnt(8)
  buffer_load_dwordx4 a[88:91], v4, s[4:7], s57 offen offset:3200 nt
  s_waitcnt vmcnt(8)
  buffer_load_dwordx4 a[92:95], v4, s[4:7], s57 offen offset:3328 nt
  s_waitcnt vmcnt(8)
  s_mov_b32 s57, 0x6000
  buffer_load_dwordx4 a[96:99], v4, s[4:7], s57 offen offset:0 nt
  s_waitcnt vmcnt(8)
  buffer_load_dwordx4 a[100:103], v4, s[4:7], s57 offen offset:128 nt
  s_waitcnt vmcnt(8)
  buffer_load_dwordx4 a[104:107], v4, s[4:7], s57 offen offset:256 nt
  s_waitcnt vmcnt(8)
  buffer_load_dwordx4 a[108:111], v4, s[4:7], s57 offen offset:3072 nt
  s_waitcnt vmcnt(6)
  buffer_load_dwordx4 a[112:115], v4, s[4:7], s57 offen offset:3200 nt
  s_waitcnt vmcnt(6)
  buffer_load_dwordx4 a[116:119], v4, s[4:7], s57 offen offset:3328 nt
  s_waitcnt vmcnt(6)
  s_mov_b32 s57, 0x7800
  buffer_load_dwordx4 a[120:123], v4, s[4:7], s57 offen offset:0 nt
  s_waitcnt vmcnt(6)
  buffer_load_dwordx4 a[124:127], v4, s[4:7], s57 offen offset:128 nt
  s_waitcnt vmcnt(6)
  buffer_load_dwordx4 a[128:131], v4, s[4:7], s57 offen offset:256 nt
  s_waitcnt vmcnt(6)
  buffer_load_dwordx4 a[132:135], v4, s[4:7], s57 offen offset:3072 nt
  s_waitcnt vmcnt(6)
  buffer_load_dwordx4 a[136:139], v4, s[4:7], s57 offen offset:3200 nt
  s_waitcnt vmcnt(6)
  buffer_load_dwordx4 a[140:143], v4, s[4:7], s57 offen offset:3328 nt
  s_waitcnt vmcnt(6)
  s_mov_b32 s57, 0x9000
  buffer_load_dwordx4 a[144:147], v4, s[4:7], s57 offen offset:0 nt
  s_waitcnt vmcnt(6)
  buffer_load_dwordx4 a[148:151], v4, s[4:7], s57 offen offset:128 nt
  s_waitcnt vmcnt(6)
  buffer_load_dwordx4 a[152:155], v4, s[4:7], s57 offen offset:256 nt
  s_waitcnt vmcnt(6)
  buffer_load_dwordx4 a[156:159], v4, s[4:7], s57 offen offset:3072 nt
  s_waitcnt vmcnt(6)
  buffer_load_dwordx4 a[160:163], v4, s[4:7], s57 offen offset:3200 nt
  s_waitcnt vmcnt(6)
  buffer_load_dwordx4 a[164:167], v4, s[4:7], s57 offen offset:3328 nt
  s_waitcnt vmcnt(6)
  s_mov_b32 s57, 0xa800
  buffer_load_dwordx4 a[168:171], v4, s[4:7], s57 offen offset:0 nt
  v_bfe_u32 v9, v5, 4, 5
  v_lshlrev_b32 v9, 3, v9
  buffer_load_dword v8, v9, s[48:51], 0 offen sc1
  s_mov_b64 exec, -1
  s_waitcnt vmcnt(7)
  buffer_load_dwordx4 a[172:175], v4, s[4:7], s57 offen offset:128 nt
  s_waitcnt vmcnt(7)
  buffer_load_dwordx4 a[176:179], v4, s[4:7], s57 offen offset:256 nt
  s_waitcnt vmcnt(7)
  buffer_load_dwordx4 a[180:183], v4, s[4:7], s57 offen offset:3072 nt
  s_waitcnt vmcnt(7)
  buffer_load_dwordx4 a[184:187], v4, s[4:7], s57 offen offset:3200 nt
  s_waitcnt vmcnt(7)
  buffer_load_dwordx4 a[188:191], v4, s[4:7], s57 offen offset:3328 nt
  s_waitcnt vmcnt(7)
  s_add_u32 s58, s56, 0
  s_mul_i32 s57, s58, 7680
  s_mul_i32 s58, s58, 960
  s_add_u32 m0, s58, 30720
  s_mov_b32 exec_hi, 0x0fffffff
  buffer_load_dwordx4 v7, s[24:27], s57 offen  lds
  s_mov_b32 exec_hi, -1
  s_waitcnt vmcnt(7)
  s_add_u32 s58, s56, 4
  s_mul_i32 s57, s58, 7680
  s_mul_i32 s58, s58, 960
  s_add_u32 m0, s58, 30720
  s_mov_b32 exec_hi, 0x0fffffff
  buffer_load_dwordx4 v7, s[24:27], s57 offen  lds
  s_mov_b32 exec_hi, -1
  s_waitcnt vmcnt(6)
  s_add_u32 s58, s56, 8
  s_mul_i32 s57, s58, 7680
  s_mul_i32 s58, s58, 960
  s_add_u32 m0, s58, 30720
  s_mov_b32 exec_hi, 0x0fffffff
  buffer_load_dwordx4 v7, s[24:27], s57 offen  lds
  s_mov_b32 exec_hi, -1
  s_mov_b32 s72, 0
  s_waitcnt vmcnt(8)
L_chk_6:
  v_lshrrev_b32 v10, 4, v8
  v_and_b32 v10, 0x0f0f0f0f, v10
  v_and_b32 v11, 0x0f0f0f0f, v8
  v_add_u32 v10, v10, v11
  v_sad_u8 v10, v10, 0, 0
  v_cmp_ne_u32 vcc, 8, v10
  s_cbranch_vccz L_ok_7
  s_add_u32 s72, s72, 1
  s_cmp_ge_u32 s72, 65536
  s_cbranch_scc1 L_ok_7
  s_sleep 16
  buffer_load_dword v8, v9, s[48:51], 0 offen sc1
  s_waitcnt vmcnt(0)
  s_branch L_chk_6
L_ok_7:
  v_readlane_b32 s58, v8, s52
  s_lshl_b32 s59, s76, 2
  s_lshl_b32 s59, 8, s59
  s_cmp_eq_u32 s58, s59
  s_cselect_b32 s75, 1, 0
  v_lshrrev_b32 v8, 9, v5
  v_mul_u32_u24 v8, 3072, v8
  v_bfe_u32 v9, v5, 6, 3
  v_lshl_add_u32 v8, v9, 7, v8
  v_bfe_u32 v9, v5, 4, 2
  v_lshl_add_u32 v8, v9, 3, v8
  s_max_u32 s58, s56, 1
  s_lshl_b32 s58, s58, 10
  s_add_u32 s58, s58, 0xfffffc00
  v_add_u32 v8, s58, v8
  v_bfe_u32 v9, v5, 7, 2
  v_lshl_add_u32 v12, v9, 5, v8
  v_xor_b32 v13, 32, v12
  v_xor_b32 v14, 64, v12
  v_xor_b32 v15, 96, v12
  ds_read_b64_tr_b16 v[8:9], v12 offset:24576
  ds_read_b64_tr_b16 v[10:11], v13 offset:24576
  ds_read_b64_tr_b16 v[16:17], v14 offset:24576
  ds_read_b64_tr_b16 v[18:19], v15 offset:24576
  ds_read_b64_tr_b16 v[20:21], v12 offset:0
  ds_read_b64_tr_b16 v[24:25], v13 offset:0
  ds_read_b64_tr_b16 v[28:29], v14 offset:0
  ds_read_b64_tr_b16 v[32:33], v15 offset:0
  ds_read_b64_tr_b16 v[22:23], v12 offset:6144
  ds_read_b64_tr_b16 v[26:27], v13 offset:6144
  ds_read_b64_tr_b16 v[30:31], v14 offset:6144
  ds_read_b64_tr_b16 v[34:35], v15 offset:6144
  ds_read_b64_tr_b16 v[36:37], v12 offset:12288
  ds_read_b64_tr_b16 v[40:41], v13 offset:12288
  ds_read_b64_tr_b16 v[44:45], v14 offset:12288
  ds_read_b64_tr_b16 v[48:49], v15 offset:12288
  ds_read_b64_tr_b16 v[38:39], v12 offset:18432
  ds_read_b64_tr_b16 v[42:43], v13 offset:18432
  ds_read_b64_tr_b16 v[46:47], v14 offset:18432
  ds_read_b64_tr_b16 v[50:51], v15 offset:18432
  v_lshrrev_b32 v12, 2, v5
  v_mov_b32 v13, 0x3f803f80
  s_mov_b32 vcc_lo, 0x44444444
  s_mov_b32 vcc_hi, 0x44444444
  v_cndmask_b32_dpp v14, v2, v13, vcc row_newbcast:8 row_mask:0xf bank_mask:0xf
  v_cndmask_b32_dpp v15, v3, v13, vcc row_newbcast:8 row_mask:0xf bank_mask:0xf
  v_cndmask_b32_dpp v52, v2, v13, vcc row_newbcast:0 row_mask:0xf bank_mask:0xf
  v_cndmask_b32_dpp v53, v3, v13, vcc row_newbcast:0 row_mask:0xf bank_mask:0xf
  v_cndmask_b32_dpp v54, v2, v13, vcc row_newbcast:2 row_mask:0xf bank_mask:0xf
  v_cndmask_b32_dpp v55, v3, v13, vcc row_newbcast:2 row_mask:0xf bank_mask:0xf
  v_cndmask_b32_dpp v56, v2, v13, vcc row_newbcast:4 row_mask:0xf bank_mask:0xf
  v_cndmask_b32_dpp v57, v3, v13, vcc row_newbcast:4 row_mask:0xf bank_mask:0xf
  v_cndmask_b32_dpp v58, v2, v13, vcc row_newbcast:6 row_mask:0xf bank_mask:0xf
  v_cndmask_b32_dpp v59, v3, v13, vcc row_newbcast:6 row_mask:0xf bank_mask:0xf
  s_waitcnt lgkmcnt(0)
  s_cmp_eq_u32 s56, 0
  s_cbranch_scc1 L_q0_8
  v_mfma_f32_16x16x16_bf16 v[60:63], v[14:15], v[8:9], 0
  v_mfma_f32_16x16x16_bf16 v[64:67], v[14:15], v[10:11], 0
  v_mfma_f32_16x16x16_bf16 v[68:71], v[14:15], v[16:17], 0
  v_mfma_f32_16x16x16_bf16 v[72:75], v[14:15], v[18:19], 0
  s_lshl_b32 s58, s56, 8
  s_add_u32 s73, s68, 0xffffff00
  s_add_u32 s73, s73, s58
  s_nop 1
  v_mfma_f32_16x16x32_bf16 v[60:63], v[52:55], v[20:23], v[60:63]
  v_mfma_f32_16x16x32_bf16 v[64:67], v[52:55], v[24:27], v[64:67]
  v_mfma_f32_16x16x32_bf16 v[68:71], v[52:55], v[28:31], v[68:71]
  v_mfma_f32_16x16x32_bf16 v[72:75], v[52:55], v[32:35], v[72:75]
  v_mfma_f32_16x16x32_bf16 v[60:63], v[56:59], v[36:39], v[60:63]
  v_mfma_f32_16x16x32_bf16 v[64:67], v[56:59], v[40:43], v[64:67]
  v_mfma_f32_16x16x32_bf16 v[68:71], v[56:59], v[44:47], v[68:71]
  v_mfma_f32_16x16x32_bf16 v[72:75], v[56:59], v[48:51], v[72:75]
  s_add_u32 s74, s73, 16384
  s_nop 4
  v_mov_b32_dpp v60, v64 quad_perm:[0,1,2,3] row_mask:0x2 bank_mask:0xf
  v_mov_b32_dpp v62, v66 quad_perm:[0,1,2,3] row_mask:0x2 bank_mask:0xf
  s_nop 0
  v_mov_b32_dpp v60, v68 quad_perm:[0,1,2,3] row_mask:0x4 bank_mask:0xf
  v_mov_b32_dpp v62, v70 quad_perm:[0,1,2,3] row_mask:0x4 bank_mask:0xf
  s_nop 0
  v_mov_b32_dpp v60, v72 quad_perm:[0,1,2,3] row_mask:0x8 bank_mask:0xf
  v_mov_b32_dpp v62, v74 quad_perm:[0,1,2,3] row_mask:0x8 bank_mask:0xf
  s_cmp_eq_u32 s75, 0
  s_cbranch_scc1 L_slow_10
  buffer_store_dword v60, v12, s[36:39], s73 offen
  buffer_store_dword v62, v12, s[36:39], s74 offen
  s_branch L_pub_11
L_slow_10:
  buffer_store_dword v60, v12, s[36:39], s73 offen sc1
  buffer_store_dword v62, v12, s[36:39], s74 offen sc1
L_pub_11:
  s_branch L_qe_9
L_q0_8:
  v_mfma_f32_16x16x16_bf16 v[60:63], v[14:15], v[14:15], 0
  v_mfma_f32_16x16x32_bf16 v[64:67], v[52:55], v[52:55], 0
  v_mfma_f32_16x16x32_bf16 v[64:67], v[56:59], v[56:59], v[64:67]
  s_add_u32 s73, s68, 0
  s_mov_b64 exec, 1
  s_nop 5
  v_add_f32 v60, v60, v64
  v_add_f32 v61, v62, v66
  s_cmp_eq_u32 s75, 0
  s_cbranch_scc1 L_slow_12
  buffer_store_dwordx2 v[60:61], v12, s[36:39], s73 offen offset:768
  s_branch L_pub_13
L_slow_12:
  buffer_store_dwordx2 v[60:61], v12, s[36:39], s73 offen offset:768 sc1
L_pub_13:
  s_mov_b64 exec, -1
L_qe_9:
  s_add_u32 s58, s56, 12
  s_mul_i32 s57, s58, 7680
  s_mul_i32 s58, s58, 960
  s_add_u32 m0, s58, 30720
  s_mov_b32 exec_hi, 0x0fffffff
  buffer_load_dwordx4 v7, s[24:27], s57 offen  lds
  s_mov_b32 exec_hi, -1
  s_add_u32 s58, s56, 16
  s_mul_i32 s57, s58, 7680
  s_mul_i32 s58, s58, 960
  s_add_u32 m0, s58, 30720
  s_mov_b32 exec_hi, 0x0fffffff
  buffer_load_dwordx4 v7, s[24:27], s57 offen  lds
  s_mov_b32 exec_hi, -1
  v_cndmask_b32_dpp v14, v2, v13, vcc row_newbcast:9 row_mask:0xf bank_mask:0xf
  v_cndmask_b32_dpp v15, v3, v13, vcc row_newbcast:9 row_mask:0xf bank_mask:0xf
  v_cndmask_b32_dpp v52, v2, v13, vcc row_newbcast:1 row_mask:0xf bank_mask:0xf
  v_cndmask_b32_dpp v53, v3, v13, vcc row_newbcast:1 row_mask:0xf bank_mask:0xf
  v_cndmask_b32_dpp v54, v2, v13, vcc row_newbcast:3 row_mask:0xf bank_mask:0xf
  v_cndmask_b32_dpp v55, v3, v13, vcc row_newbcast:3 row_mask:0xf bank_mask:0xf
  v_cndmask_b32_dpp v56, v2, v13, vcc row_newbcast:5 row_mask:0xf bank_mask:0xf
  v_cndmask_b32_dpp v57, v3, v13, vcc row_newbcast:5 row_mask:0xf bank_mask:0xf
  v_cndmask_b32_dpp v58, v2, v13, vcc row_newbcast:7 row_mask:0xf bank_mask:0xf
  v_cndmask_b32_dpp v59, v3, v13, vcc row_newbcast:7 row_mask:0xf bank_mask:0xf
  s_waitcnt lgkmcnt(0)
  s_cmp_eq_u32 s56, 0
  s_cbranch_scc1 L_q0_14
  v_mfma_f32_16x16x16_bf16 v[60:63], v[14:15], v[8:9], 0
  v_mfma_f32_16x16x16_bf16 v[64:67], v[14:15], v[10:11], 0
  v_mfma_f32_16x16x16_bf16 v[8:11], v[14:15], v[16:17], 0
  v_mfma_f32_16x16x16_bf16 v[68:71], v[14:15], v[18:19], 0
  s_lshl_b32 s58, s56, 8
  s_add_u32 s73, s68, 0x1f00
  s_add_u32 s73, s73, s58
  s_nop 1
  v_mfma_f32_16x16x32_bf16 v[60:63], v[52:55], v[20:23], v[60:63]
  v_mfma_f32_16x16x32_bf16 v[64:67], v[52:55], v[24:27], v[64:67]
  v_mfma_f32_16x16x32_bf16 v[8:11], v[52:55], v[28:31], v[8:11]
  v_mfma_f32_16x16x32_bf16 v[68:71], v[52:55], v[32:35], v[68:71]
  v_mfma_f32_16x16x32_bf16 v[60:63], v[56:59], v[36:39], v[60:63]
  v_mfma_f32_16x16x32_bf16 v[64:67], v[56:59], v[40:43], v[64:67]
  v_mfma_f32_16x16x32_bf16 v[8:11], v[56:59], v[44:47], v[8:11]
  v_mfma_f32_16x16x32_bf16 v[68:71], v[56:59], v[48:51], v[68:71]
  s_nop 5
  v_mov_b32_dpp v60, v64 quad_perm:[0,1,2,3] row_mask:0x2 bank_mask:0xf
  s_nop 1
  v_mov_b32_dpp v60, v8 quad_perm:[0,1,2,3] row_mask:0x4 bank_mask:0xf
  s_nop 1
  v_mov_b32_dpp v60, v68 quad_perm:[0,1,2,3] row_mask:0x8 bank_mask:0xf
  s_cmp_eq_u32 s75, 0
  s_cbranch_scc1 L_slow_16
  buffer_store_dword v60, v12, s[36:39], s73 offen
  s_branch L_pub_17
L_slow_16:
  buffer_store_dword v60, v12, s[36:39], s73 offen sc1
L_pub_17:
  s_branch L_qe_15
L_q0_14:
  v_mfma_f32_16x16x16_bf16 v[60:63], v[14:15], v[14:15], 0
  v_mfma_f32_16x16x32_bf16 v[64:67], v[52:55], v[52:55], 0
  v_mfma_f32_16x16x32_bf16 v[64:67], v[56:59], v[56:59], v[64:67]
  s_add_u32 s73, s68, 8192
  s_mov_b64 exec, 1
  s_nop 5
  v_add_f32 v60, v60, v64
  v_add_f32 v61, v62, v66
  s_cmp_eq_u32 s75, 0
  s_cbranch_scc1 L_slow_18
  buffer_store_dwordx2 v[60:61], v12, s[36:39], s73 offen offset:768
  s_branch L_pub_19
L_slow_18:
  buffer_store_dwordx2 v[60:61], v12, s[36:39], s73 offen offset:768 sc1
L_pub_19:
  s_mov_b64 exec, -1
L_qe_15:
  s_waitcnt vmcnt(9)
  s_add_u32 s58, s56, 20
  s_mul_i32 s57, s58, 7680
  s_mul_i32 s58, s58, 960
  s_add_u32 m0, s58, 30720
  s_mov_b32 exec_hi, 0x0fffffff
  buffer_load_dwordx4 v7, s[24:27], s57 offen  lds
  s_mov_b32 exec_hi, -1
  s_waitcnt vmcnt(9)
  s_add_u32 s58, s56, 24
  s_mul_i32 s57, s58, 7680
  s_mul_i32 s58, s58, 960
  s_add_u32 m0, s58, 30720
  s_mov_b32 exec_hi, 0x0fffffff
  buffer_load_dwordx4 v7, s[24:27], s57 offen  lds
  s_mov_b32 exec_hi, -1
  s_waitcnt vmcnt(9)
  s_add_u32 s58, s56, 28
  s_mul_i32 s57, s58, 7680
  s_mul_i32 s58, s58, 960
  s_add_u32 m0, s58, 30720
  s_mov_b32 exec_hi, 0x0fffffff
  buffer_load_dwordx4 v7, s[24:27], s57 offen  lds
  s_mov_b32 exec_hi, -1
  s_waitcnt vmcnt(9)
  s_add_u32 m0, s71, 0
  s_mov_b32 s57, 0x0
  buffer_load_dwordx4 v1, s[8:11], s57 offen offset:0 nt lds
  s_waitcnt vmcnt(9)
  s_add_u32 m0, s71, 896
  s_nop 0
  buffer_load_dwordx4 v1, s[8:11], s57 offen offset:128 nt lds
  s_waitcnt vmcnt(7)
  s_add_u32 m0, s71, 1792
  s_nop 0
  buffer_load_dwordx4 v1, s[8:11], s57 offen offset:256 nt lds
  s_waitcnt vmcnt(7)
  s_add_u32 m0, s71, 2688
  s_nop 0
  buffer_load_dwordx4 v1, s[8:11], s57 offen offset:384 nt lds
  s_waitcnt vmcnt(6)
  s_add_u32 m0, s71, 3584
  s_nop 0
  buffer_load_dwordx4 v1, s[8:11], s57 offen offset:512 nt lds
  s_waitcnt vmcnt(6)
  s_add_u32 m0, s71, 4480
  s_nop 0
  buffer_load_dwordx4 v1, s[8:11], s57 offen offset:640 nt lds
  s_waitcnt vmcnt(6)
  s_add_u32 m0, s71, 6144
  s_mov_b32 s57, 0x1800
  buffer_load_dwordx4 v1, s[8:11], s57 offen offset:0 nt lds
  s_waitcnt vmcnt(6)
  s_add_u32 m0, s71, 7040
  s_nop 0
  buffer_load_dwordx4 v1, s[8:11], s57 offen offset:128 nt lds
  s_waitcnt vmcnt(6)
  s_add_u32 m0, s71, 7936
  s_nop 0
  buffer_load_dwordx4 v1, s[8:11], s57 offen offset:256 nt lds
  v_lshrrev_b32 v9, 8, v5
  v_and_b32 v8, 0xf0, v5
  v_lshl_add_u32 v8, v9, 10, v8
  v_bfe_u32 v11, v5, 1, 7
  v_lshl_add_u32 v11, v9, 1, v11
  s_lshl_b32 s58, s56, 7
  s_add_u32 s58, s58, 162880
  v_add_u32 v11, s58, v11
  v_lshlrev_b32 v9, 6, v5
  v_mov_b32 v10, 163264
  v_mov_b32 v12, 0
  v_mov_b32 v13, 0
  s_cmp_lt_u32 s56, 3
  s_cbranch_scc0 L_w_20
  s_add_u32 s74, s69, 16384
  s_lshl_b32 s73, s56, 8
  s_add_u32 s73, s73, s74
  s_add_u32 s74, s73, 4096
  buffer_load_dwordx4 v[16:19], v8, s[36:39], s73 offen sc1
  buffer_load_dwordx4 v[20:23], v8, s[36:39], s74 offen sc1
  s_mov_b64 exec, -1
L_w_20:
  s_waitcnt vmcnt(8)
  s_mov_b32 s57, 0x1800
  buffer_load_dwordx4 a[192:195], v1, s[8:11], s57 offen offset:384 nt
  s_waitcnt vmcnt(8)
  buffer_load_dwordx4 a[196:199], v1, s[8:11], s57 offen offset:512 nt
  s_waitcnt vmcnt(8)
  buffer_load_dwordx4 a[200:203], v1, s[8:11], s57 offen offset:640 nt
  s_waitcnt vmcnt(8)
  s_mov_b32 s57, 0x3000
  buffer_load_dwordx4 a[204:207], v1, s[8:11], s57 offen offset:0 nt
  s_waitcnt vmcnt(8)
  buffer_load_dwordx4 a[208:211], v1, s[8:11], s57 offen offset:128 nt
  s_waitcnt vmcnt(8)
  buffer_load_dwordx4 a[212:215], v1, s[8:11], s57 offen offset:256 nt
  s_waitcnt vmcnt(8)
  buffer_load_dwordx4 a[216:219], v1, s[8:11], s57 offen offset:384 nt
  s_waitcnt vmcnt(6)
  buffer_load_dwordx4 a[220:223], v1, s[8:11], s57 offen offset:512 nt
  s_cmp_lt_u32 s56, 3
  s_cbranch_scc0 L_w_21
  s_mov_b32 s72, 0
  s_waitcnt vmcnt(8)
L_chk_22:
  v_pk_add_f32 v[16:17], v[16:17], v[20:21]
  v_pk_add_f32 v[18:19], v[18:19], v[22:23]
  s_nop 0
  v_permlane16_swap_b32 v16, v17
  v_permlane16_swap_b32 v18, v19
  v_add_f32 v16, v16, v17
  v_add_f32 v18, v18, v19
  s_nop 1
  v_permlane32_swap_b32 v16, v18
  v_add_f32 v16, v16, v18
  v_cmp_u_f32 vcc, v16, v16
  s_cbranch_vccz L_ok_23
  s_add_u32 s72, s72, 1
  s_cmp_ge_u32 s72, 65536
  s_cbranch_scc1 L_ok_23
  s_add_u32 s74, s69, 16384
  s_lshl_b32 s73, s56, 8
  s_add_u32 s73, s73, s74
  s_add_u32 s74, s73, 4096
  buffer_load_dwordx4 v[16:19], v8, s[36:39], s73 offen sc1
  buffer_load_dwordx4 v[20:23], v8, s[36:39], s74 offen sc1
  s_waitcnt vmcnt(0)
  s_branch L_chk_22
L_ok_23:
  v_mul_f32 v14, 0xbacccccd, v16
  v_lshrrev_b32 v15, 2, v5
  s_lshl_b32 s73, s56, 8
  s_add_u32 s73, s73, s70
  s_add_u32 s73, s73, 0
  s_mov_b32 s62, s73
L_w_21:
  s_cmp_lt_u32 s56, 3
  s_cbranch_scc0 L_w_24
  s_add_u32 s74, s69, 0
  s_mov_b32 exec_lo, 0xff
  s_mov_b32 exec_hi, 0x0
  buffer_load_dwordx2 v[12:13], v9, s[36:39], s74 offen offset:768 sc1
  s_mov_b64 exec, -1
  s_lshl_b32 s73, s56, 8
  s_add_u32 s73, s73, s74
  s_add_u32 s74, s73, 4096
  buffer_load_dwordx4 v[16:19], v8, s[36:39], s73 offen sc1
  buffer_load_dwordx4 v[20:23], v8, s[36:39], s74 offen sc1
  s_mov_b64 exec, -1
L_w_24:
  s_waitcnt vmcnt(9)
  s_mov_b32 s57, 0x3000
  buffer_load_dwordx4 a[224:227], v1, s[8:11], s57 offen offset:640 nt
  s_waitcnt vmcnt(9)
  s_mov_b32 s57, 0x4800
  buffer_load_dwordx4 a[228:231], v1, s[8:11], s57 offen offset:0 nt
  s_waitcnt vmcnt(9)
  buffer_load_dwordx4 a[232:235], v1, s[8:11], s57 offen offset:128 nt
  s_waitcnt vmcnt(9)
  buffer_load_dwordx4 a[236:239], v1, s[8:11], s57 offen offset:256 nt
  s_waitcnt vmcnt(9)
  buffer_load_dwordx4 a[240:243], v1, s[8:11], s57 offen offset:384 nt
  s_waitcnt vmcnt(9)
  buffer_load_dwordx4 a[244:247], v1, s[8:11], s57 offen offset:512 nt
  s_waitcnt vmcnt(9)
  buffer_load_dwordx4 a[248:251], v1, s[8:11], s57 offen offset:640 nt
  s_waitcnt vmcnt(6)
  s_mov_b32 s57, 0x6000
  buffer_load_dwordx4 a[252:255], v1, s[8:11], s57 offen offset:0 nt
  s_cmp_lt_u32 s56, 3
  s_cbranch_scc0 L_w_25
  s_mov_b32 s72, 0
  s_waitcnt vmcnt(8)
L_chk_26:
  v_pk_add_f32 v[16:17], v[16:17], v[20:21]
  v_pk_add_f32 v[18:19], v[18:19], v[22:23]
  v_add_f32_dpp v13, v13, v13 quad_perm:[1,0,3,2] row_mask:0xf bank_mask:0xf
  v_add_f32_dpp v12, v12, v12 quad_perm:[1,0,3,2] row_mask:0xf bank_mask:0xf
  v_permlane16_swap_b32 v16, v17
  v_permlane16_swap_b32 v18, v19
  v_add_f32 v16, v16, v17
  v_add_f32 v18, v18, v19
  v_add_f32_dpp v13, v13, v13 quad_perm:[2,3,0,1] row_mask:0xf bank_mask:0xf
  v_add_f32_dpp v12, v12, v12 quad_perm:[2,3,0,1] row_mask:0xf bank_mask:0xf
  v_permlane32_swap_b32 v16, v18
  v_add_f32_dpp v13, v13, v13 row_half_mirror row_mask:0xf bank_mask:0xf
  v_add_f32_dpp v12, v12, v12 row_half_mirror row_mask:0xf bank_mask:0xf
  v_add_f32 v16, v16, v18
  v_readfirstlane_b32 s58, v13
  s_nop 1
  v_fmac_f32 v16, s58, v14
  v_cmp_u_f32 vcc, v16, v12
  s_cbranch_vccz L_ok_27
  s_add_u32 s72, s72, 1
  s_cmp_ge_u32 s72, 65536
  s_cbranch_scc1 L_ok_27
  s_add_u32 s74, s69, 0
  s_mov_b32 exec_lo, 0xff
  s_mov_b32 exec_hi, 0x0
  buffer_load_dwordx2 v[12:13], v9, s[36:39], s74 offen offset:768 sc1
  s_mov_b64 exec, -1
  s_lshl_b32 s73, s56, 8
  s_add_u32 s73, s73, s74
  s_add_u32 s74, s73, 4096
  buffer_load_dwordx4 v[16:19], v8, s[36:39], s73 offen sc1
  buffer_load_dwordx4 v[20:23], v8, s[36:39], s74 offen sc1
  s_waitcnt vmcnt(0)
  s_branch L_chk_26
L_ok_27:
  v_cvt_pk_bf16_f32 v16, v16, v16
  ds_write_b16 v11, v16
  s_mov_b64 exec, 1
  ds_write_b64 v10, v[12:13]
  s_mov_b64 exec, -1
  buffer_store_dword v14, v15, s[36:39], s62 offen
L_w_25:
  v_lshrrev_b32 v9, 8, v5
  v_and_b32 v8, 0xf0, v5
  v_lshl_add_u32 v8, v9, 10, v8
  v_bfe_u32 v11, v5, 1, 7
  v_lshl_add_u32 v11, v9, 1, v11
  s_lshl_b32 s58, s56, 7
  s_add_u32 s58, s58, 163280
  v_add_u32 v11, s58, v11
  v_lshlrev_b32 v9, 6, v5
  v_mov_b32 v10, 163664
  v_mov_b32 v12, 0
  v_mov_b32 v13, 0
  s_cmp_lt_u32 s56, 3
  s_cbranch_scc0 L_w_28
  s_add_u32 s74, s69, 8192
  s_mov_b32 exec_lo, 0xff
  s_mov_b32 exec_hi, 0x0
  buffer_load_dwordx2 v[12:13], v9, s[36:39], s74 offen offset:768 sc1
  s_mov_b64 exec, -1
  s_lshl_b32 s73, s56, 8
  s_add_u32 s73, s73, s74
  s_add_u32 s74, s73, 4096
  buffer_load_dwordx4 v[16:19], v8, s[36:39], s73 offen sc1
  buffer_load_dwordx4 v[20:23], v8, s[36:39], s74 offen sc1
  s_mov_b64 exec, -1
L_w_28:
  s_waitcnt vmcnt(10)
  s_mov_b32 s57, 0x6000
  buffer_load_dwordx4 v[24:27], v1, s[8:11], s57 offen offset:128 nt
  s_waitcnt vmcnt(10)
  buffer_load_dwordx4 v[28:31], v1, s[8:11], s57 offen offset:256 nt
  s_waitcnt vmcnt(10)
  buffer_load_dwordx4 v[32:35], v1, s[8:11], s57 offen offset:384 nt
  s_waitcnt vmcnt(10)
  buffer_load_dwordx4 v[36:39], v1, s[8:11], s57 offen offset:512 nt
  s_waitcnt vmcnt(10)
  buffer_load_dwordx4 v[40:43], v1, s[8:11], s57 offen offset:640 nt
  s_waitcnt vmcnt(10)
  s_mov_b32 s57, 0x7800
  buffer_load_dwordx4 v[44:47], v1, s[8:11], s57 offen offset:0 nt
  s_waitcnt vmcnt(10)
  buffer_load_dwordx4 v[48:51], v1, s[8:11], s57 offen offset:128 nt
  s_waitcnt vmcnt(6)
  buffer_load_dwordx4 v[52:55], v1, s[8:11], s57 offen offset:256 nt
  s_cmp_lt_u32 s56, 3
  s_cbranch_scc0 L_w_29
  s_mov_b32 s72, 0
  s_waitcnt vmcnt(8)
L_chk_30:
  v_pk_add_f32 v[16:17], v[16:17], v[20:21]
  v_pk_add_f32 v[18:19], v[18:19], v[22:23]
  v_add_f32_dpp v13, v13, v13 quad_perm:[1,0,3,2] row_mask:0xf bank_mask:0xf
  v_add_f32_dpp v12, v12, v12 quad_perm:[1,0,3,2] row_mask:0xf bank_mask:0xf
  v_permlane16_swap_b32 v16, v17
  v_permlane16_swap_b32 v18, v19
  v_add_f32 v16, v16, v17
  v_add_f32 v18, v18, v19
  v_add_f32_dpp v13, v13, v13 quad_perm:[2,3,0,1] row_mask:0xf bank_mask:0xf
  v_add_f32_dpp v12, v12, v12 quad_perm:[2,3,0,1] row_mask:0xf bank_mask:0xf
  v_permlane32_swap_b32 v16, v18
  v_add_f32_dpp v13, v13, v13 row_half_mirror row_mask:0xf bank_mask:0xf
  v_add_f32_dpp v12, v12, v12 row_half_mirror row_mask:0xf bank_mask:0xf
  v_add_f32 v16, v16, v18
  v_readfirstlane_b32 s58, v13
  s_nop 1
  v_fmac_f32 v16, s58, v14
  v_cmp_u_f32 vcc, v16, v12
  s_cbranch_vccz L_ok_31
  s_add_u32 s72, s72, 1
  s_cmp_ge_u32 s72, 65536
  s_cbranch_scc1 L_ok_31
  s_add_u32 s74, s69, 8192
  s_mov_b32 exec_lo, 0xff
  s_mov_b32 exec_hi, 0x0
  buffer_load_dwordx2 v[12:13], v9, s[36:39], s74 offen offset:768 sc1
  s_mov_b64 exec, -1
  s_lshl_b32 s73, s56, 8
  s_add_u32 s73, s73, s74
  s_add_u32 s74, s73, 4096
  buffer_load_dwordx4 v[16:19], v8, s[36:39], s73 offen sc1
  buffer_load_dwordx4 v[20:23], v8, s[36:39], s74 offen sc1
  s_waitcnt vmcnt(0)
  s_branch L_chk_30
L_ok_31:
  v_cvt_pk_bf16_f32 v16, v16, v16
  ds_write_b16 v11, v16
  s_mov_b64 exec, 1
  ds_write_b64 v10, v[12:13]
  s_mov_b64 exec, -1
L_w_29:
  v_mov_b32 v8, 0
  v_mov_b32 v9, 0
  v_mov_b32 v10, 0
  v_mov_b32 v11, 0
  v_mov_b32 v12, 0
  v_mov_b32 v13, 0
  v_mov_b32 v14, 0
  v_mov_b32 v15, 0
  v_mov_b32 v16, 0
  v_mov_b32 v17, 0
  v_mov_b32 v18, 0
  v_mov_b32 v19, 0
  v_and_b32 v20, 0x30, v5
  v_bfe_u32 v21, v5, 8, 1
  v_lshl_add_u32 v20, v21, 6, v20
  v_add_u32 v20, 162880, v20
  v_mov_b32 v21, 163264
  s_waitcnt lgkmcnt(0)
  s_barrier
  s_mov_b32 exec_lo, 0xf0f0f0f
  s_mov_b32 exec_hi, 0xf0f0f0f0
  ds_read_b128 v[8:11], v20 offset:0
  ds_read_b128 v[12:15], v20 offset:128
  ds_read_b128 v[16:19], v20 offset:256
  s_mov_b64 exec, -1
  ds_read_b64 v[22:23], v21
  s_waitcnt lgkmcnt(0)
  s_waitcnt vmcnt(6)
  s_mov_b32 s57, 0x7800
  buffer_load_dwordx4 v[56:59], v1, s[8:11], s57 offen offset:384 nt
  v_mfma_f32_16x16x32_bf16 v[60:63], v[8:11], a[0:3], 0
  v_mfma_f32_16x16x32_bf16 v[64:67], v[8:11], a[12:15], 0
  v_mfma_f32_16x16x32_bf16 v[60:63], v[12:15], a[4:7], v[60:63]
  v_mul_f32 v23, 0x3acccccd, v23
  v_mul_f32 v22, 0x3acccccd, v22
  v_mfma_f32_16x16x32_bf16 v[64:67], v[12:15], a[16:19], v[64:67]
  v_fma_f32 v22, -v23, v23, v22
  v_max_f32 v22, 0, v22
  v_mfma_f32_16x16x32_bf16 v[60:63], v[16:19], a[8:11], v[60:63]
  v_add_f32 v22, 0x3727c5ac, v22
  v_rsq_f32 v22, v22
  v_mfma_f32_16x16x32_bf16 v[64:67], v[16:19], a[20:23], v[64:67]
  v_mul_f32 v22, 0x3dd53b95, v22
  s_waitcnt vmcnt(6)
  buffer_load_dwordx4 v[68:71], v1, s[8:11], s57 offen offset:512 nt
  v_mfma_f32_16x16x32_bf16 v[72:75], v[8:11], a[24:27], 0
  v_mfma_f32_16x16x32_bf16 v[76:79], v[8:11], a[36:39], 0
  v_mfma_f32_16x16x32_bf16 v[72:75], v[12:15], a[28:31], v[72:75]
  v_mov_b32_dpp v80, v60 quad_perm:[0,0,0,0] row_mask:0xf bank_mask:0xf
  s_nop 0
  v_mov_b32_dpp v20, v64 quad_perm:[0,0,0,0] row_mask:0xf bank_mask:0xf
  v_mfma_f32_16x16x32_bf16 v[76:79], v[12:15], a[40:43], v[76:79]
  v_add_f32_dpp v80, v61, v80 quad_perm:[1,1,1,1] row_mask:0xf bank_mask:0xf
  v_add_f32_dpp v20, v65, v20 quad_perm:[1,1,1,1] row_mask:0xf bank_mask:0xf
  v_mfma_f32_16x16x32_bf16 v[72:75], v[16:19], a[32:35], v[72:75]
  v_add_f32_dpp v80, v62, v80 quad_perm:[2,2,2,2] row_mask:0xf bank_mask:0xf
  v_add_f32_dpp v20, v66, v20 quad_perm:[2,2,2,2] row_mask:0xf bank_mask:0xf
  v_mfma_f32_16x16x32_bf16 v[76:79], v[16:19], a[44:47], v[76:79]
  v_add_f32_dpp v80, v63, v80 quad_perm:[3,3,3,3] row_mask:0xf bank_mask:0xf
  s_nop 1
  v_add_f32_dpp v80, v67, v20 quad_perm:[3,3,3,3] row_mask:0xc bank_mask:0xf
  s_waitcnt vmcnt(6)
  buffer_load_dwordx4 v[60:63], v1, s[8:11], s57 offen offset:640 nt
  v_mfma_f32_16x16x32_bf16 v[64:67], v[8:11], a[48:51], 0
  v_mfma_f32_16x16x32_bf16 v[84:87], v[8:11], a[60:63], 0
  v_mfma_f32_16x16x32_bf16 v[64:67], v[12:15], a[52:55], v[64:67]
  v_mov_b32_dpp v81, v72 quad_perm:[0,0,0,0] row_mask:0xf bank_mask:0xf
  v_mov_b32_dpp v20, v76 quad_perm:[0,0,0,0] row_mask:0xf bank_mask:0xf
  v_mfma_f32_16x16x32_bf16 v[84:87], v[12:15], a[64:67], v[84:87]
  v_add_f32_dpp v81, v73, v81 quad_perm:[1,1,1,1] row_mask:0xf bank_mask:0xf
  v_add_f32_dpp v20, v77, v20 quad_perm:[1,1,1,1] row_mask:0xf bank_mask:0xf
  v_mfma_f32_16x16x32_bf16 v[64:67], v[16:19], a[56:59], v[64:67]
  v_add_f32_dpp v81, v74, v81 quad_perm:[2,2,2,2] row_mask:0xf bank_mask:0xf
  v_add_f32_dpp v20, v78, v20 quad_perm:[2,2,2,2] row_mask:0xf bank_mask:0xf
  v_mfma_f32_16x16x32_bf16 v[84:87], v[16:19], a[68:71], v[84:87]
  v_add_f32_dpp v81, v75, v81 quad_perm:[3,3,3,3] row_mask:0xf bank_mask:0xf
  s_nop 1
  v_add_f32_dpp v81, v79, v20 quad_perm:[3,3,3,3] row_mask:0xc bank_mask:0xf
  s_waitcnt vmcnt(6)
  s_mov_b32 s57, 0x9000
  buffer_load_dwordx4 v[72:75], v1, s[8:11], s57 offen offset:0 nt
  v_mfma_f32_16x16x32_bf16 v[76:79], v[8:11], a[72:75], 0
  v_mfma_f32_16x16x32_bf16 v[88:91], v[8:11], a[84:87], 0
  v_mfma_f32_16x16x32_bf16 v[76:79], v[12:15], a[76:79], v[76:79]
  v_mov_b32_dpp v82, v64 quad_perm:[0,0,0,0] row_mask:0xf bank_mask:0xf
  v_mov_b32_dpp v20, v84 quad_perm:[0,0,0,0] row_mask:0xf bank_mask:0xf
  v_mfma_f32_16x16x32_bf16 v[88:91], v[12:15], a[88:91], v[88:91]
  v_add_f32_dpp v82, v65, v82 quad_perm:[1,1,1,1] row_mask:0xf bank_mask:0xf
  v_add_f32_dpp v20, v85, v20 quad_perm:[1,1,1,1] row_mask:0xf bank_mask:0xf
  v_mfma_f32_16x16x32_bf16 v[76:79], v[16:19], a[80:83], v[76:79]
  v_add_f32_dpp v82, v66, v82 quad_perm:[2,2,2,2] row_mask:0xf bank_mask:0xf
  v_add_f32_dpp v20, v86, v20 quad_perm:[2,2,2,2] row_mask:0xf bank_mask:0xf
  v_mfma_f32_16x16x32_bf16 v[88:91], v[16:19], a[92:95], v[88:91]
  v_add_f32_dpp v82, v67, v82 quad_perm:[3,3,3,3] row_mask:0xf bank_mask:0xf
  s_nop 1
  v_add_f32_dpp v82, v87, v20 quad_perm:[3,3,3,3] row_mask:0xc bank_mask:0xf
  s_waitcnt vmcnt(6)
  buffer_load_dwordx4 v[64:67], v1, s[8:11], s57 offen offset:128 nt
  v_mfma_f32_16x16x32_bf16 v[84:87], v[8:11], a[96:99], 0
  v_mfma_f32_16x16x32_bf16 v[92:95], v[8:11], a[108:111], 0
  v_mfma_f32_16x16x32_bf16 v[84:87], v[12:15], a[100:103], v[84:87]
  v_mov_b32_dpp v83, v76 quad_perm:[0,0,0,0] row_mask:0xf bank_mask:0xf
  v_mov_b32_dpp v20, v88 quad_perm:[0,0,0,0] row_mask:0xf bank_mask:0xf
  v_mfma_f32_16x16x32_bf16 v[92:95], v[12:15], a[112:115], v[92:95]
  v_add_f32_dpp v83, v77, v83 quad_perm:[1,1,1,1] row_mask:0xf bank_mask:0xf
  v_add_f32_dpp v20, v89, v20 quad_perm:[1,1,1,1] row_mask:0xf bank_mask:0xf
  v_mfma_f32_16x16x32_bf16 v[84:87], v[16:19], a[104:107], v[84:87]
  v_add_f32_dpp v83, v78, v83 quad_perm:[2,2,2,2] row_mask:0xf bank_mask:0xf
  v_add_f32_dpp v20, v90, v20 quad_perm:[2,2,2,2] row_mask:0xf bank_mask:0xf
  v_mfma_f32_16x16x32_bf16 v[92:95], v[16:19], a[116:119], v[92:95]
  v_add_f32_dpp v83, v79, v83 quad_perm:[3,3,3,3] row_mask:0xf bank_mask:0xf
  s_nop 1
  v_add_f32_dpp v83, v91, v20 quad_perm:[3,3,3,3] row_mask:0xc bank_mask:0xf
  s_waitcnt vmcnt(6)
  buffer_load_dwordx4 v[76:79], v1, s[8:11], s57 offen offset:256 nt
  v_mfma_f32_16x16x32_bf16 v[88:91], v[8:11], a[120:123], 0
  v_mfma_f32_16x16x32_bf16 v[96:99], v[8:11], a[132:135], 0
  v_mfma_f32_16x16x32_bf16 v[88:91], v[12:15], a[124:127], v[88:91]
  v_mov_b32_dpp v100, v84 quad_perm:[0,0,0,0] row_mask:0xf bank_mask:0xf
  v_mov_b32_dpp v20, v92 quad_perm:[0,0,0,0] row_mask:0xf bank_mask:0xf
  v_mfma_f32_16x16x32_bf16 v[96:99], v[12:15], a[136:139], v[96:99]
  v_add_f32_dpp v100, v85, v100 quad_perm:[1,1,1,1] row_mask:0xf bank_mask:0xf
  v_add_f32_dpp v20, v93, v20 quad_perm:[1,1,1,1] row_mask:0xf bank_mask:0xf
  v_mfma_f32_16x16x32_bf16 v[88:91], v[16:19], a[128:131], v[88:91]
  v_add_f32_dpp v100, v86, v100 quad_perm:[2,2,2,2] row_mask:0xf bank_mask:0xf
  v_add_f32_dpp v20, v94, v20 quad_perm:[2,2,2,2] row_mask:0xf bank_mask:0xf
  v_mfma_f32_16x16x32_bf16 v[96:99], v[16:19], a[140:143], v[96:99]
  v_add_f32_dpp v100, v87, v100 quad_perm:[3,3,3,3] row_mask:0xf bank_mask:0xf
  s_nop 1
  v_add_f32_dpp v100, v95, v20 quad_perm:[3,3,3,3] row_mask:0xc bank_mask:0xf
  s_waitcnt vmcnt(6)
  s_add_u32 s58, s56, 0
  s_mul_i32 s59, s58, 43
  s_lshr_b32 s59, s59, 7
  s_mul_i32 s59, s59, 97920
  s_lshl_b32 s57, s58, 7
  s_add_u32 s57, s57, s59
  s_lshl_b32 s58, s58, 10
  s_add_u32 m0, s58, 61440
  s_nop 0
  buffer_load_dwordx4 v6, s[28:31], s57 offen nt lds
  v_mfma_f32_16x16x32_bf16 v[84:87], v[8:11], a[144:147], 0
  v_mfma_f32_16x16x32_bf16 v[92:95], v[8:11], a[156:159], 0
  v_mfma_f32_16x16x32_bf16 v[84:87], v[12:15], a[148:151], v[84:87]
  v_mov_b32_dpp v101, v88 quad_perm:[0,0,0,0] row_mask:0xf bank_mask:0xf
  v_mov_b32_dpp v20, v96 quad_perm:[0,0,0,0] row_mask:0xf bank_mask:0xf
  v_mfma_f32_16x16x32_bf16 v[92:95], v[12:15], a[160:163], v[92:95]
  v_add_f32_dpp v101, v89, v101 quad_perm:[1,1,1,1] row_mask:0xf bank_mask:0xf
  v_add_f32_dpp v20, v97, v20 quad_perm:[1,1,1,1] row_mask:0xf bank_mask:0xf
  v_mfma_f32_16x16x32_bf16 v[84:87], v[16:19], a[152:155], v[84:87]
  v_add_f32_dpp v101, v90, v101 quad_perm:[2,2,2,2] row_mask:0xf bank_mask:0xf
  v_add_f32_dpp v20, v98, v20 quad_perm:[2,2,2,2] row_mask:0xf bank_mask:0xf
  v_mfma_f32_16x16x32_bf16 v[92:95], v[16:19], a[164:167], v[92:95]
  v_add_f32_dpp v101, v91, v101 quad_perm:[3,3,3,3] row_mask:0xf bank_mask:0xf
  s_nop 1
  v_add_f32_dpp v101, v99, v20 quad_perm:[3,3,3,3] row_mask:0xc bank_mask:0xf
  s_waitcnt vmcnt(6)
  s_add_u32 s58, s56, 4
  s_mul_i32 s59, s58, 43
  s_lshr_b32 s59, s59, 7
  s_mul_i32 s59, s59, 97920
  s_lshl_b32 s57, s58, 7
  s_add_u32 s57, s57, s59
  s_lshl_b32 s58, s58, 10
  s_add_u32 m0, s58, 61440
  s_nop 0
  buffer_load_dwordx4 v6, s[28:31], s57 offen nt lds
  v_mfma_f32_16x16x32_bf16 v[88:91], v[8:11], a[168:171], 0
  v_mfma_f32_16x16x32_bf16 v[96:99], v[8:11], a[180:183], 0
  v_mfma_f32_16x16x32_bf16 v[88:91], v[12:15], a[172:175], v[88:91]
  v_mov_b32_dpp v102, v84 quad_perm:[0,0,0,0] row_mask:0xf bank_mask:0xf
  v_mov_b32_dpp v20, v92 quad_perm:[0,0,0,0] row_mask:0xf bank_mask:0xf
  v_mfma_f32_16x16x32_bf16 v[96:99], v[12:15], a[184:187], v[96:99]
  v_add_f32_dpp v102, v85, v102 quad_perm:[1,1,1,1] row_mask:0xf bank_mask:0xf
  v_add_f32_dpp v20, v93, v20 quad_perm:[1,1,1,1] row_mask:0xf bank_mask:0xf
  v_mfma_f32_16x16x32_bf16 v[88:91], v[16:19], a[176:179], v[88:91]
  v_add_f32_dpp v102, v86, v102 quad_perm:[2,2,2,2] row_mask:0xf bank_mask:0xf
  v_add_f32_dpp v20, v94, v20 quad_perm:[2,2,2,2] row_mask:0xf bank_mask:0xf
  v_mfma_f32_16x16x32_bf16 v[96:99], v[16:19], a[188:191], v[96:99]
  v_add_f32_dpp v102, v87, v102 quad_perm:[3,3,3,3] row_mask:0xf bank_mask:0xf
  s_nop 1
  v_add_f32_dpp v102, v95, v20 quad_perm:[3,3,3,3] row_mask:0xc bank_mask:0xf
  s_waitcnt vmcnt(6)
  s_add_u32 s58, s56, 8
  s_mul_i32 s59, s58, 43
  s_lshr_b32 s59, s59, 7
  s_mul_i32 s59, s59, 97920
  s_lshl_b32 s57, s58, 7
  s_add_u32 s57, s57, s59
  s_lshl_b32 s58, s58, 10
  s_add_u32 m0, s58, 61440
  s_nop 0
  buffer_load_dwordx4 v6, s[28:31], s57 offen nt lds
  v_mov_b32_dpp v103, v88 quad_perm:[0,0,0,0] row_mask:0xf bank_mask:0xf
  v_mov_b32_dpp v20, v96 quad_perm:[0,0,0,0] row_mask:0xf bank_mask:0xf
  s_nop 0
  v_add_f32_dpp v103, v89, v103 quad_perm:[1,1,1,1] row_mask:0xf bank_mask:0xf
  v_add_f32_dpp v20, v97, v20 quad_perm:[1,1,1,1] row_mask:0xf bank_mask:0xf
  s_nop 0
  v_add_f32_dpp v103, v90, v103 quad_perm:[2,2,2,2] row_mask:0xf bank_mask:0xf
  v_add_f32_dpp v20, v98, v20 quad_perm:[2,2,2,2] row_mask:0xf bank_mask:0xf
  s_nop 0
  v_add_f32_dpp v103, v91, v103 quad_perm:[3,3,3,3] row_mask:0xf bank_mask:0xf
  s_nop 1
  v_add_f32_dpp v103, v99, v20 quad_perm:[3,3,3,3] row_mask:0xc bank_mask:0xf
  v_max_f32 v20, v80, v81
  v_max3_f32 v20, v20, v82, v83
  v_max3_f32 v20, v20, v100, v101
  v_max3_f32 v20, v20, v102, v103
  s_nop 1
  v_max_f32_dpp v20, v20, v20 row_ror:4 row_mask:0xf bank_mask:0xf
  s_nop 1
  v_max_f32_dpp v20, v20, v20 row_ror:8 row_mask:0xf bank_mask:0xf
  s_nop 1
  v_max_f32_dpp v20, v20, v20 row_bcast:15 row_mask:0xa bank_mask:0xf
  s_nop 1
  v_max_f32_dpp v20, v20, v20 row_bcast:31 row_mask:0xc bank_mask:0xf
  s_nop 0
  v_readlane_b32 s58, v20, 63
  s_nop 1
  v_mul_f32_e64 v20, -s58, v22
  v_fma_f32 v80, v80, v22, v20
  v_fma_f32 v81, v81, v22, v20
  v_fma_f32 v82, v82, v22, v20
  v_fma_f32 v83, v83, v22, v20
  v_fma_f32 v100, v100, v22, v20
  v_fma_f32 v101, v101, v22, v20
  v_fma_f32 v102, v102, v22, v20
  v_fma_f32 v103, v103, v22, v20
  v_exp_f32 v80, v80
  v_exp_f32 v81, v81
  v_exp_f32 v82, v82
  v_exp_f32 v83, v83
  v_exp_f32 v100, v100
  v_exp_f32 v101, v101
  v_exp_f32 v102, v102
  v_exp_f32 v103, v103
  v_add_f32 v21, v80, v81
  v_add_f32 v21, v21, v82
  v_add_f32 v21, v21, v83
  v_add_f32 v21, v21, v100
  v_add_f32 v21, v21, v101
  v_add_f32 v21, v21, v102
  v_add_f32 v21, v21, v103
  v_cvt_pk_bf16_f32 v80, v80, v80
  v_cvt_pk_bf16_f32 v81, v81, v81
  v_cvt_pk_bf16_f32 v82, v82, v82
  v_cvt_pk_bf16_f32 v83, v83, v83
  v_cvt_pk_bf16_f32 v100, v100, v100
  v_cvt_pk_bf16_f32 v101, v101, v101
  v_cvt_pk_bf16_f32 v102, v102, v102
  v_cvt_pk_bf16_f32 v103, v103, v103
  s_waitcnt vmcnt(6)
  s_add_u32 s58, s56, 12
  s_mul_i32 s59, s58, 43
  s_lshr_b32 s59, s59, 7
  s_mul_i32 s59, s59, 97920
  s_lshl_b32 s57, s58, 7
  s_add_u32 s57, s57, s59
  s_lshl_b32 s58, s58, 10
  s_add_u32 m0, s58, 61440
  s_nop 0
  buffer_load_dwordx4 v6, s[28:31], s57 offen nt lds
  v_and_b32 v22, 16, v5
  v_mov_b32 v23, 0xffff
  v_lshlrev_b32 v22, v22, v23
  v_bfe_u32 v23, v5, 5, 2
  v_cmp_eq_u32 vcc, 0, v23
  s_nop 1
  v_cndmask_b32 v8, 0, v22, vcc
  v_cmp_eq_u32 vcc, 1, v23
  s_nop 1
  v_cndmask_b32 v9, 0, v22, vcc
  v_cmp_eq_u32 vcc, 2, v23
  s_nop 1
  v_cndmask_b32 v10, 0, v22, vcc
  v_cmp_eq_u32 vcc, 3, v23
  s_nop 1
  v_cndmask_b32 v11, 0, v22, vcc
  v_bfe_u32 v12, v5, 7, 2
  v_lshlrev_b32 v12, 4, v12
  v_lshrrev_b32 v13, 9, v5
  v_lshl_add_u32 v12, v13, 3, v12
  v_bfe_u32 v13, v5, 4, 3
  v_add_lshl_u32 v12, v12, v13, 2
  s_mul_i32 s58, s56, 768
  s_add_u32 s58, s58, 159744
  v_add_u32 v12, s58, v12
  v_lshrrev_b32 v14, 8, v5
  v_bfe_u32 v13, v5, 4, 2
  v_lshl_add_u32 v14, v14, 2, v13
  v_bfe_u32 v13, v5, 7, 1
  v_lshl_add_u32 v14, v14, 1, v13
  v_lshlrev_b32 v14, 7, v14
  v_bfe_u32 v13, v5, 6, 1
  v_lshl_add_u32 v14, v13, 3, v14
  v_add_u32 v13, s71, v5
  s_lshl_b32 s58, s56, 3
  s_add_u32 s58, s58, 162816
  v_mov_b32 v15, s58
  v_and_b32 v16, v80, v8
  v_and_b32 v17, v80, v9
  v_and_b32_dpp v18, v80, v10 row_shr:4 row_mask:0xf bank_mask:0xf bound_ctrl:0
  v_and_b32_dpp v19, v80, v11 row_shr:4 row_mask:0xf bank_mask:0xf bound_ctrl:0
  ds_read_b128 v[84:87], v13 offset:0
  ds_read_b128 v[88:91], v13 offset:1024
  ds_read_b128 v[92:95], v13 offset:2048
  s_waitcnt lgkmcnt(0)
  ds_read_b128 v[96:99], v13 offset:3072
  ds_read_b128 v[104:107], v13 offset:4096
  ds_read_b128 v[108:111], v13 offset:5120
  v_mfma_f32_16x16x32_bf16 v[112:115], v[84:87], v[16:19], 0
  v_and_b32 v86, v80, v10
  v_and_b32 v87, v80, v11
  v_mfma_f32_16x16x32_bf16 v[116:119], v[88:91], v[16:19], 0
  v_and_b32_dpp v84, v80, v8 row_shl:4 row_mask:0xf bank_mask:0xf bound_ctrl:0
  v_and_b32_dpp v85, v80, v9 row_shl:4 row_mask:0xf bank_mask:0xf bound_ctrl:0
  v_add_f32_dpp v21, v21, v21 row_ror:4 row_mask:0xf bank_mask:0xf
  v_mfma_f32_16x16x32_bf16 v[88:91], v[92:95], v[16:19], 0
  s_nop 0
  v_add_f32_dpp v21, v21, v21 row_ror:8 row_mask:0xf bank_mask:0xf
  s_waitcnt vmcnt(6)
  s_add_u32 s58, s56, 16
  s_mul_i32 s59, s58, 43
  s_lshr_b32 s59, s59, 7
  s_mul_i32 s59, s59, 97920
  s_lshl_b32 s57, s58, 7
  s_add_u32 s57, s57, s59
  s_lshl_b32 s58, s58, 10
  s_add_u32 m0, s58, 61440
  s_nop 0
  buffer_load_dwordx4 v6, s[28:31], s57 offen nt lds
  s_waitcnt lgkmcnt(0)
  ds_read_b128 v[16:19], v13 offset:6144
  ds_read_b128 v[92:95], v13 offset:7168
  ds_read_b128 v[120:123], v13 offset:8192
  v_mfma_f32_16x16x32_bf16 v[112:115], v[96:99], v[84:87], v[112:115]
  v_and_b32 v96, v81, v8
  v_and_b32 v97, v81, v9
  v_mfma_f32_16x16x32_bf16 v[116:119], v[104:107], v[84:87], v[116:119]
  v_and_b32_dpp v98, v81, v10 row_shr:4 row_mask:0xf bank_mask:0xf bound_ctrl:0
  v_and_b32_dpp v99, v81, v11 row_shr:4 row_mask:0xf bank_mask:0xf bound_ctrl:0
  v_add_f32_dpp v21, v21, v21 row_bcast:15 row_mask:0xa bank_mask:0xf
  v_mfma_f32_16x16x32_bf16 v[88:91], v[108:111], v[84:87], v[88:91]
  s_nop 0
  v_add_f32_dpp v21, v21, v21 row_bcast:31 row_mask:0xc bank_mask:0xf
  s_waitcnt vmcnt(6)
  s_add_u32 s58, s56, 20
  s_mul_i32 s59, s58, 43
  s_lshr_b32 s59, s59, 7
  s_mul_i32 s59, s59, 97920
  s_lshl_b32 s57, s58, 7
  s_add_u32 s57, s57, s59
  s_lshl_b32 s58, s58, 10
  s_add_u32 m0, s58, 61440
  s_nop 0
  buffer_load_dwordx4 v6, s[28:31], s57 offen nt lds
  s_waitcnt lgkmcnt(0)
  v_mfma_f32_16x16x32_bf16 v[112:115], v[16:19], v[96:99], v[112:115]
  v_and_b32 v18, v81, v10
  v_and_b32 v19, v81, v11
  v_mfma_f32_16x16x32_bf16 v[116:119], v[92:95], v[96:99], v[116:119]
  v_and_b32_dpp v16, v81, v8 row_shl:4 row_mask:0xf bank_mask:0xf bound_ctrl:0
  v_and_b32_dpp v17, v81, v9 row_shl:4 row_mask:0xf bank_mask:0xf bound_ctrl:0
  v_mfma_f32_16x16x32_bf16 v[88:91], v[120:123], v[96:99], v[88:91]
  s_mov_b32 exec_lo, 0x0
  s_mov_b32 exec_hi, 0x80000000
  ds_write_b64 v15, v[20:21]
  s_mov_b64 exec, -1
  s_waitcnt vmcnt(6)
  s_add_u32 s58, s56, 24
  s_mul_i32 s59, s58, 43
  s_lshr_b32 s59, s59, 7
  s_mul_i32 s59, s59, 97920
  s_lshl_b32 s57, s58, 7
  s_add_u32 s57, s57, s59
  s_lshl_b32 s58, s58, 10
  s_add_u32 m0, s58, 61440
  s_nop 0
  buffer_load_dwordx4 v6, s[28:31], s57 offen nt lds
  v_mfma_f32_16x16x32_bf16 v[112:115], a[192:195], v[16:19], v[112:115]
  v_and_b32 v20, v82, v8
  v_and_b32 v21, v82, v9
  v_mfma_f32_16x16x32_bf16 v[116:119], a[196:199], v[16:19], v[116:119]
  v_and_b32_dpp v22, v82, v10 row_shr:4 row_mask:0xf bank_mask:0xf bound_ctrl:0
  v_and_b32_dpp v23, v82, v11 row_shr:4 row_mask:0xf bank_mask:0xf bound_ctrl:0
  v_mfma_f32_16x16x32_bf16 v[88:91], a[200:203], v[16:19], v[88:91]
  s_waitcnt vmcnt(6)
  s_add_u32 s58, s56, 28
  s_min_u32 s58, s58, 29
  s_mul_i32 s59, s58, 43
  s_lshr_b32 s59, s59, 7
  s_mul_i32 s59, s59, 97920
  s_lshl_b32 s57, s58, 7
  s_add_u32 s57, s57, s59
  s_lshl_b32 s58, s58, 10
  s_add_u32 m0, s58, 61440
  s_nop 0
  buffer_load_dwordx4 v6, s[28:31], s57 offen nt lds
  v_mfma_f32_16x16x32_bf16 v[112:115], a[204:207], v[20:23], v[112:115]
  v_and_b32 v18, v82, v10
  v_and_b32 v19, v82, v11
  v_mfma_f32_16x16x32_bf16 v[116:119], a[208:211], v[20:23], v[116:119]
  v_and_b32_dpp v16, v82, v8 row_shl:4 row_mask:0xf bank_mask:0xf bound_ctrl:0
  v_and_b32_dpp v17, v82, v9 row_shl:4 row_mask:0xf bank_mask:0xf bound_ctrl:0
  v_mfma_f32_16x16x32_bf16 v[88:91], a[212:215], v[20:23], v[88:91]
  s_waitcnt vmcnt(6)
  s_mov_b32 s57, 0x0
  buffer_load_dwordx4 v[20:23], v4, s[12:15], s57 offen offset:0 nt
  v_mfma_f32_16x16x32_bf16 v[112:115], a[216:219], v[16:19], v[112:115]
  v_and_b32 v84, v83, v8
  v_and_b32 v85, v83, v9
  v_mfma_f32_16x16x32_bf16 v[116:119], a[220:223], v[16:19], v[116:119]
  v_and_b32_dpp v86, v83, v10 row_shr:4 row_mask:0xf bank_mask:0xf bound_ctrl:0
  v_and_b32_dpp v87, v83, v11 row_shr:4 row_mask:0xf bank_mask:0xf bound_ctrl:0
  v_mfma_f32_16x16x32_bf16 v[88:91], a[224:227], v[16:19], v[88:91]
  s_waitcnt vmcnt(6)
  buffer_load_dwordx4 v[16:19], v4, s[12:15], s57 offen offset:128 nt
  v_mfma_f32_16x16x32_bf16 v[112:115], a[228:231], v[84:87], v[112:115]
  v_and_b32 v94, v83, v10
  v_and_b32 v95, v83, v11
  v_mfma_f32_16x16x32_bf16 v[116:119], a[232:235], v[84:87], v[116:119]
  v_and_b32_dpp v92, v83, v8 row_shl:4 row_mask:0xf bank_mask:0xf bound_ctrl:0
  v_and_b32_dpp v93, v83, v9 row_shl:4 row_mask:0xf bank_mask:0xf bound_ctrl:0
  v_mfma_f32_16x16x32_bf16 v[88:91], a[236:239], v[84:87], v[88:91]
  s_waitcnt vmcnt(6)
  buffer_load_dwordx4 v[80:83], v4, s[12:15], s57 offen offset:256 nt
  v_mfma_f32_16x16x32_bf16 v[112:115], a[240:243], v[92:95], v[112:115]
  v_and_b32 v84, v100, v8
  v_and_b32 v85, v100, v9
  v_mfma_f32_16x16x32_bf16 v[116:119], a[244:247], v[92:95], v[116:119]
  v_and_b32_dpp v86, v100, v10 row_shr:4 row_mask:0xf bank_mask:0xf bound_ctrl:0
  v_and_b32_dpp v87, v100, v11 row_shr:4 row_mask:0xf bank_mask:0xf bound_ctrl:0
  v_mfma_f32_16x16x32_bf16 v[88:91], a[248:251], v[92:95], v[88:91]
  s_waitcnt vmcnt(6)
  buffer_load_dwordx4 v[92:95], v4, s[12:15], s57 offen offset:3072 nt
  v_mfma_f32_16x16x32_bf16 v[112:115], a[252:255], v[84:87], v[112:115]
  v_and_b32 v98, v100, v10
  v_and_b32 v99, v100, v11
  v_mfma_f32_16x16x32_bf16 v[116:119], v[24:27], v[84:87], v[116:119]
  v_and_b32_dpp v96, v100, v8 row_shl:4 row_mask:0xf bank_mask:0xf bound_ctrl:0
  v_and_b32_dpp v97, v100, v9 row_shl:4 row_mask:0xf bank_mask:0xf bound_ctrl:0
  v_mfma_f32_16x16x32_bf16 v[88:91], v[28:31], v[84:87], v[88:91]
  s_waitcnt vmcnt(6)
  buffer_load_dwordx4 v[84:87], v4, s[12:15], s57 offen offset:3200 nt
  v_mfma_f32_16x16x32_bf16 v[112:115], v[32:35], v[96:99], v[112:115]
  v_and_b32 v104, v101, v8
  v_and_b32 v105, v101, v9
  v_mfma_f32_16x16x32_bf16 v[116:119], v[36:39], v[96:99], v[116:119]
  v_and_b32_dpp v106, v101, v10 row_shr:4 row_mask:0xf bank_mask:0xf bound_ctrl:0
  v_and_b32_dpp v107, v101, v11 row_shr:4 row_mask:0xf bank_mask:0xf bound_ctrl:0
  v_mfma_f32_16x16x32_bf16 v[88:91], v[40:43], v[96:99], v[88:91]
  s_waitcnt vmcnt(6)
  buffer_load_dwordx4 v[96:99], v4, s[12:15], s57 offen offset:3328 nt
  v_mfma_f32_16x16x32_bf16 v[112:115], v[44:47], v[104:107], v[112:115]
  v_and_b32 v110, v101, v10
  v_and_b32 v111, v101, v11
  v_mfma_f32_16x16x32_bf16 v[116:119], v[48:51], v[104:107], v[116:119]
  v_and_b32_dpp v108, v101, v8 row_shl:4 row_mask:0xf bank_mask:0xf bound_ctrl:0
  v_and_b32_dpp v109, v101, v9 row_shl:4 row_mask:0xf bank_mask:0xf bound_ctrl:0
  v_mfma_f32_16x16x32_bf16 v[88:91], v[52:55], v[104:107], v[88:91]
  s_waitcnt vmcnt(6)
  s_mov_b32 s57, 0x1800
  buffer_load_dwordx4 v[104:107], v4, s[12:15], s57 offen offset:0 nt
  v_mfma_f32_16x16x32_bf16 v[112:115], v[56:59], v[108:111], v[112:115]
  v_and_b32 v120, v102, v8
  v_and_b32 v121, v102, v9
  v_mfma_f32_16x16x32_bf16 v[116:119], v[68:71], v[108:111], v[116:119]
  v_and_b32_dpp v122, v102, v10 row_shr:4 row_mask:0xf bank_mask:0xf bound_ctrl:0
  v_and_b32_dpp v123, v102, v11 row_shr:4 row_mask:0xf bank_mask:0xf bound_ctrl:0
  v_mfma_f32_16x16x32_bf16 v[88:91], v[60:63], v[108:111], v[88:91]
  s_waitcnt vmcnt(6)
  buffer_load_dwordx4 v[108:111], v4, s[12:15], s57 offen offset:128 nt
  v_mfma_f32_16x16x32_bf16 v[112:115], v[72:75], v[120:123], v[112:115]
  v_and_b32 v126, v102, v10
  v_and_b32 v127, v102, v11
  v_mfma_f32_16x16x32_bf16 v[116:119], v[64:67], v[120:123], v[116:119]
  v_and_b32_dpp v124, v102, v8 row_shl:4 row_mask:0xf bank_mask:0xf bound_ctrl:0
  v_and_b32_dpp v125, v102, v9 row_shl:4 row_mask:0xf bank_mask:0xf bound_ctrl:0
  v_mfma_f32_16x16x32_bf16 v[88:91], v[76:79], v[120:123], v[88:91]
  s_waitcnt vmcnt(6)
  buffer_load_dwordx4 v[120:123], v4, s[12:15], s57 offen offset:256 nt
  s_waitcnt vmcnt(6)
  buffer_load_dwordx4 v[128:131], v4, s[12:15], s57 offen offset:3072 nt
  s_waitcnt vmcnt(6)
  buffer_load_dwordx4 v[132:135], v4, s[12:15], s57 offen offset:3200 nt
  s_waitcnt vmcnt(6)
  buffer_load_dwordx4 v[136:139], v4, s[12:15], s57 offen offset:3328 nt
  s_waitcnt vmcnt(6)
  s_mov_b32 s57, 0x0
  buffer_load_dwordx4 v[140:143], v1, s[16:19], s57 offen offset:0 nt
  s_waitcnt vmcnt(6)
  buffer_load_dwordx4 v[144:147], v1, s[16:19], s57 offen offset:128 nt
  s_waitcnt vmcnt(6)
  buffer_load_dwordx4 v[148:151], v1, s[16:19], s57 offen offset:256 nt
  s_waitcnt vmcnt(6)
  buffer_load_dwordx4 v[152:155], v1, s[16:19], s57 offen offset:384 nt
  s_waitcnt vmcnt(6)
  s_mov_b32 s57, 0x9000
  buffer_load_dwordx4 v[156:159], v1, s[8:11], s57 offen offset:384
  s_waitcnt vmcnt(6)
  buffer_load_dwordx4 v[160:163], v1, s[8:11], s57 offen offset:512
  s_waitcnt vmcnt(6)
  buffer_load_dwordx4 v[164:167], v1, s[8:11], s57 offen offset:640
  s_waitcnt vmcnt(6)
  s_mov_b32 s57, 0xa800
  buffer_load_dwordx4 v[168:171], v1, s[8:11], s57 offen offset:0
  s_waitcnt vmcnt(6)
  buffer_load_dwordx4 v[172:175], v1, s[8:11], s57 offen offset:128
  s_waitcnt vmcnt(6)
  buffer_load_dwordx4 v[176:179], v1, s[8:11], s57 offen offset:256
  s_waitcnt vmcnt(6)
  buffer_load_dwordx4 v[180:183], v1, s[8:11], s57 offen offset:384
  s_waitcnt vmcnt(6)
  buffer_load_dwordx4 v[184:187], v1, s[8:11], s57 offen offset:512
  s_waitcnt vmcnt(6)
  buffer_load_dwordx4 v[188:191], v1, s[8:11], s57 offen offset:640
  s_waitcnt vmcnt(6)
  v_mfma_f32_16x16x32_bf16 v[112:115], v[156:159], v[124:127], v[112:115]
  v_and_b32 v156, v103, v8
  v_and_b32 v157, v103, v9
  v_mfma_f32_16x16x32_bf16 v[116:119], v[160:163], v[124:127], v[116:119]
  v_and_b32_dpp v158, v103, v10 row_shr:4 row_mask:0xf bank_mask:0xf bound_ctrl:0
  v_and_b32_dpp v159, v103, v11 row_shr:4 row_mask:0xf bank_mask:0xf bound_ctrl:0
  v_mfma_f32_16x16x32_bf16 v[88:91], v[164:167], v[124:127], v[88:91]
  s_waitcnt vmcnt(3)
  v_mfma_f32_16x16x32_bf16 v[112:115], v[168:171], v[156:159], v[112:115]
  v_and_b32 v126, v103, v10
  v_and_b32 v127, v103, v11
  v_mfma_f32_16x16x32_bf16 v[116:119], v[172:175], v[156:159], v[116:119]
  v_and_b32_dpp v124, v103, v8 row_shl:4 row_mask:0xf bank_mask:0xf bound_ctrl:0
  v_and_b32_dpp v125, v103, v9 row_shl:4 row_mask:0xf bank_mask:0xf bound_ctrl:0
  v_mfma_f32_16x16x32_bf16 v[88:91], v[176:179], v[156:159], v[88:91]
  s_waitcnt vmcnt(0)
  v_mfma_f32_16x16x32_bf16 v[112:115], v[180:183], v[124:127], v[112:115]
  v_mfma_f32_16x16x32_bf16 v[116:119], v[184:187], v[124:127], v[116:119]
  v_mfma_f32_16x16x32_bf16 v[88:91], v[188:191], v[124:127], v[88:91]
  v_mov_b32 v8, 162816
  v_add_u32 v9, 159744, v5
  s_add_u32 s73, s64, 0
  s_nop 2
  v_permlane32_swap_b32 v112, v113
  v_permlane32_swap_b32 v114, v115
  v_permlane32_swap_b32 v116, v117
  v_permlane32_swap_b32 v118, v119
  v_permlane32_swap_b32 v88, v89
  v_permlane32_swap_b32 v90, v91
  v_add_f32_dpp v100, v113, v112 row_shl:8 row_mask:0xf bank_mask:0x3
  v_add_f32_dpp v101, v117, v116 row_shl:8 row_mask:0xf bank_mask:0x3
  v_add_f32_dpp v102, v89, v88 row_shl:8 row_mask:0xf bank_mask:0x3
  v_add_f32_dpp v100, v114, v115 row_shr:8 row_mask:0xf bank_mask:0xc
  v_add_f32_dpp v101, v118, v119 row_shr:8 row_mask:0xf bank_mask:0xc
  v_add_f32_dpp v102, v90, v91 row_shr:8 row_mask:0xf bank_mask:0xc
  ds_write_b32 v12, v100 offset:0
  ds_write_b32 v12, v101 offset:256
  ds_write_b32 v12, v102 offset:512
  s_waitcnt lgkmcnt(0)
  s_barrier
  s_cmp_eq_u32 s56, 3
  s_cbranch_scc0 L_w_32
  ds_read_b128 v[88:91], v8
  ds_read_b128 v[100:103], v8 offset:16
  ds_read_b128 v[112:115], v9 offset:0
  ds_read_b128 v[116:119], v9 offset:768
  ds_read_b128 v[124:127], v9 offset:1536
  ds_read_b128 v[156:159], v9 offset:2304
  s_mov_b32 vcc_lo, 0
  s_mov_b32 vcc_hi, 0xffff0000
  s_mov_b32 exec_hi, 0x1ffff
  s_waitcnt lgkmcnt(4)
  v_min3_f32 v8, v88, v90, v100
  v_min_f32 v8, v8, v102
  v_sub_f32 v88, v8, v88
  v_sub_f32 v90, v8, v90
  v_sub_f32 v100, v8, v100
  v_sub_f32 v102, v8, v102
  v_exp_f32 v88, v88
  v_exp_f32 v90, v90
  v_exp_f32 v100, v100
  v_exp_f32 v102, v102
  s_waitcnt lgkmcnt(0)
  v_pk_mul_f32 v[112:113], v[112:113], v[88:89] op_sel_hi:[1,0]
  v_pk_mul_f32 v[114:115], v[114:115], v[88:89] op_sel_hi:[1,0]
  v_mul_f32 v89, v88, v89
  v_pk_mul_f32 v[124:125], v[124:125], v[100:101] op_sel_hi:[1,0]
  v_pk_mul_f32 v[126:127], v[126:127], v[100:101] op_sel_hi:[1,0]
  v_mul_f32 v101, v100, v101
  v_pk_fma_f32 v[112:113], v[116:117], v[90:91], v[112:113] op_sel_hi:[1,0,1]
  v_pk_fma_f32 v[114:115], v[118:119], v[90:91], v[114:115] op_sel_hi:[1,0,1]
  v_fmac_f32 v89, v90, v91
  v_pk_fma_f32 v[124:125], v[156:157], v[102:103], v[124:125] op_sel_hi:[1,0,1]
  v_pk_fma_f32 v[126:127], v[158:159], v[102:103], v[126:127] op_sel_hi:[1,0,1]
  v_fmac_f32 v101, v102, v103
  v_pk_add_f32 v[112:113], v[112:113], v[124:125]
  v_pk_add_f32 v[114:115], v[114:115], v[126:127]
  v_add_f32 v9, v89, v101
  v_cvt_pk_bf16_f32 v116, v112, v113
  v_cvt_pk_bf16_f32 v117, v114, v115
  v_cndmask_b32 v116, v116, v8, vcc
  v_cndmask_b32 v117, v117, v9, vcc
  s_cmp_eq_u32 s75, 0
  s_cbranch_scc1 L_slow_33
  buffer_store_dwordx2 v[116:117], v14, s[36:39], s73 offen
  s_branch L_pub_34
L_slow_33:
  buffer_store_dwordx2 v[116:117], v14, s[36:39], s73 offen sc1
L_pub_34:
  s_mov_b64 exec, -1
L_w_32:
  v_and_b32 v8, 0x70, v5
  s_sleep 3
  v_lshrrev_b32 v9, 8, v5
  v_bfe_u32 v10, v5, 7, 1
  v_mul_u32_u24 v10, 192, v10
  v_lshl_add_u32 v9, v9, 4, v10
  v_lshrrev_b32 v10, 6, v5
  v_mul_u32_u24 v10, 160, v10
  v_bfe_u32 v11, v5, 4, 2
  v_lshl_add_u32 v10, v11, 3, v10
  s_lshl_b32 s58, s56, 5
  s_add_u32 s58, s58, 30720
  v_add_u32 v10, s58, v10
  s_cmp_lt_u32 s56, 3
  s_cbranch_scc0 L_w_35
  ds_read_b64_tr_b16 v[12:13], v10 offset:0
  ds_read_b64_tr_b16 v[14:15], v10 offset:2560
  ds_read_b64_tr_b16 v[88:89], v10 offset:5120
  ds_read_b64_tr_b16 v[90:91], v10 offset:7680
  ds_read_b64_tr_b16 v[100:101], v10 offset:10240
  ds_read_b64_tr_b16 v[102:103], v10 offset:12800
  ds_read_b64_tr_b16 v[112:113], v10 offset:15360
  ds_read_b64_tr_b16 v[114:115], v10 offset:17920
  ds_read_b64_tr_b16 v[116:117], v10 offset:20480
  ds_read_b64_tr_b16 v[118:119], v10 offset:23040
  ds_read_b64_tr_b16 v[124:125], v10 offset:25600
  ds_read_b64_tr_b16 v[126:127], v10 offset:28160
  ds_read_b64_tr_b16 v[156:157], v10 offset:96
  ds_read_b64_tr_b16 v[158:159], v10 offset:2656
  ds_read_b64_tr_b16 v[160:161], v10 offset:5216
  ds_read_b64_tr_b16 v[162:163], v10 offset:7776
  ds_read_b64_tr_b16 v[164:165], v10 offset:10336
  ds_read_b64_tr_b16 v[166:167], v10 offset:12896
  ds_read_b64_tr_b16 v[168:169], v10 offset:15456
  ds_read_b64_tr_b16 v[170:171], v10 offset:18016
  ds_read_b64_tr_b16 v[172:173], v10 offset:20576
  ds_read_b64_tr_b16 v[174:175], v10 offset:23136
  ds_read_b64_tr_b16 v[176:177], v10 offset:25696
  ds_read_b64_tr_b16 v[178:179], v10 offset:28256
L_w_35:
  s_lshl_b32 s58, s56, 6
  s_add_u32 s74, s66, s58
  s_add_u32 s74, s74, 0
  s_cmp_lt_u32 s56, 3
  s_cbranch_scc0 L_w_36
  s_mov_b32 s72, 0
L_poll_37:
  s_add_u32 s73, s65, 0
  buffer_load_dwordx2 v[180:181], v8, s[36:39], s73 offen offset:3072 sc1
  buffer_load_dwordx4 v[184:187], v5, s[36:39], s73 offen offset:0 sc1
  buffer_load_dwordx4 v[188:191], v5, s[36:39], s73 offen offset:1024 sc1
  buffer_load_dwordx4 v[192:195], v5, s[36:39], s73 offen offset:2048 sc1
  s_add_u32 s72, s72, 1
  s_cmp_lt_u32 s72, 65536
  s_cselect_b64 s[60:61], -1, 0
  s_waitcnt vmcnt(0)
  v_max3_u32 v182, v180, v181, v184
  v_max3_u32 v183, v185, v186, v187
  v_max3_u32 v182, v182, v188, v189
  v_max3_u32 v183, v183, v190, v191
  v_max3_u32 v182, v182, v192, v193
  v_max3_u32 v183, v183, v194, v195
  v_max_u32 v182, v182, v183
  v_cmp_eq_u32 vcc, -1, v182
  s_and_b64 vcc, vcc, s[60:61]
  s_cbranch_vccnz L_poll_37
  s_waitcnt lgkmcnt(0)
  v_mfma_f32_16x16x32_bf16 v[196:199], v[12:15], v[184:187], 0
  v_min_f32_dpp v182, v180, v180 quad_perm:[1,0,3,2] row_mask:0xf bank_mask:0xf
  v_mfma_f32_16x16x32_bf16 v[12:15], v[88:91], v[184:187], 0
  s_nop 0
  v_min_f32_dpp v182, v182, v182 quad_perm:[2,3,0,1] row_mask:0xf bank_mask:0xf
  v_mfma_f32_16x16x32_bf16 v[196:199], v[100:103], v[188:191], v[196:199]
  s_nop 0
  v_min_f32_dpp v182, v182, v182 row_half_mirror row_mask:0xf bank_mask:0xf
  v_mfma_f32_16x16x32_bf16 v[12:15], v[112:115], v[188:191], v[12:15]
  v_sub_f32 v180, v182, v180
  v_exp_f32 v180, v180
  v_mfma_f32_16x16x32_bf16 v[196:199], v[116:119], v[192:195], v[196:199]
  v_mul_f32 v181, v180, v181
  v_mfma_f32_16x16x32_bf16 v[12:15], v[124:127], v[192:195], v[12:15]
  s_nop 0
  v_add_f32_dpp v181, v181, v181 quad_perm:[1,0,3,2] row_mask:0xf bank_mask:0xf
  v_mfma_f32_16x16x32_bf16 v[88:91], v[156:159], v[184:187], 0
  s_nop 0
  v_add_f32_dpp v181, v181, v181 quad_perm:[2,3,0,1] row_mask:0xf bank_mask:0xf
  v_mfma_f32_16x16x32_bf16 v[100:103], v[160:163], v[184:187], 0
  s_nop 0
  v_add_f32_dpp v181, v181, v181 row_half_mirror row_mask:0xf bank_mask:0xf
  v_mfma_f32_16x16x32_bf16 v[88:91], v[164:167], v[188:191], v[88:91]
  v_rcp_f32 v181, v181
  s_nop 0
  v_mul_f32 v180, v180, v181
  v_mfma_f32_16x16x32_bf16 v[100:103], v[168:171], v[188:191], v[100:103]
  v_add_f32_dpp v112, v12, v196 row_shl:8 row_mask:0xf bank_mask:0x3
  v_add_f32_dpp v113, v13, v197 row_shl:8 row_mask:0xf bank_mask:0x3
  v_mfma_f32_16x16x32_bf16 v[88:91], v[172:175], v[192:195], v[88:91]
  v_add_f32_dpp v114, v14, v198 row_shl:8 row_mask:0xf bank_mask:0x3
  v_add_f32_dpp v115, v15, v199 row_shl:8 row_mask:0xf bank_mask:0x3
  v_mfma_f32_16x16x32_bf16 v[100:103], v[176:179], v[192:195], v[100:103]
  s_cmp_lt_u32 s56, 2
  s_mov_b32 s58, 0x00010001
  s_cselect_b32 s58, 0x01010101, s58
  s_nop 4
  v_add_f32_dpp v112, v88, v100 row_shr:8 row_mask:0xf bank_mask:0xc
  v_add_f32_dpp v113, v89, v101 row_shr:8 row_mask:0xf bank_mask:0xc
  v_add_f32_dpp v114, v90, v102 row_shr:8 row_mask:0xf bank_mask:0xc
  v_add_f32_dpp v115, v91, v103 row_shr:8 row_mask:0xf bank_mask:0xc
  v_mul_f32 v112, v180, v112
  v_mul_f32 v113, v180, v113
  v_mul_f32 v114, v180, v114
  v_mul_f32 v115, v180, v115
  v_add_f32_dpp v112, v112, v112 quad_perm:[1,0,3,2] row_mask:0xf bank_mask:0xf
  v_add_f32_dpp v113, v113, v113 quad_perm:[1,0,3,2] row_mask:0xf bank_mask:0xf
  v_add_f32_dpp v114, v114, v114 quad_perm:[1,0,3,2] row_mask:0xf bank_mask:0xf
  v_add_f32_dpp v115, v115, v115 quad_perm:[1,0,3,2] row_mask:0xf bank_mask:0xf
  v_add_f32_dpp v112, v112, v112 quad_perm:[2,3,0,1] row_mask:0xf bank_mask:0xf
  v_add_f32_dpp v113, v113, v113 quad_perm:[2,3,0,1] row_mask:0xf bank_mask:0xf
  v_add_f32_dpp v114, v114, v114 quad_perm:[2,3,0,1] row_mask:0xf bank_mask:0xf
  v_add_f32_dpp v115, v115, v115 quad_perm:[2,3,0,1] row_mask:0xf bank_mask:0xf
  v_add_f32_dpp v112, v112, v112 row_half_mirror row_mask:0xf bank_mask:0xf
  v_add_f32_dpp v113, v113, v113 row_half_mirror row_mask:0xf bank_mask:0xf
  v_add_f32_dpp v114, v114, v114 row_half_mirror row_mask:0xf bank_mask:0xf
  v_add_f32_dpp v115, v115, v115 row_half_mirror row_mask:0xf bank_mask:0xf
  s_mov_b32 exec_lo, s58
  s_mov_b32 exec_hi, s58
  buffer_store_dwordx4 v[112:115], v9, s[36:39], s74 offen sc1
  s_mov_b64 exec, -1
L_w_36:
  s_barrier
  v_lshlrev_b32 v8, 3, v5
  s_add_u32 s58, s68, 786432
  s_add_u32 s59, s77, 262144
  s_cmp_eq_u32 s56, 1
  s_cselect_b32 s58, s59, s58
  s_add_u32 s59, s68, 802816
  s_cmp_eq_u32 s56, 2
  s_cselect_b32 s58, s59, s58
  s_mov_b32 exec_lo, 0x7f
  s_mov_b32 exec_hi, 0x0
  buffer_load_dword v9, v8, s[36:39], s58 offen sc1
  s_mov_b64 exec, -1
  s_mov_b32 s57, 0x0
  buffer_load_dwordx4 v[12:15], v1, s[16:19], s57 offen offset:512 nt
  buffer_load_dwordx4 v[88:91], v1, s[16:19], s57 offen offset:640 nt
  s_mov_b32 s57, 0x1800
  buffer_load_dwordx4 v[100:103], v1, s[16:19], s57 offen offset:0 nt
  buffer_load_dwordx4 v[112:115], v1, s[16:19], s57 offen offset:128 nt
  buffer_load_dwordx4 v[116:119], v1, s[16:19], s57 offen offset:256 nt
  buffer_load_dwordx4 v[124:127], v1, s[16:19], s57 offen offset:384 nt
  buffer_load_dwordx4 v[156:159], v1, s[16:19], s57 offen offset:512 nt
  buffer_load_dwordx4 v[160:163], v1, s[16:19], s57 offen offset:640 nt
  s_add_u32 s58, s56, 0
  s_mul_i32 s57, s58, 7680
  s_mul_i32 s58, s58, 960
  s_add_u32 m0, s58, 92160
  s_mov_b32 exec_hi, 0x0fffffff
  buffer_load_dwordx4 v7, s[32:35], s57 offen  lds
  s_mov_b32 exec_hi, -1
  s_add_u32 s58, s56, 4
  s_mul_i32 s57, s58, 7680
  s_mul_i32 s58, s58, 960
  s_add_u32 m0, s58, 92160
  s_mov_b32 exec_hi, 0x0fffffff
  buffer_load_dwordx4 v7, s[32:35], s57 offen  lds
  s_mov_b32 exec_hi, -1
  s_add_u32 s58, s56, 8
  s_mul_i32 s57, s58, 7680
  s_mul_i32 s58, s58, 960
  s_add_u32 m0, s58, 92160
  s_mov_b32 exec_hi, 0x0fffffff
  buffer_load_dwordx4 v7, s[32:35], s57 offen  lds
  s_mov_b32 exec_hi, -1
  s_add_u32 s58, s56, 12
  s_mul_i32 s57, s58, 7680
  s_mul_i32 s58, s58, 960
  s_add_u32 m0, s58, 92160
  s_mov_b32 exec_hi, 0x0fffffff
  buffer_load_dwordx4 v7, s[32:35], s57 offen  lds
  s_mov_b32 exec_hi, -1
  s_add_u32 s58, s56, 16
  s_mul_i32 s57, s58, 7680
  s_mul_i32 s58, s58, 960
  s_add_u32 m0, s58, 92160
  s_mov_b32 exec_hi, 0x0fffffff
  buffer_load_dwordx4 v7, s[32:35], s57 offen  lds
  s_mov_b32 exec_hi, -1
  s_add_u32 s58, s56, 20
  s_mul_i32 s57, s58, 7680
  s_mul_i32 s58, s58, 960
  s_add_u32 m0, s58, 92160
  s_mov_b32 exec_hi, 0x0fffffff
  buffer_load_dwordx4 v7, s[32:35], s57 offen  lds
  s_mov_b32 exec_hi, -1
  s_add_u32 s58, s56, 24
  s_mul_i32 s57, s58, 7680
  s_mul_i32 s58, s58, 960
  s_add_u32 m0, s58, 92160
  s_mov_b32 exec_hi, 0x0fffffff
  buffer_load_dwordx4 v7, s[32:35], s57 offen  lds
  s_mov_b32 exec_hi, -1
  s_add_u32 s58, s56, 28
  s_mul_i32 s57, s58, 7680
  s_mul_i32 s58, s58, 960
  s_add_u32 m0, s58, 92160
  s_mov_b32 exec_hi, 0x0fffffff
  buffer_load_dwordx4 v7, s[32:35], s57 offen  lds
  s_mov_b32 exec_hi, -1
  v_bfe_u32 v10, v5, 5, 3
  v_add_u32 v11, -1, v10
  v_and_b32 v11, 3, v11
  v_add_u32 v11, 1, v11
  v_min_u32 v10, v11, v10
  v_lshrrev_b32 v11, 8, v5
  v_lshl_add_u32 v10, v10, 2, v11
  v_mul_u32_u24 v10, 16, v10
  v_add_u32 v10, 159744, v10
  v_and_b32 v11, 0x1f0, v5
  v_lshrrev_b32 v164, 9, v5
  v_lshl_add_u32 v11, v164, 2, v11
  s_mul_i32 s58, s56, 320
  s_add_u32 s58, s58, 159744
  v_add_u32 v11, s58, v11
  v_lshlrev_b32 v164, 16, v2
  v_and_b32 v165, 0xffff0000, v2
  v_lshlrev_b32 v166, 16, v3
  v_and_b32 v167, 0xffff0000, v3
  v_mov_b32 v168, 0
  v_mov_b32 v169, 0
  v_mov_b32 v170, 0
  v_mov_b32 v171, 0
  v_mov_b32 v172, 0
  v_mov_b32 v173, 0
  v_mov_b32 v174, 0
  v_mov_b32 v175, 0
  v_mov_b32 v176, 0
  v_mov_b32 v177, 0
  v_mov_b32 v178, 0
  v_mov_b32 v179, 0
  v_and_b32 v180, 0x30, v5
  v_bfe_u32 v181, v5, 8, 1
  v_lshl_add_u32 v180, v181, 6, v180
  v_add_u32 v180, 162880, v180
  v_mov_b32 v181, 163264
  v_and_b32 v182, 16, v5
  v_mov_b32 v183, 0xffff
  v_lshlrev_b32 v182, v182, v183
  v_bfe_u32 v183, v5, 5, 2
  v_cmp_eq_u32 vcc, 0, v183
  s_nop 1
  v_cndmask_b32 v184, 0, v182, vcc
  v_cmp_eq_u32 vcc, 1, v183
  s_nop 1
  v_cndmask_b32 v185, 0, v182, vcc
  v_cmp_eq_u32 vcc, 2, v183
  s_nop 1
  v_cndmask_b32 v186, 0, v182, vcc
  v_cmp_eq_u32 vcc, 3, v183
  s_nop 1
  v_cndmask_b32 v187, 0, v182, vcc
  v_bfe_u32 v188, v5, 7, 2
  v_lshlrev_b32 v188, 4, v188
  v_lshrrev_b32 v189, 9, v5
  v_lshl_add_u32 v188, v189, 3, v188
  v_bfe_u32 v189, v5, 4, 3
  v_add_lshl_u32 v188, v188, v189, 2
  s_mul_i32 s58, s56, 768
  s_add_u32 s58, s58, 159744
  v_add_u32 v188, s58, v188
  v_lshrrev_b32 v190, 8, v5
  v_bfe_u32 v189, v5, 4, 2
  v_lshl_add_u32 v190, v190, 2, v189
  v_bfe_u32 v189, v5, 7, 1
  v_lshl_add_u32 v190, v190, 1, v189
  v_lshlrev_b32 v190, 7, v190
  v_bfe_u32 v189, v5, 6, 1
  v_lshl_add_u32 v190, v189, 3, v190
  v_add_u32 v189, s71, v5
  s_lshl_b32 s58, s56, 3
  s_add_u32 s58, s58, 162816
  v_mov_b32 v191, s58
  s_mov_b32 exec_lo, 0xfffff
  s_mov_b32 exec_hi, 0xfffff
  s_lshl_b32 s73, s56, 12
  s_add_u32 s73, s73, s67
  s_add_u32 s73, s73, 0
  buffer_load_dwordx4 v[192:195], v5, s[36:39], s73 offen offset:0 sc1
  buffer_load_dwordx4 v[196:199], v5, s[36:39], s73 offen offset:1024 sc1
  buffer_load_dwordx4 v[200:203], v5, s[36:39], s73 offen offset:2048 sc1
  buffer_load_dwordx4 v[204:207], v5, s[36:39], s73 offen offset:3072 sc1
  s_mov_b64 exec, -1
  s_mov_b32 s72, 0
  s_waitcnt vmcnt(0)
L_chk_39:
  s_mov_b32 exec_lo, 0xfffff
  s_mov_b32 exec_hi, 0xfffff
  v_pk_add_f32 v[192:193], v[192:193], v[196:197]
  v_pk_add_f32 v[194:195], v[194:195], v[198:199]
  v_pk_add_f32 v[200:201], v[200:201], v[204:205]
  v_pk_add_f32 v[202:203], v[202:203], v[206:207]
  v_pk_add_f32 v[192:193], v[192:193], v[200:201]
  v_pk_add_f32 v[194:195], v[194:195], v[202:203]
  s_nop 0
  v_permlane32_swap_b32 v192, v193
  v_permlane32_swap_b32 v194, v195
  v_add_f32 v192, v192, v193
  v_add_f32 v194, v194, v195
  v_cmp_u_f32 vcc, v192, v194
  s_cbranch_vccz L_ok_40
  s_add_u32 s72, s72, 1
  s_cmp_ge_u32 s72, 65536
  s_cbranch_scc1 L_ok_40
  s_sleep 1
  s_mov_b32 exec_lo, 0xfffff
  s_mov_b32 exec_hi, 0xfffff
  s_lshl_b32 s73, s56, 12
  s_add_u32 s73, s73, s67
  s_add_u32 s73, s73, 0
  buffer_load_dwordx4 v[192:195], v5, s[36:39], s73 offen offset:0 sc1
  buffer_load_dwordx4 v[196:199], v5, s[36:39], s73 offen offset:1024 sc1
  buffer_load_dwordx4 v[200:203], v5, s[36:39], s73 offen offset:2048 sc1
  buffer_load_dwordx4 v[204:207], v5, s[36:39], s73 offen offset:3072 sc1
  s_waitcnt vmcnt(0)
  s_branch L_chk_39
L_ok_40:
  ds_write2_b32 v11, v192, v194 offset0:0 offset1:2
  s_mov_b64 exec, -1
  s_waitcnt lgkmcnt(0)
  s_barrier
  ds_read_b128 v[192:195], v10 offset:0
  ds_read_b128 v[196:199], v10 offset:320
  ds_read_b128 v[200:203], v10 offset:640
  ds_read_b128 v[204:207], v10 offset:960
  s_mov_b32 exec_lo, 0x55555555
  s_mov_b32 exec_hi, 0x55555555
  s_mov_b32 vcc_lo, 0x44444444
  s_mov_b32 vcc_hi, 0x44444444
  s_waitcnt lgkmcnt(2)
  v_pk_add_f32 v[192:193], v[192:193], v[196:197]
  v_pk_add_f32 v[194:195], v[194:195], v[198:199]
  v_pk_add_f32 v[164:165], v[164:165], v[192:193]
  v_pk_add_f32 v[166:167], v[166:167], v[194:195]
  s_waitcnt lgkmcnt(0)
  v_pk_add_f32 v[200:201], v[200:201], v[204:205]
  v_pk_add_f32 v[202:203], v[202:203], v[206:207]
  v_pk_add_f32 v[164:165], v[164:165], v[200:201]
  v_pk_add_f32 v[166:167], v[166:167], v[202:203]
  v_cvt_pk_bf16_f32 v2, v164, v165
  v_cvt_pk_bf16_f32 v3, v166, v167
  s_mov_b64 exec, -1
  v_lshrrev_b32 v182, 9, v5
  v_mul_u32_u24 v182, 3072, v182
  v_bfe_u32 v183, v5, 6, 3
  v_lshl_add_u32 v182, v183, 7, v182
  v_bfe_u32 v183, v5, 4, 2
  v_lshl_add_u32 v182, v183, 3, v182
  s_max_u32 s58, s56, 1
  s_lshl_b32 s58, s58, 10
  s_add_u32 s58, s58, 0xec00
  v_add_u32 v182, s58, v182
  v_bfe_u32 v183, v5, 7, 2
  v_lshl_add_u32 v8, v183, 5, v182
  v_xor_b32 v9, 32, v8
  v_xor_b32 v10, 64, v8
  v_xor_b32 v11, 96, v8
  ds_read_b64_tr_b16 v[164:165], v8 offset:24576
  ds_read_b64_tr_b16 v[166:167], v9 offset:24576
  ds_read_b64_tr_b16 v[192:193], v10 offset:24576
  ds_read_b64_tr_b16 v[194:195], v11 offset:24576
  ds_read_b64_tr_b16 v[196:197], v8 offset:0
  ds_read_b64_tr_b16 v[200:201], v9 offset:0
  ds_read_b64_tr_b16 v[204:205], v10 offset:0
  ds_read_b64_tr_b16 v[208:209], v11 offset:0
  ds_read_b64_tr_b16 v[198:199], v8 offset:6144
  ds_read_b64_tr_b16 v[202:203], v9 offset:6144
  ds_read_b64_tr_b16 v[206:207], v10 offset:6144
  ds_read_b64_tr_b16 v[210:211], v11 offset:6144
  ds_read_b64_tr_b16 v[212:213], v8 offset:12288
  ds_read_b64_tr_b16 v[216:217], v9 offset:12288
  ds_read_b64_tr_b16 v[220:221], v10 offset:12288
  ds_read_b64_tr_b16 v[224:225], v11 offset:12288
  ds_read_b64_tr_b16 v[214:215], v8 offset:18432
  ds_read_b64_tr_b16 v[218:219], v9 offset:18432
  ds_read_b64_tr_b16 v[222:223], v10 offset:18432
  ds_read_b64_tr_b16 v[226:227], v11 offset:18432
  v_lshrrev_b32 v182, 2, v5
  v_mov_b32 v183, 0x3f803f80
  s_nop 1
  v_cndmask_b32_dpp v8, v2, v183, vcc row_newbcast:8 row_mask:0xf bank_mask:0xf
  v_cndmask_b32_dpp v9, v3, v183, vcc row_newbcast:8 row_mask:0xf bank_mask:0xf
  v_cndmask_b32_dpp v228, v2, v183, vcc row_newbcast:0 row_mask:0xf bank_mask:0xf
  v_cndmask_b32_dpp v229, v3, v183, vcc row_newbcast:0 row_mask:0xf bank_mask:0xf
  v_cndmask_b32_dpp v230, v2, v183, vcc row_newbcast:2 row_mask:0xf bank_mask:0xf
  v_cndmask_b32_dpp v231, v3, v183, vcc row_newbcast:2 row_mask:0xf bank_mask:0xf
  v_cndmask_b32_dpp v232, v2, v183, vcc row_newbcast:4 row_mask:0xf bank_mask:0xf
  v_cndmask_b32_dpp v233, v3, v183, vcc row_newbcast:4 row_mask:0xf bank_mask:0xf
  v_cndmask_b32_dpp v234, v2, v183, vcc row_newbcast:6 row_mask:0xf bank_mask:0xf
  v_cndmask_b32_dpp v235, v3, v183, vcc row_newbcast:6 row_mask:0xf bank_mask:0xf
  s_waitcnt lgkmcnt(0)
  s_cmp_eq_u32 s56, 0
  s_cbranch_scc1 L_q0_41
  v_mfma_f32_16x16x16_bf16 v[236:239], v[8:9], v[164:165], 0
  v_mfma_f32_16x16x16_bf16 v[240:243], v[8:9], v[166:167], 0
  v_mfma_f32_16x16x16_bf16 v[164:167], v[8:9], v[192:193], 0
  v_mfma_f32_16x16x16_bf16 v[244:247], v[8:9], v[194:195], 0
  s_lshl_b32 s58, s56, 8
  s_add_u32 s73, s68, 0xbff00
  s_add_u32 s73, s73, s58
  s_nop 1
  v_mfma_f32_16x16x32_bf16 v[236:239], v[228:231], v[196:199], v[236:239]
  v_mfma_f32_16x16x32_bf16 v[240:243], v[228:231], v[200:203], v[240:243]
  v_mfma_f32_16x16x32_bf16 v[164:167], v[228:231], v[204:207], v[164:167]
  v_mfma_f32_16x16x32_bf16 v[244:247], v[228:231], v[208:211], v[244:247]
  v_mfma_f32_16x16x32_bf16 v[236:239], v[232:235], v[212:215], v[236:239]
  v_mfma_f32_16x16x32_bf16 v[240:243], v[232:235], v[216:219], v[240:243]
  v_mfma_f32_16x16x32_bf16 v[164:167], v[232:235], v[220:223], v[164:167]
  v_mfma_f32_16x16x32_bf16 v[244:247], v[232:235], v[224:227], v[244:247]
  s_add_u32 s74, s73, 16384
  s_nop 4
  v_mov_b32_dpp v236, v240 quad_perm:[0,1,2,3] row_mask:0x2 bank_mask:0xf
  v_mov_b32_dpp v238, v242 quad_perm:[0,1,2,3] row_mask:0x2 bank_mask:0xf
  s_nop 0
  v_mov_b32_dpp v236, v164 quad_perm:[0,1,2,3] row_mask:0x4 bank_mask:0xf
  v_mov_b32_dpp v238, v166 quad_perm:[0,1,2,3] row_mask:0x4 bank_mask:0xf
  s_nop 0
  v_mov_b32_dpp v236, v244 quad_perm:[0,1,2,3] row_mask:0x8 bank_mask:0xf
  v_mov_b32_dpp v238, v246 quad_perm:[0,1,2,3] row_mask:0x8 bank_mask:0xf
  s_cmp_eq_u32 s75, 0
  s_cbranch_scc1 L_slow_43
  buffer_store_dword v236, v182, s[36:39], s73 offen
  buffer_store_dword v238, v182, s[36:39], s74 offen
  s_branch L_pub_44
L_slow_43:
  buffer_store_dword v236, v182, s[36:39], s73 offen sc1
  buffer_store_dword v238, v182, s[36:39], s74 offen sc1
L_pub_44:
  s_branch L_qe_42
L_q0_41:
  v_mfma_f32_16x16x16_bf16 v[236:239], v[8:9], v[8:9], 0
  v_mfma_f32_16x16x32_bf16 v[240:243], v[228:231], v[228:231], 0
  v_mfma_f32_16x16x32_bf16 v[240:243], v[232:235], v[232:235], v[240:243]
  s_add_u32 s73, s68, 786432
  s_mov_b64 exec, 1
  s_nop 5
  v_add_f32 v236, v236, v240
  v_add_f32 v237, v238, v242
  s_cmp_eq_u32 s75, 0
  s_cbranch_scc1 L_slow_45
  buffer_store_dwordx2 v[236:237], v182, s[36:39], s73 offen offset:768
  s_branch L_pub_46
L_slow_45:
  buffer_store_dwordx2 v[236:237], v182, s[36:39], s73 offen offset:768 sc1
L_pub_46:
  s_mov_b64 exec, -1
L_qe_42:
  v_lshrrev_b32 v9, 8, v5
  v_and_b32 v8, 0xf0, v5
  v_lshl_add_u32 v8, v9, 10, v8
  v_bfe_u32 v11, v5, 1, 7
  v_lshl_add_u32 v11, v9, 1, v11
  s_lshl_b32 s58, s56, 7
  s_add_u32 s58, s58, 162880
  v_add_u32 v11, s58, v11
  v_lshlrev_b32 v9, 6, v5
  v_mov_b32 v10, 163264
  v_mov_b32 v182, 0
  v_mov_b32 v183, 0
  s_sleep 2
  s_cmp_lt_u32 s56, 3
  s_cbranch_scc0 L_w_47
  s_mov_b32 s72, 0
L_poll_48:
  s_add_u32 s74, s69, 802816
  s_lshl_b32 s73, s56, 8
  s_add_u32 s73, s73, s74
  s_add_u32 s74, s73, 4096
  buffer_load_dwordx4 v[164:167], v8, s[36:39], s73 offen sc1
  buffer_load_dwordx4 v[192:195], v8, s[36:39], s74 offen sc1
  s_add_u32 s72, s72, 1
  s_cmp_lt_u32 s72, 65536
  s_cselect_b64 s[60:61], -1, 0
  s_waitcnt vmcnt(0)
  v_pk_add_f32 v[164:165], v[164:165], v[192:193]
  v_pk_add_f32 v[166:167], v[166:167], v[194:195]
  s_nop 0
  v_permlane16_swap_b32 v164, v165
  v_permlane16_swap_b32 v166, v167
  v_add_f32 v164, v164, v165
  v_add_f32 v166, v166, v167
  s_nop 1
  v_permlane32_swap_b32 v164, v166
  v_add_f32 v164, v164, v166
  v_cmp_u_f32 vcc, v164, v164
  s_and_b64 vcc, vcc, s[60:61]
  s_cbranch_vccnz L_poll_48
  v_mul_f32 v192, 0xbacccccd, v164
  v_lshrrev_b32 v193, 2, v5
  s_lshl_b32 s73, s56, 8
  s_add_u32 s73, s73, s70
  s_add_u32 s73, s73, 262144
  s_mov_b32 s62, s73
L_w_47:
  s_cmp_lt_u32 s56, 3
  s_cbranch_scc0 L_w_50
  s_mov_b32 s72, 0
L_poll_51:
  s_add_u32 s74, s69, 786432
  s_mov_b32 exec_lo, 0xff
  s_mov_b32 exec_hi, 0x0
  buffer_load_dwordx2 v[182:183], v9, s[36:39], s74 offen offset:768 sc1
  s_mov_b64 exec, -1
  s_lshl_b32 s73, s56, 8
  s_add_u32 s73, s73, s74
  s_add_u32 s74, s73, 4096
  buffer_load_dwordx4 v[164:167], v8, s[36:39], s73 offen sc1
  buffer_load_dwordx4 v[196:199], v8, s[36:39], s74 offen sc1
  s_add_u32 s72, s72, 1
  s_cmp_lt_u32 s72, 65536
  s_cselect_b64 s[60:61], -1, 0
  s_waitcnt vmcnt(0)
  v_pk_add_f32 v[164:165], v[164:165], v[196:197]
  v_pk_add_f32 v[166:167], v[166:167], v[198:199]
  v_add_f32_dpp v183, v183, v183 quad_perm:[1,0,3,2] row_mask:0xf bank_mask:0xf
  v_add_f32_dpp v182, v182, v182 quad_perm:[1,0,3,2] row_mask:0xf bank_mask:0xf
  v_permlane16_swap_b32 v164, v165
  v_permlane16_swap_b32 v166, v167
  v_add_f32 v164, v164, v165
  v_add_f32 v166, v166, v167
  v_add_f32_dpp v183, v183, v183 quad_perm:[2,3,0,1] row_mask:0xf bank_mask:0xf
  v_add_f32_dpp v182, v182, v182 quad_perm:[2,3,0,1] row_mask:0xf bank_mask:0xf
  v_permlane32_swap_b32 v164, v166
  v_add_f32_dpp v183, v183, v183 row_half_mirror row_mask:0xf bank_mask:0xf
  v_add_f32_dpp v182, v182, v182 row_half_mirror row_mask:0xf bank_mask:0xf
  v_add_f32 v164, v164, v166
  v_readfirstlane_b32 s58, v183
  s_nop 1
  v_fmac_f32 v164, s58, v192
  v_cmp_u_f32 vcc, v164, v182
  s_and_b64 vcc, vcc, s[60:61]
  s_cbranch_vccnz L_poll_51
  v_cvt_pk_bf16_f32 v164, v164, v164
  ds_write_b16 v11, v164
  s_mov_b64 exec, 1
  ds_write_b64 v10, v[182:183]
  s_mov_b64 exec, -1
  buffer_store_dword v192, v193, s[36:39], s62 offen
L_w_50:
  s_waitcnt lgkmcnt(0)
  s_barrier
  s_mov_b32 exec_lo, 0xf0f0f0f
  s_mov_b32 exec_hi, 0xf0f0f0f0
  ds_read_b128 v[168:171], v180 offset:0
  ds_read_b128 v[172:175], v180 offset:128
  ds_read_b128 v[176:179], v180 offset:256
  s_mov_b64 exec, -1
  ds_read_b64 v[182:183], v181
  s_waitcnt lgkmcnt(0)
  v_mfma_f32_16x16x32_bf16 v[8:11], v[168:171], v[20:23], 0
  v_mfma_f32_16x16x32_bf16 v[164:167], v[168:171], v[92:95], 0
  v_mfma_f32_16x16x32_bf16 v[8:11], v[172:175], v[16:19], v[8:11]
  v_mul_f32 v183, 0x3acccccd, v183
  v_mul_f32 v182, 0x3acccccd, v182
  v_mfma_f32_16x16x32_bf16 v[164:167], v[172:175], v[84:87], v[164:167]
  v_fma_f32 v182, -v183, v183, v182
  v_max_f32 v182, 0, v182
  v_mfma_f32_16x16x32_bf16 v[8:11], v[176:179], v[80:83], v[8:11]
  v_add_f32 v182, 0x3727c5ac, v182
  v_rsq_f32 v182, v182
  v_mfma_f32_16x16x32_bf16 v[164:167], v[176:179], v[96:99], v[164:167]
  v_mul_f32 v182, 0x3dd53b95, v182
  v_mfma_f32_16x16x32_bf16 v[192:195], v[168:171], v[104:107], 0
  v_mfma_f32_16x16x32_bf16 v[196:199], v[168:171], v[128:131], 0
  v_mfma_f32_16x16x32_bf16 v[192:195], v[172:175], v[108:111], v[192:195]
  s_nop 0
  v_mov_b32_dpp v180, v8 quad_perm:[0,0,0,0] row_mask:0xf bank_mask:0xf
  s_nop 1
  v_mov_b32_dpp v168, v164 quad_perm:[0,0,0,0] row_mask:0xf bank_mask:0xf
  v_mfma_f32_16x16x32_bf16 v[196:199], v[172:175], v[132:135], v[196:199]
  v_add_f32_dpp v180, v9, v180 quad_perm:[1,1,1,1] row_mask:0xf bank_mask:0xf
  v_add_f32_dpp v168, v165, v168 quad_perm:[1,1,1,1] row_mask:0xf bank_mask:0xf
  v_mfma_f32_16x16x32_bf16 v[192:195], v[176:179], v[120:123], v[192:195]
  v_add_f32_dpp v180, v10, v180 quad_perm:[2,2,2,2] row_mask:0xf bank_mask:0xf
  v_add_f32_dpp v168, v166, v168 quad_perm:[2,2,2,2] row_mask:0xf bank_mask:0xf
  v_mfma_f32_16x16x32_bf16 v[196:199], v[176:179], v[136:139], v[196:199]
  v_add_f32_dpp v180, v11, v180 quad_perm:[3,3,3,3] row_mask:0xf bank_mask:0xf
  s_nop 1
  v_add_f32_dpp v180, v167, v168 quad_perm:[3,3,3,3] row_mask:0xc bank_mask:0xf
  s_nop 0
  v_mov_b32_dpp v181, v192 quad_perm:[0,0,0,0] row_mask:0xf bank_mask:0xf
  s_nop 1
  v_mov_b32_dpp v8, v196 quad_perm:[0,0,0,0] row_mask:0xf bank_mask:0xf
  v_add_f32_dpp v181, v193, v181 quad_perm:[1,1,1,1] row_mask:0xf bank_mask:0xf
  s_nop 0
  v_add_f32_dpp v8, v197, v8 quad_perm:[1,1,1,1] row_mask:0xf bank_mask:0xf
  v_add_f32_dpp v181, v194, v181 quad_perm:[2,2,2,2] row_mask:0xf bank_mask:0xf
  s_nop 0
  v_add_f32_dpp v8, v198, v8 quad_perm:[2,2,2,2] row_mask:0xf bank_mask:0xf
  v_add_f32_dpp v181, v195, v181 quad_perm:[3,3,3,3] row_mask:0xf bank_mask:0xf
  s_nop 1
  v_add_f32_dpp v181, v199, v8 quad_perm:[3,3,3,3] row_mask:0xc bank_mask:0xf
  v_max_f32 v8, v180, v181
  s_nop 1
  v_max_f32_dpp v8, v8, v8 row_ror:4 row_mask:0xf bank_mask:0xf
  s_nop 1
  v_max_f32_dpp v8, v8, v8 row_ror:8 row_mask:0xf bank_mask:0xf
  s_nop 1
  v_max_f32_dpp v8, v8, v8 row_bcast:15 row_mask:0xa bank_mask:0xf
  s_nop 1
  v_max_f32_dpp v8, v8, v8 row_bcast:31 row_mask:0xc bank_mask:0xf
  s_nop 0
  v_readlane_b32 s58, v8, 63
  s_nop 1
  v_mul_f32_e64 v8, -s58, v182
  v_fma_f32 v180, v180, v182, v8
  v_fma_f32 v181, v181, v182, v8
  v_exp_f32 v180, v180
  v_exp_f32 v181, v181
  s_nop 0
  v_add_f32 v9, v180, v181
  v_cvt_pk_bf16_f32 v180, v180, v180
  v_cvt_pk_bf16_f32 v181, v181, v181
  v_and_b32 v164, v180, v184
  v_and_b32 v165, v180, v185
  v_and_b32_dpp v166, v180, v186 row_shr:4 row_mask:0xf bank_mask:0xf bound_ctrl:0
  v_and_b32_dpp v167, v180, v187 row_shr:4 row_mask:0xf bank_mask:0xf bound_ctrl:0
  s_nop 1
  v_mfma_f32_16x16x32_bf16 v[168:171], v[140:143], v[164:167], 0
  v_and_b32 v174, v180, v186
  v_and_b32 v175, v180, v187
  v_mfma_f32_16x16x32_bf16 v[176:179], v[144:147], v[164:167], 0
  v_and_b32_dpp v172, v180, v184 row_shl:4 row_mask:0xf bank_mask:0xf bound_ctrl:0
  v_and_b32_dpp v173, v180, v185 row_shl:4 row_mask:0xf bank_mask:0xf bound_ctrl:0
  v_add_f32_dpp v9, v9, v9 row_ror:4 row_mask:0xf bank_mask:0xf
  v_mfma_f32_16x16x32_bf16 v[192:195], v[148:151], v[164:167], 0
  s_nop 0
  v_add_f32_dpp v9, v9, v9 row_ror:8 row_mask:0xf bank_mask:0xf
  v_mfma_f32_16x16x32_bf16 v[168:171], v[152:155], v[172:175], v[168:171]
  v_and_b32 v164, v181, v184
  v_and_b32 v165, v181, v185
  v_mfma_f32_16x16x32_bf16 v[176:179], v[12:15], v[172:175], v[176:179]
  v_and_b32_dpp v166, v181, v186 row_shr:4 row_mask:0xf bank_mask:0xf bound_ctrl:0
  v_and_b32_dpp v167, v181, v187 row_shr:4 row_mask:0xf bank_mask:0xf bound_ctrl:0
  v_add_f32_dpp v9, v9, v9 row_bcast:15 row_mask:0xa bank_mask:0xf
  v_mfma_f32_16x16x32_bf16 v[192:195], v[88:91], v[172:175], v[192:195]
  s_nop 0
  v_add_f32_dpp v9, v9, v9 row_bcast:31 row_mask:0xc bank_mask:0xf
  v_mfma_f32_16x16x32_bf16 v[168:171], v[100:103], v[164:167], v[168:171]
  v_and_b32 v174, v181, v186
  v_and_b32 v175, v181, v187
  v_mfma_f32_16x16x32_bf16 v[176:179], v[112:115], v[164:167], v[176:179]
  v_and_b32_dpp v172, v181, v184 row_shl:4 row_mask:0xf bank_mask:0xf bound_ctrl:0
  v_and_b32_dpp v173, v181, v185 row_shl:4 row_mask:0xf bank_mask:0xf bound_ctrl:0
  v_mfma_f32_16x16x32_bf16 v[192:195], v[116:119], v[164:167], v[192:195]
  s_mov_b32 exec_lo, 0x0
  s_mov_b32 exec_hi, 0x80000000
  ds_write_b64 v191, v[8:9]
  s_mov_b64 exec, -1
  v_mfma_f32_16x16x32_bf16 v[168:171], v[124:127], v[172:175], v[168:171]
  v_mfma_f32_16x16x32_bf16 v[176:179], v[156:159], v[172:175], v[176:179]
  v_mfma_f32_16x16x32_bf16 v[192:195], v[160:163], v[172:175], v[192:195]
  v_mov_b32 v8, 162816
  v_add_u32 v9, 159744, v5
  s_add_u32 s73, s64, 262144
  s_nop 2
  v_permlane32_swap_b32 v168, v169
  v_permlane32_swap_b32 v170, v171
  v_permlane32_swap_b32 v176, v177
  v_permlane32_swap_b32 v178, v179
  v_permlane32_swap_b32 v192, v193
  v_permlane32_swap_b32 v194, v195
  v_add_f32_dpp v164, v169, v168 row_shl:8 row_mask:0xf bank_mask:0x3
  v_add_f32_dpp v165, v177, v176 row_shl:8 row_mask:0xf bank_mask:0x3
  v_add_f32_dpp v166, v193, v192 row_shl:8 row_mask:0xf bank_mask:0x3
  v_add_f32_dpp v164, v170, v171 row_shr:8 row_mask:0xf bank_mask:0xc
  v_add_f32_dpp v165, v178, v179 row_shr:8 row_mask:0xf bank_mask:0xc
  v_add_f32_dpp v166, v194, v195 row_shr:8 row_mask:0xf bank_mask:0xc
  ds_write_b32 v188, v164 offset:0
  ds_write_b32 v188, v165 offset:256
  ds_write_b32 v188, v166 offset:512
  s_waitcnt lgkmcnt(0)
  s_barrier
  s_cmp_eq_u32 s56, 3
  s_cbranch_scc0 L_w_53
  ds_read_b128 v[164:167], v8
  ds_read_b128 v[168:171], v8 offset:16
  ds_read_b128 v[172:175], v9 offset:0
  ds_read_b128 v[176:179], v9 offset:768
  ds_read_b128 v[180:183], v9 offset:1536
  ds_read_b128 v[184:187], v9 offset:2304
  s_mov_b32 vcc_lo, 0
  s_mov_b32 vcc_hi, 0xffff0000
  s_mov_b32 exec_hi, 0x1ffff
  s_waitcnt lgkmcnt(4)
  v_min3_f32 v8, v164, v166, v168
  v_min_f32 v8, v8, v170
  v_sub_f32 v164, v8, v164
  v_sub_f32 v166, v8, v166
  v_sub_f32 v168, v8, v168
  v_sub_f32 v170, v8, v170
  v_exp_f32 v164, v164
  v_exp_f32 v166, v166
  v_exp_f32 v168, v168
  v_exp_f32 v170, v170
  s_waitcnt lgkmcnt(0)
  v_pk_mul_f32 v[172:173], v[172:173], v[164:165] op_sel_hi:[1,0]
  v_pk_mul_f32 v[174:175], v[174:175], v[164:165] op_sel_hi:[1,0]
  v_mul_f32 v165, v164, v165
  v_pk_mul_f32 v[180:181], v[180:181], v[168:169] op_sel_hi:[1,0]
  v_pk_mul_f32 v[182:183], v[182:183], v[168:169] op_sel_hi:[1,0]
  v_mul_f32 v169, v168, v169
  v_pk_fma_f32 v[172:173], v[176:177], v[166:167], v[172:173] op_sel_hi:[1,0,1]
  v_pk_fma_f32 v[174:175], v[178:179], v[166:167], v[174:175] op_sel_hi:[1,0,1]
  v_fmac_f32 v165, v166, v167
  v_pk_fma_f32 v[180:181], v[184:185], v[170:171], v[180:181] op_sel_hi:[1,0,1]
  v_pk_fma_f32 v[182:183], v[186:187], v[170:171], v[182:183] op_sel_hi:[1,0,1]
  v_fmac_f32 v169, v170, v171
  v_pk_add_f32 v[172:173], v[172:173], v[180:181]
  v_pk_add_f32 v[174:175], v[174:175], v[182:183]
  v_add_f32 v9, v165, v169
  v_cvt_pk_bf16_f32 v176, v172, v173
  v_cvt_pk_bf16_f32 v177, v174, v175
  v_cndmask_b32 v176, v176, v8, vcc
  v_cndmask_b32 v177, v177, v9, vcc
  s_cmp_eq_u32 s75, 0
  s_cbranch_scc1 L_slow_54
  buffer_store_dwordx2 v[176:177], v190, s[36:39], s73 offen
  s_branch L_pub_55
L_slow_54:
  buffer_store_dwordx2 v[176:177], v190, s[36:39], s73 offen sc1
L_pub_55:
  s_mov_b64 exec, -1
L_w_53:
  v_and_b32 v8, 0x70, v5
  s_sleep 3
  v_lshrrev_b32 v9, 8, v5
  v_bfe_u32 v10, v5, 7, 1
  v_mul_u32_u24 v10, 192, v10
  v_lshl_add_u32 v9, v9, 4, v10
  v_lshrrev_b32 v10, 6, v5
  v_mul_u32_u24 v10, 160, v10
  v_bfe_u32 v11, v5, 4, 2
  v_lshl_add_u32 v10, v11, 3, v10
  s_lshl_b32 s58, s56, 5
  s_add_u32 s58, s58, 92160
  v_add_u32 v10, s58, v10
  s_cmp_lt_u32 s56, 3
  s_cbranch_scc0 L_w_56
  ds_read_b64_tr_b16 v[164:165], v10 offset:0
  ds_read_b64_tr_b16 v[166:167], v10 offset:2560
  ds_read_b64_tr_b16 v[168:169], v10 offset:5120
  ds_read_b64_tr_b16 v[170:171], v10 offset:7680
  ds_read_b64_tr_b16 v[172:173], v10 offset:10240
  ds_read_b64_tr_b16 v[174:175], v10 offset:12800
  ds_read_b64_tr_b16 v[176:177], v10 offset:15360
  ds_read_b64_tr_b16 v[178:179], v10 offset:17920
  ds_read_b64_tr_b16 v[180:181], v10 offset:20480
  ds_read_b64_tr_b16 v[182:183], v10 offset:23040
  ds_read_b64_tr_b16 v[184:185], v10 offset:25600
  ds_read_b64_tr_b16 v[186:187], v10 offset:28160
  ds_read_b64_tr_b16 v[188:189], v10 offset:96
  ds_read_b64_tr_b16 v[190:191], v10 offset:2656
  ds_read_b64_tr_b16 v[192:193], v10 offset:5216
  ds_read_b64_tr_b16 v[194:195], v10 offset:7776
  ds_read_b64_tr_b16 v[196:197], v10 offset:10336
  ds_read_b64_tr_b16 v[198:199], v10 offset:12896
  ds_read_b64_tr_b16 v[200:201], v10 offset:15456
  ds_read_b64_tr_b16 v[202:203], v10 offset:18016
  ds_read_b64_tr_b16 v[204:205], v10 offset:20576
  ds_read_b64_tr_b16 v[206:207], v10 offset:23136
  ds_read_b64_tr_b16 v[208:209], v10 offset:25696
  ds_read_b64_tr_b16 v[210:211], v10 offset:28256
L_w_56:
  s_lshl_b32 s58, s56, 6
  s_add_u32 s74, s66, s58
  s_add_u32 s74, s74, 262144
  s_cmp_lt_u32 s56, 3
  s_cbranch_scc0 L_w_57
  s_mov_b32 s72, 0
L_poll_58:
  s_add_u32 s73, s65, 262144
  buffer_load_dwordx2 v[212:213], v8, s[36:39], s73 offen offset:3072 sc1
  buffer_load_dwordx4 v[216:219], v5, s[36:39], s73 offen offset:0 sc1
  buffer_load_dwordx4 v[220:223], v5, s[36:39], s73 offen offset:1024 sc1
  buffer_load_dwordx4 v[224:227], v5, s[36:39], s73 offen offset:2048 sc1
  s_add_u32 s72, s72, 1
  s_cmp_lt_u32 s72, 65536
  s_cselect_b64 s[60:61], -1, 0
  s_waitcnt vmcnt(0)
  v_max3_u32 v214, v212, v213, v216
  v_max3_u32 v215, v217, v218, v219
  v_max3_u32 v214, v214, v220, v221
  v_max3_u32 v215, v215, v222, v223
  v_max3_u32 v214, v214, v224, v225
  v_max3_u32 v215, v215, v226, v227
  v_max_u32 v214, v214, v215
  v_cmp_eq_u32 vcc, -1, v214
  s_and_b64 vcc, vcc, s[60:61]
  s_cbranch_vccnz L_poll_58
  s_waitcnt lgkmcnt(0)
  v_mfma_f32_16x16x32_bf16 v[228:231], v[164:167], v[216:219], 0
  v_min_f32_dpp v214, v212, v212 quad_perm:[1,0,3,2] row_mask:0xf bank_mask:0xf
  v_mfma_f32_16x16x32_bf16 v[164:167], v[168:171], v[216:219], 0
  s_nop 0
  v_min_f32_dpp v214, v214, v214 quad_perm:[2,3,0,1] row_mask:0xf bank_mask:0xf
  v_mfma_f32_16x16x32_bf16 v[228:231], v[172:175], v[220:223], v[228:231]
  s_nop 0
  v_min_f32_dpp v214, v214, v214 row_half_mirror row_mask:0xf bank_mask:0xf
  v_mfma_f32_16x16x32_bf16 v[164:167], v[176:179], v[220:223], v[164:167]
  v_sub_f32 v212, v214, v212
  v_exp_f32 v212, v212
  v_mfma_f32_16x16x32_bf16 v[228:231], v[180:183], v[224:227], v[228:231]
  v_mul_f32 v213, v212, v213
  v_mfma_f32_16x16x32_bf16 v[164:167], v[184:187], v[224:227], v[164:167]
  s_nop 0
  v_add_f32_dpp v213, v213, v213 quad_perm:[1,0,3,2] row_mask:0xf bank_mask:0xf
  v_mfma_f32_16x16x32_bf16 v[168:171], v[188:191], v[216:219], 0
  s_nop 0
  v_add_f32_dpp v213, v213, v213 quad_perm:[2,3,0,1] row_mask:0xf bank_mask:0xf
  v_mfma_f32_16x16x32_bf16 v[172:175], v[192:195], v[216:219], 0
  s_nop 0
  v_add_f32_dpp v213, v213, v213 row_half_mirror row_mask:0xf bank_mask:0xf
  v_mfma_f32_16x16x32_bf16 v[168:171], v[196:199], v[220:223], v[168:171]
  v_rcp_f32 v213, v213
  s_nop 0
  v_mul_f32 v212, v212, v213
  v_mfma_f32_16x16x32_bf16 v[172:175], v[200:203], v[220:223], v[172:175]
  v_add_f32_dpp v176, v164, v228 row_shl:8 row_mask:0xf bank_mask:0x3
  v_add_f32_dpp v177, v165, v229 row_shl:8 row_mask:0xf bank_mask:0x3
  v_mfma_f32_16x16x32_bf16 v[168:171], v[204:207], v[224:227], v[168:171]
  v_add_f32_dpp v178, v166, v230 row_shl:8 row_mask:0xf bank_mask:0x3
  v_add_f32_dpp v179, v167, v231 row_shl:8 row_mask:0xf bank_mask:0x3
  v_mfma_f32_16x16x32_bf16 v[172:175], v[208:211], v[224:227], v[172:175]
  s_cmp_lt_u32 s56, 2
  s_mov_b32 s58, 0x00010001
  s_cselect_b32 s58, 0x01010101, s58
  s_nop 4
  v_add_f32_dpp v176, v168, v172 row_shr:8 row_mask:0xf bank_mask:0xc
  v_add_f32_dpp v177, v169, v173 row_shr:8 row_mask:0xf bank_mask:0xc
  v_add_f32_dpp v178, v170, v174 row_shr:8 row_mask:0xf bank_mask:0xc
  v_add_f32_dpp v179, v171, v175 row_shr:8 row_mask:0xf bank_mask:0xc
  v_mul_f32 v176, v212, v176
  v_mul_f32 v177, v212, v177
  v_mul_f32 v178, v212, v178
  v_mul_f32 v179, v212, v179
  v_add_f32_dpp v176, v176, v176 quad_perm:[1,0,3,2] row_mask:0xf bank_mask:0xf
  v_add_f32_dpp v177, v177, v177 quad_perm:[1,0,3,2] row_mask:0xf bank_mask:0xf
  v_add_f32_dpp v178, v178, v178 quad_perm:[1,0,3,2] row_mask:0xf bank_mask:0xf
  v_add_f32_dpp v179, v179, v179 quad_perm:[1,0,3,2] row_mask:0xf bank_mask:0xf
  v_add_f32_dpp v176, v176, v176 quad_perm:[2,3,0,1] row_mask:0xf bank_mask:0xf
  v_add_f32_dpp v177, v177, v177 quad_perm:[2,3,0,1] row_mask:0xf bank_mask:0xf
  v_add_f32_dpp v178, v178, v178 quad_perm:[2,3,0,1] row_mask:0xf bank_mask:0xf
  v_add_f32_dpp v179, v179, v179 quad_perm:[2,3,0,1] row_mask:0xf bank_mask:0xf
  v_add_f32_dpp v176, v176, v176 row_half_mirror row_mask:0xf bank_mask:0xf
  v_add_f32_dpp v177, v177, v177 row_half_mirror row_mask:0xf bank_mask:0xf
  v_add_f32_dpp v178, v178, v178 row_half_mirror row_mask:0xf bank_mask:0xf
  v_add_f32_dpp v179, v179, v179 row_half_mirror row_mask:0xf bank_mask:0xf
  s_mov_b32 exec_lo, s58
  s_mov_b32 exec_hi, s58
  buffer_store_dwordx4 v[176:179], v9, s[36:39], s74 offen sc1
  s_mov_b64 exec, -1
L_w_57:
  s_barrier
  v_mov_b32 v8, -1
  v_mov_b32 v9, -1
  v_mov_b32 v10, -1
  v_mov_b32 v11, -1
  s_cmp_eq_u32 s56, 0
  s_cbranch_scc0 L_w_60
  s_mov_b32 exec_lo, 0xffffffff
  s_mov_b32 exec_hi, 0x0
  s_add_u32 s74, s77, 131072
  buffer_store_dwordx4 v[8:11], v5, s[36:39], s74 offen sc1
  s_add_u32 s74, s77, 786432
  buffer_store_dwordx4 v[8:11], v5, s[36:39], s74 offen sc1
  s_mov_b32 exec_lo, 0xffffffff
  s_mov_b32 exec_hi, 0xffffff
  s_add_u32 s74, s68, 2359296
  buffer_store_dwordx4 v[8:11], v5, s[36:39], s74 offen sc1
  s_mov_b32 exec_lo, 0xffffff
  s_mov_b32 exec_hi, 0x0
  s_add_u32 s74, s66, 655360
  buffer_store_dwordx4 v[8:11], v5, s[36:39], s74 offen sc1
  s_mov_b64 exec, -1
L_w_60:
  s_cmp_eq_u32 s56, 1
  s_cbranch_scc0 L_w_61
  s_mov_b32 exec_lo, 0xffffffff
  s_mov_b32 exec_hi, 0x0
  s_add_u32 s74, s77, 393216
  buffer_store_dwordx4 v[8:11], v5, s[36:39], s74 offen sc1
  s_add_u32 s74, s77, 917504
  buffer_store_dwordx4 v[8:11], v5, s[36:39], s74 offen sc1
  s_mov_b32 exec_lo, 0xffffffff
  s_mov_b32 exec_hi, 0xffffff
  s_add_u32 s74, s68, 2367488
  buffer_store_dwordx4 v[8:11], v5, s[36:39], s74 offen sc1
  s_mov_b32 exec_lo, 0xffffff
  s_mov_b32 exec_hi, 0x0
  s_add_u32 s74, s66, 786432
  buffer_store_dwordx4 v[8:11], v5, s[36:39], s74 offen sc1
  s_mov_b64 exec, -1
L_w_61:
  s_cmp_eq_u32 s56, 2
  s_cbranch_scc0 L_w_62
  s_mov_b32 exec_lo, 0xffffffff
  s_mov_b32 exec_hi, 0x0
  s_add_u32 s74, s77, 524288
  buffer_store_dwordx4 v[8:11], v5, s[36:39], s74 offen sc1
  s_mov_b32 exec_lo, 0xffffffff
  s_mov_b32 exec_hi, 0xffffff
  s_add_u32 s74, s68, 794624
  buffer_store_dwordx4 v[8:11], v5, s[36:39], s74 offen sc1
  s_mov_b32 exec_lo, 0xffffff
  s_mov_b32 exec_hi, 0x0
  s_add_u32 s74, s66, 131072
  buffer_store_dwordx4 v[8:11], v5, s[36:39], s74 offen sc1
  s_add_u32 s74, s66, 917504
  buffer_store_dwordx4 v[8:11], v5, s[36:39], s74 offen sc1
  s_mov_b64 exec, -1
L_w_62:
  s_cmp_eq_u32 s56, 3
  s_cbranch_scc0 L_w_63
  s_mov_b32 exec_lo, 0xffffffff
  s_mov_b32 exec_hi, 0x0
  s_add_u32 s74, s77, 655360
  buffer_store_dwordx4 v[8:11], v5, s[36:39], s74 offen sc1
  s_mov_b32 exec_lo, 0xffffffff
  s_mov_b32 exec_hi, 0xffffff
  s_add_u32 s74, s68, 1581056
  buffer_store_dwordx4 v[8:11], v5, s[36:39], s74 offen sc1
  s_mov_b32 exec_lo, 0xffffff
  s_mov_b32 exec_hi, 0x0
  s_add_u32 s74, s66, 393216
  buffer_store_dwordx4 v[8:11], v5, s[36:39], s74 offen sc1
  s_mov_b64 exec, -1
L_w_63:
  s_nop 0
  v_lshrrev_b32 v9, 2, v5
  s_lshl_b32 s73, s56, 8
  s_add_u32 s73, s73, s70
  s_add_u32 s73, s73, 0
  buffer_load_dword v8, v9, s[36:39], s73 offen sc1
  v_lshlrev_b32 v10, 3, v5
  s_add_u32 s58, s68, 1572864
  s_mov_b32 exec_lo, 0x7f
  s_mov_b32 exec_hi, 0x0
  buffer_load_dword v11, v10, s[36:39], s58 offen sc1
  s_mov_b64 exec, -1
  v_bfe_u32 v164, v5, 5, 3
  v_add_u32 v165, -1, v164
  v_and_b32 v165, 3, v165
  v_add_u32 v165, 1, v165
  v_min_u32 v164, v165, v164
  v_lshrrev_b32 v165, 8, v5
  v_lshl_add_u32 v164, v164, 2, v165
  v_mul_u32_u24 v164, 16, v164
  v_add_u32 v164, 159744, v164
  v_and_b32 v165, 0x1f0, v5
  v_lshrrev_b32 v166, 9, v5
  v_lshl_add_u32 v165, v166, 2, v165
  s_mul_i32 s58, s56, 320
  s_add_u32 s58, s58, 159744
  v_add_u32 v165, s58, v165
  v_lshrrev_b32 v166, 9, v5
  v_mul_u32_u24 v166, 3072, v166
  v_bfe_u32 v167, v5, 6, 3
  v_lshl_add_u32 v166, v167, 7, v166
  v_bfe_u32 v167, v5, 4, 2
  v_lshl_add_u32 v166, v167, 3, v166
  s_max_u32 s58, s56, 1
  s_lshl_b32 s58, s58, 10
  s_add_u32 s58, s58, 0xfffffc00
  v_add_u32 v166, s58, v166
  v_bfe_u32 v167, v5, 7, 2
  v_lshl_add_u32 v168, v167, 5, v166
  v_xor_b32 v169, 32, v168
  v_xor_b32 v170, 64, v168
  v_xor_b32 v171, 96, v168
  ds_read_b64_tr_b16 v[172:173], v168 offset:24576
  ds_read_b64_tr_b16 v[174:175], v169 offset:24576
  ds_read_b64_tr_b16 v[176:177], v170 offset:24576
  ds_read_b64_tr_b16 v[178:179], v171 offset:24576
  ds_read_b64_tr_b16 v[180:181], v168 offset:0
  ds_read_b64_tr_b16 v[184:185], v169 offset:0
  ds_read_b64_tr_b16 v[188:189], v170 offset:0
  ds_read_b64_tr_b16 v[192:193], v171 offset:0
  ds_read_b64_tr_b16 v[182:183], v168 offset:6144
  ds_read_b64_tr_b16 v[186:187], v169 offset:6144
  ds_read_b64_tr_b16 v[190:191], v170 offset:6144
  ds_read_b64_tr_b16 v[194:195], v171 offset:6144
  ds_read_b64_tr_b16 v[196:197], v168 offset:12288
  ds_read_b64_tr_b16 v[200:201], v169 offset:12288
  ds_read_b64_tr_b16 v[204:205], v170 offset:12288
  ds_read_b64_tr_b16 v[208:209], v171 offset:12288
  ds_read_b64_tr_b16 v[198:199], v168 offset:18432
  ds_read_b64_tr_b16 v[202:203], v169 offset:18432
  ds_read_b64_tr_b16 v[206:207], v170 offset:18432
  ds_read_b64_tr_b16 v[210:211], v171 offset:18432
  v_lshrrev_b32 v166, 2, v5
  v_mov_b32 v167, 0x3f803f80
  v_lshlrev_b32 v168, 16, v2
  v_and_b32 v169, 0xffff0000, v2
  v_lshlrev_b32 v170, 16, v3
  v_and_b32 v171, 0xffff0000, v3
  v_mov_b32 v212, 0
  v_mov_b32 v213, 0
  v_mov_b32 v214, 0
  v_mov_b32 v215, 0
  v_mov_b32 v216, 0
  v_mov_b32 v217, 0
  v_mov_b32 v218, 0
  v_mov_b32 v219, 0
  v_mov_b32 v220, 0
  v_mov_b32 v221, 0
  v_mov_b32 v222, 0
  v_mov_b32 v223, 0
  v_and_b32 v224, 0x30, v5
  v_bfe_u32 v225, v5, 8, 1
  v_lshl_add_u32 v224, v225, 6, v224
  v_add_u32 v224, 162880, v224
  v_mov_b32 v225, 163264
  v_and_b32 v226, 16, v5
  v_mov_b32 v227, 0xffff
  v_lshlrev_b32 v226, v226, v227
  v_bfe_u32 v227, v5, 5, 2
  v_cmp_eq_u32 vcc, 0, v227
  s_nop 1
  v_cndmask_b32 v228, 0, v226, vcc
  v_cmp_eq_u32 vcc, 1, v227
  s_nop 1
  v_cndmask_b32 v229, 0, v226, vcc
  v_cmp_eq_u32 vcc, 2, v227
  s_nop 1
  v_cndmask_b32 v230, 0, v226, vcc
  v_cmp_eq_u32 vcc, 3, v227
  s_nop 1
  v_cndmask_b32 v231, 0, v226, vcc
  v_bfe_u32 v232, v5, 7, 2
  v_lshlrev_b32 v232, 4, v232
  v_lshrrev_b32 v233, 9, v5
  v_lshl_add_u32 v232, v233, 3, v232
  v_bfe_u32 v233, v5, 4, 3
  v_add_lshl_u32 v232, v232, v233, 2
  s_mul_i32 s58, s56, 768
  s_add_u32 s58, s58, 159744
  v_add_u32 v232, s58, v232
  v_lshrrev_b32 v234, 8, v5
  v_bfe_u32 v233, v5, 4, 2
  v_lshl_add_u32 v234, v234, 2, v233
  v_bfe_u32 v233, v5, 7, 1
  v_lshl_add_u32 v234, v234, 1, v233
  v_lshlrev_b32 v234, 7, v234
  v_bfe_u32 v233, v5, 6, 1
  v_lshl_add_u32 v234, v233, 3, v234
  v_add_u32 v233, s71, v5
  s_lshl_b32 s58, s56, 3
  s_add_u32 s58, s58, 162816
  v_mov_b32 v235, s58
  s_sleep 2
  s_mov_b32 exec_lo, 0xfffff
  s_mov_b32 exec_hi, 0xfffff
  s_lshl_b32 s73, s56, 12
  s_add_u32 s73, s73, s67
  s_add_u32 s73, s73, 262144
  buffer_load_dwordx4 v[236:239], v5, s[36:39], s73 offen offset:0 sc1
  buffer_load_dwordx4 v[240:243], v5, s[36:39], s73 offen offset:1024 sc1
  buffer_load_dwordx4 v[244:247], v5, s[36:39], s73 offen offset:2048 sc1
  buffer_load_dwordx4 v[248:251], v5, s[36:39], s73 offen offset:3072 sc1
  s_mov_b64 exec, -1
  s_mov_b32 s72, 0
  s_waitcnt vmcnt(0)
L_chk_64:
  s_mov_b32 exec_lo, 0xfffff
  s_mov_b32 exec_hi, 0xfffff
  v_pk_add_f32 v[236:237], v[236:237], v[240:241]
  v_pk_add_f32 v[238:239], v[238:239], v[242:243]
  v_pk_add_f32 v[244:245], v[244:245], v[248:249]
  v_pk_add_f32 v[246:247], v[246:247], v[250:251]
  v_pk_add_f32 v[236:237], v[236:237], v[244:245]
  v_pk_add_f32 v[238:239], v[238:239], v[246:247]
  s_nop 0
  v_permlane32_swap_b32 v236, v237
  v_permlane32_swap_b32 v238, v239
  v_add_f32 v236, v236, v237
  v_add_f32 v238, v238, v239
  v_cmp_u_f32 vcc, v236, v238
  s_cbranch_vccz L_ok_65
  s_add_u32 s72, s72, 1
  s_cmp_ge_u32 s72, 65536
  s_cbranch_scc1 L_ok_65
  s_sleep 1
  s_mov_b32 exec_lo, 0xfffff
  s_mov_b32 exec_hi, 0xfffff
  s_lshl_b32 s73, s56, 12
  s_add_u32 s73, s73, s67
  s_add_u32 s73, s73, 262144
  buffer_load_dwordx4 v[236:239], v5, s[36:39], s73 offen offset:0 sc1
  buffer_load_dwordx4 v[240:243], v5, s[36:39], s73 offen offset:1024 sc1
  buffer_load_dwordx4 v[244:247], v5, s[36:39], s73 offen offset:2048 sc1
  buffer_load_dwordx4 v[248:251], v5, s[36:39], s73 offen offset:3072 sc1
  s_waitcnt vmcnt(0)
  s_branch L_chk_64
L_ok_65:
  ds_write2_b32 v165, v236, v238 offset0:0 offset1:2
  s_mov_b64 exec, -1
  s_waitcnt lgkmcnt(0)
  s_barrier
  ds_read_b128 v[236:239], v164 offset:0
  ds_read_b128 v[240:243], v164 offset:320
  ds_read_b128 v[244:247], v164 offset:640
  ds_read_b128 v[248:251], v164 offset:960
  s_mov_b32 exec_lo, 0x55555555
  s_mov_b32 exec_hi, 0x55555555
  s_mov_b32 vcc_lo, 0x44444444
  s_mov_b32 vcc_hi, 0x44444444
  s_waitcnt lgkmcnt(2)
  v_pk_add_f32 v[236:237], v[236:237], v[240:241]
  v_pk_add_f32 v[238:239], v[238:239], v[242:243]
  v_pk_add_f32 v[168:169], v[168:169], v[236:237]
  v_pk_add_f32 v[170:171], v[170:171], v[238:239]
  s_waitcnt lgkmcnt(0)
  v_pk_add_f32 v[244:245], v[244:245], v[248:249]
  v_pk_add_f32 v[246:247], v[246:247], v[250:251]
  v_pk_add_f32 v[168:169], v[168:169], v[244:245]
  v_pk_add_f32 v[170:171], v[170:171], v[246:247]
  v_cvt_pk_bf16_f32 v2, v168, v169
  v_cvt_pk_bf16_f32 v3, v170, v171
  s_mov_b64 exec, -1
  v_cndmask_b32_dpp v10, v2, v167, vcc row_newbcast:8 row_mask:0xf bank_mask:0xf
  v_cndmask_b32_dpp v11, v3, v167, vcc row_newbcast:8 row_mask:0xf bank_mask:0xf
  v_cndmask_b32_dpp v168, v2, v167, vcc row_newbcast:0 row_mask:0xf bank_mask:0xf
  v_cndmask_b32_dpp v169, v3, v167, vcc row_newbcast:0 row_mask:0xf bank_mask:0xf
  v_cndmask_b32_dpp v170, v2, v167, vcc row_newbcast:2 row_mask:0xf bank_mask:0xf
  v_cndmask_b32_dpp v171, v3, v167, vcc row_newbcast:2 row_mask:0xf bank_mask:0xf
  v_cndmask_b32_dpp v236, v2, v167, vcc row_newbcast:4 row_mask:0xf bank_mask:0xf
  v_cndmask_b32_dpp v237, v3, v167, vcc row_newbcast:4 row_mask:0xf bank_mask:0xf
  v_cndmask_b32_dpp v238, v2, v167, vcc row_newbcast:6 row_mask:0xf bank_mask:0xf
  v_cndmask_b32_dpp v239, v3, v167, vcc row_newbcast:6 row_mask:0xf bank_mask:0xf
  s_waitcnt lgkmcnt(0)
  s_cmp_eq_u32 s56, 0
  s_cbranch_scc1 L_q0_66
  v_mfma_f32_16x16x16_bf16 v[240:243], v[10:11], v[172:173], 0
  v_mfma_f32_16x16x16_bf16 v[244:247], v[10:11], v[174:175], 0
  v_mfma_f32_16x16x16_bf16 v[172:175], v[10:11], v[176:177], 0
  v_mfma_f32_16x16x16_bf16 v[248:251], v[10:11], v[178:179], 0
  s_lshl_b32 s58, s56, 8
  s_add_u32 s73, s68, 0x17ff00
  s_add_u32 s73, s73, s58
  s_nop 1
  v_mfma_f32_16x16x32_bf16 v[240:243], v[168:171], v[180:183], v[240:243]
  v_mfma_f32_16x16x32_bf16 v[244:247], v[168:171], v[184:187], v[244:247]
  v_mfma_f32_16x16x32_bf16 v[172:175], v[168:171], v[188:191], v[172:175]
  v_mfma_f32_16x16x32_bf16 v[248:251], v[168:171], v[192:195], v[248:251]
  v_mfma_f32_16x16x32_bf16 v[240:243], v[236:239], v[196:199], v[240:243]
  v_mfma_f32_16x16x32_bf16 v[244:247], v[236:239], v[200:203], v[244:247]
  v_mfma_f32_16x16x32_bf16 v[172:175], v[236:239], v[204:207], v[172:175]
  v_mfma_f32_16x16x32_bf16 v[248:251], v[236:239], v[208:211], v[248:251]
  s_nop 5
  v_mov_b32_dpp v240, v244 quad_perm:[0,1,2,3] row_mask:0x2 bank_mask:0xf
  s_nop 1
  v_mov_b32_dpp v240, v172 quad_perm:[0,1,2,3] row_mask:0x4 bank_mask:0xf
  s_nop 1
  v_mov_b32_dpp v240, v248 quad_perm:[0,1,2,3] row_mask:0x8 bank_mask:0xf
  s_cmp_eq_u32 s75, 0
  s_cbranch_scc1 L_slow_68
  buffer_store_dword v240, v166, s[36:39], s73 offen
  s_branch L_pub_69
L_slow_68:
  buffer_store_dword v240, v166, s[36:39], s73 offen sc1
L_pub_69:
  s_branch L_qe_67
L_q0_66:
  v_mfma_f32_16x16x16_bf16 v[240:243], v[10:11], v[10:11], 0
  v_mfma_f32_16x16x32_bf16 v[244:247], v[168:171], v[168:171], 0
  v_mfma_f32_16x16x32_bf16 v[244:247], v[236:239], v[236:239], v[244:247]
  s_add_u32 s73, s68, 1572864
  s_mov_b64 exec, 1
  s_nop 5
  v_add_f32 v240, v240, v244
  v_add_f32 v241, v242, v246
  s_cmp_eq_u32 s75, 0
  s_cbranch_scc1 L_slow_70
  buffer_store_dwordx2 v[240:241], v166, s[36:39], s73 offen offset:768
  s_branch L_pub_71
L_slow_70:
  buffer_store_dwordx2 v[240:241], v166, s[36:39], s73 offen offset:768 sc1
L_pub_71:
  s_mov_b64 exec, -1
L_qe_67:
  v_lshrrev_b32 v165, 8, v5
  v_and_b32 v164, 0xf0, v5
  v_lshl_add_u32 v164, v165, 10, v164
  v_bfe_u32 v167, v5, 1, 7
  v_lshl_add_u32 v167, v165, 1, v167
  s_lshl_b32 s58, s56, 7
  s_add_u32 s58, s58, 162880
  v_add_u32 v167, s58, v167
  v_lshlrev_b32 v165, 6, v5
  v_mov_b32 v166, 163264
  v_mov_b32 v10, 0
  v_mov_b32 v11, 0
  s_sleep 2
  s_cmp_lt_u32 s56, 3
  s_cbranch_scc0 L_w_72
  s_mov_b32 s72, 0
L_poll_73:
  s_add_u32 s74, s69, 1572864
  s_mov_b32 exec_lo, 0xff
  s_mov_b32 exec_hi, 0x0
  buffer_load_dwordx2 v[10:11], v165, s[36:39], s74 offen offset:768 sc1
  s_mov_b64 exec, -1
  s_lshl_b32 s73, s56, 8
  s_add_u32 s73, s73, s74
  s_add_u32 s74, s73, 4096
  buffer_load_dwordx4 v[168:171], v164, s[36:39], s73 offen sc1
  buffer_load_dwordx4 v[172:175], v164, s[36:39], s74 offen sc1
  s_add_u32 s72, s72, 1
  s_cmp_lt_u32 s72, 65536
  s_cselect_b64 s[60:61], -1, 0
  s_waitcnt vmcnt(0)
  v_pk_add_f32 v[168:169], v[168:169], v[172:173]
  v_pk_add_f32 v[170:171], v[170:171], v[174:175]
  v_add_f32_dpp v11, v11, v11 quad_perm:[1,0,3,2] row_mask:0xf bank_mask:0xf
  v_add_f32_dpp v10, v10, v10 quad_perm:[1,0,3,2] row_mask:0xf bank_mask:0xf
  v_permlane16_swap_b32 v168, v169
  v_permlane16_swap_b32 v170, v171
  v_add_f32 v168, v168, v169
  v_add_f32 v170, v170, v171
  v_add_f32_dpp v11, v11, v11 quad_perm:[2,3,0,1] row_mask:0xf bank_mask:0xf
  v_add_f32_dpp v10, v10, v10 quad_perm:[2,3,0,1] row_mask:0xf bank_mask:0xf
  v_permlane32_swap_b32 v168, v170
  v_add_f32_dpp v11, v11, v11 row_half_mirror row_mask:0xf bank_mask:0xf
  v_add_f32_dpp v10, v10, v10 row_half_mirror row_mask:0xf bank_mask:0xf
  v_add_f32 v168, v168, v170
  v_readfirstlane_b32 s58, v11
  s_nop 1
  v_fmac_f32 v168, s58, v8
  v_cmp_u_f32 vcc, v168, v10
  s_and_b64 vcc, vcc, s[60:61]
  s_cbranch_vccnz L_poll_73
  v_cvt_pk_bf16_f32 v168, v168, v168
  ds_write_b16 v167, v168
  s_mov_b64 exec, 1
  ds_write_b64 v166, v[10:11]
  s_mov_b64 exec, -1
L_w_72:
  s_waitcnt lgkmcnt(0)
  s_barrier
  s_mov_b32 exec_lo, 0xf0f0f0f
  s_mov_b32 exec_hi, 0xf0f0f0f0
  ds_read_b128 v[212:215], v224 offset:0
  ds_read_b128 v[216:219], v224 offset:128
  ds_read_b128 v[220:223], v224 offset:256
  s_mov_b64 exec, -1
  ds_read_b64 v[226:227], v225
  s_mov_b32 s57, 0x3000000
  buffer_load_dwordx4 v[8:11], v4, s[4:7], s57 offen offset:0 nt
  buffer_load_dwordx4 v[164:167], v4, s[4:7], s57 offen offset:128 nt
  buffer_load_dwordx4 v[168:171], v4, s[4:7], s57 offen offset:256 nt
  buffer_load_dwordx4 v[172:175], v4, s[4:7], s57 offen offset:3072 nt
  buffer_load_dwordx4 v[176:179], v4, s[4:7], s57 offen offset:3200 nt
  buffer_load_dwordx4 v[180:183], v4, s[4:7], s57 offen offset:3328 nt
  s_mov_b32 s57, 0x3001800
  buffer_load_dwordx4 v[184:187], v4, s[4:7], s57 offen offset:0 nt
  buffer_load_dwordx4 v[188:191], v4, s[4:7], s57 offen offset:128 nt
  s_waitcnt lgkmcnt(0)
  v_mfma_f32_16x16x32_bf16 v[192:195], v[212:215], a[0:3], 0
  v_mfma_f32_16x16x32_bf16 v[196:199], v[212:215], a[12:15], 0
  v_mfma_f32_16x16x32_bf16 v[192:195], v[216:219], a[4:7], v[192:195]
  v_mul_f32 v227, 0x3acccccd, v227
  v_mul_f32 v226, 0x3acccccd, v226
  v_mfma_f32_16x16x32_bf16 v[196:199], v[216:219], a[16:19], v[196:199]
  v_fma_f32 v226, -v227, v227, v226
  v_max_f32 v226, 0, v226
  v_mfma_f32_16x16x32_bf16 v[192:195], v[220:223], a[8:11], v[192:195]
  v_add_f32 v226, 0x3727c5ac, v226
  v_rsq_f32 v226, v226
  v_mfma_f32_16x16x32_bf16 v[196:199], v[220:223], a[20:23], v[196:199]
  v_mul_f32 v226, 0x3dd53b95, v226
  s_mov_b32 s57, 0x9000
  buffer_load_dwordx4 a[0:3], v1, s[8:11], s57 offen offset:384 nt
  buffer_load_dwordx4 a[4:7], v1, s[8:11], s57 offen offset:512 nt
  buffer_load_dwordx4 a[8:11], v1, s[8:11], s57 offen offset:640 nt
  v_mfma_f32_16x16x32_bf16 v[200:203], v[212:215], a[24:27], 0
  v_mfma_f32_16x16x32_bf16 v[204:207], v[212:215], a[36:39], 0
  v_mfma_f32_16x16x32_bf16 v[200:203], v[216:219], a[28:31], v[200:203]
  v_mov_b32_dpp v208, v192 quad_perm:[0,0,0,0] row_mask:0xf bank_mask:0xf
  v_mov_b32_dpp v224, v196 quad_perm:[0,0,0,0] row_mask:0xf bank_mask:0xf
  v_mfma_f32_16x16x32_bf16 v[204:207], v[216:219], a[40:43], v[204:207]
  v_add_f32_dpp v208, v193, v208 quad_perm:[1,1,1,1] row_mask:0xf bank_mask:0xf
  v_add_f32_dpp v224, v197, v224 quad_perm:[1,1,1,1] row_mask:0xf bank_mask:0xf
  v_mfma_f32_16x16x32_bf16 v[200:203], v[220:223], a[32:35], v[200:203]
  v_add_f32_dpp v208, v194, v208 quad_perm:[2,2,2,2] row_mask:0xf bank_mask:0xf
  v_add_f32_dpp v224, v198, v224 quad_perm:[2,2,2,2] row_mask:0xf bank_mask:0xf
  v_mfma_f32_16x16x32_bf16 v[204:207], v[220:223], a[44:47], v[204:207]
  v_add_f32_dpp v208, v195, v208 quad_perm:[3,3,3,3] row_mask:0xf bank_mask:0xf
  s_nop 1
  v_add_f32_dpp v208, v199, v224 quad_perm:[3,3,3,3] row_mask:0xc bank_mask:0xf
  s_mov_b32 s57, 0xa800
  buffer_load_dwordx4 a[12:15], v1, s[8:11], s57 offen offset:0 nt
  buffer_load_dwordx4 a[16:19], v1, s[8:11], s57 offen offset:128 nt
  buffer_load_dwordx4 a[20:23], v1, s[8:11], s57 offen offset:256 nt
  v_mfma_f32_16x16x32_bf16 v[192:195], v[212:215], a[48:51], 0
  v_mfma_f32_16x16x32_bf16 v[196:199], v[212:215], a[60:63], 0
  v_mfma_f32_16x16x32_bf16 v[192:195], v[216:219], a[52:55], v[192:195]
  v_mov_b32_dpp v209, v200 quad_perm:[0,0,0,0] row_mask:0xf bank_mask:0xf
  v_mov_b32_dpp v224, v204 quad_perm:[0,0,0,0] row_mask:0xf bank_mask:0xf
  v_mfma_f32_16x16x32_bf16 v[196:199], v[216:219], a[64:67], v[196:199]
  v_add_f32_dpp v209, v201, v209 quad_perm:[1,1,1,1] row_mask:0xf bank_mask:0xf
  v_add_f32_dpp v224, v205, v224 quad_perm:[1,1,1,1] row_mask:0xf bank_mask:0xf
  v_mfma_f32_16x16x32_bf16 v[192:195], v[220:223], a[56:59], v[192:195]
  v_add_f32_dpp v209, v202, v209 quad_perm:[2,2,2,2] row_mask:0xf bank_mask:0xf
  v_add_f32_dpp v224, v206, v224 quad_perm:[2,2,2,2] row_mask:0xf bank_mask:0xf
  v_mfma_f32_16x16x32_bf16 v[196:199], v[220:223], a[68:71], v[196:199]
  v_add_f32_dpp v209, v203, v209 quad_perm:[3,3,3,3] row_mask:0xf bank_mask:0xf
  s_nop 1
  v_add_f32_dpp v209, v207, v224 quad_perm:[3,3,3,3] row_mask:0xc bank_mask:0xf
  buffer_load_dwordx4 a[24:27], v1, s[8:11], s57 offen offset:384 nt
  buffer_load_dwordx4 a[28:31], v1, s[8:11], s57 offen offset:512 nt
  buffer_load_dwordx4 a[32:35], v1, s[8:11], s57 offen offset:640 nt
  v_mfma_f32_16x16x32_bf16 v[200:203], v[212:215], a[72:75], 0
  v_mfma_f32_16x16x32_bf16 v[204:207], v[212:215], a[84:87], 0
  v_mfma_f32_16x16x32_bf16 v[200:203], v[216:219], a[76:79], v[200:203]
  v_mov_b32_dpp v210, v192 quad_perm:[0,0,0,0] row_mask:0xf bank_mask:0xf
  v_mov_b32_dpp v224, v196 quad_perm:[0,0,0,0] row_mask:0xf bank_mask:0xf
  v_mfma_f32_16x16x32_bf16 v[204:207], v[216:219], a[88:91], v[204:207]
  v_add_f32_dpp v210, v193, v210 quad_perm:[1,1,1,1] row_mask:0xf bank_mask:0xf
  v_add_f32_dpp v224, v197, v224 quad_perm:[1,1,1,1] row_mask:0xf bank_mask:0xf
  v_mfma_f32_16x16x32_bf16 v[200:203], v[220:223], a[80:83], v[200:203]
  v_add_f32_dpp v210, v194, v210 quad_perm:[2,2,2,2] row_mask:0xf bank_mask:0xf
  v_add_f32_dpp v224, v198, v224 quad_perm:[2,2,2,2] row_mask:0xf bank_mask:0xf
  v_mfma_f32_16x16x32_bf16 v[204:207], v[220:223], a[92:95], v[204:207]
  v_add_f32_dpp v210, v195, v210 quad_perm:[3,3,3,3] row_mask:0xf bank_mask:0xf
  s_nop 1
  v_add_f32_dpp v210, v199, v224 quad_perm:[3,3,3,3] row_mask:0xc bank_mask:0xf
  v_mfma_f32_16x16x32_bf16 v[192:195], v[212:215], a[96:99], 0
  v_mfma_f32_16x16x32_bf16 v[196:199], v[212:215], a[108:111], 0
  v_mfma_f32_16x16x32_bf16 v[192:195], v[216:219], a[100:103], v[192:195]
  v_mov_b32_dpp v211, v200 quad_perm:[0,0,0,0] row_mask:0xf bank_mask:0xf
  v_mov_b32_dpp v224, v204 quad_perm:[0,0,0,0] row_mask:0xf bank_mask:0xf
  v_mfma_f32_16x16x32_bf16 v[196:199], v[216:219], a[112:115], v[196:199]
  v_add_f32_dpp v211, v201, v211 quad_perm:[1,1,1,1] row_mask:0xf bank_mask:0xf
  v_add_f32_dpp v224, v205, v224 quad_perm:[1,1,1,1] row_mask:0xf bank_mask:0xf
  v_mfma_f32_16x16x32_bf16 v[192:195], v[220:223], a[104:107], v[192:195]
  v_add_f32_dpp v211, v202, v211 quad_perm:[2,2,2,2] row_mask:0xf bank_mask:0xf
  v_add_f32_dpp v224, v206, v224 quad_perm:[2,2,2,2] row_mask:0xf bank_mask:0xf
  v_mfma_f32_16x16x32_bf16 v[196:199], v[220:223], a[116:119], v[196:199]
  v_add_f32_dpp v211, v203, v211 quad_perm:[3,3,3,3] row_mask:0xf bank_mask:0xf
  s_nop 1
  v_add_f32_dpp v211, v207, v224 quad_perm:[3,3,3,3] row_mask:0xc bank_mask:0xf
  s_mov_b32 s57, 0x3001800
  buffer_load_dwordx4 a[36:39], v4, s[4:7], s57 offen offset:256 nt
  buffer_load_dwordx4 a[40:43], v4, s[4:7], s57 offen offset:3072 nt
  v_mfma_f32_16x16x32_bf16 v[200:203], v[212:215], a[120:123], 0
  v_mfma_f32_16x16x32_bf16 v[204:207], v[212:215], a[132:135], 0
  v_mfma_f32_16x16x32_bf16 v[200:203], v[216:219], a[124:127], v[200:203]
  v_mov_b32_dpp v236, v192 quad_perm:[0,0,0,0] row_mask:0xf bank_mask:0xf
  v_mov_b32_dpp v224, v196 quad_perm:[0,0,0,0] row_mask:0xf bank_mask:0xf
  v_mfma_f32_16x16x32_bf16 v[204:207], v[216:219], a[136:139], v[204:207]
  v_add_f32_dpp v236, v193, v236 quad_perm:[1,1,1,1] row_mask:0xf bank_mask:0xf
  v_add_f32_dpp v224, v197, v224 quad_perm:[1,1,1,1] row_mask:0xf bank_mask:0xf
  v_mfma_f32_16x16x32_bf16 v[200:203], v[220:223], a[128:131], v[200:203]
  v_add_f32_dpp v236, v194, v236 quad_perm:[2,2,2,2] row_mask:0xf bank_mask:0xf
  v_add_f32_dpp v224, v198, v224 quad_perm:[2,2,2,2] row_mask:0xf bank_mask:0xf
  v_mfma_f32_16x16x32_bf16 v[204:207], v[220:223], a[140:143], v[204:207]
  v_add_f32_dpp v236, v195, v236 quad_perm:[3,3,3,3] row_mask:0xf bank_mask:0xf
  s_nop 1
  v_add_f32_dpp v236, v199, v224 quad_perm:[3,3,3,3] row_mask:0xc bank_mask:0xf
  v_mfma_f32_16x16x32_bf16 v[192:195], v[212:215], a[144:147], 0
  v_mfma_f32_16x16x32_bf16 v[196:199], v[212:215], a[156:159], 0
  v_mfma_f32_16x16x32_bf16 v[192:195], v[216:219], a[148:151], v[192:195]
  v_mov_b32_dpp v237, v200 quad_perm:[0,0,0,0] row_mask:0xf bank_mask:0xf
  v_mov_b32_dpp v224, v204 quad_perm:[0,0,0,0] row_mask:0xf bank_mask:0xf
  v_mfma_f32_16x16x32_bf16 v[196:199], v[216:219], a[160:163], v[196:199]
  v_add_f32_dpp v237, v201, v237 quad_perm:[1,1,1,1] row_mask:0xf bank_mask:0xf
  v_add_f32_dpp v224, v205, v224 quad_perm:[1,1,1,1] row_mask:0xf bank_mask:0xf
  v_mfma_f32_16x16x32_bf16 v[192:195], v[220:223], a[152:155], v[192:195]
  v_add_f32_dpp v237, v202, v237 quad_perm:[2,2,2,2] row_mask:0xf bank_mask:0xf
  v_add_f32_dpp v224, v206, v224 quad_perm:[2,2,2,2] row_mask:0xf bank_mask:0xf
  v_mfma_f32_16x16x32_bf16 v[196:199], v[220:223], a[164:167], v[196:199]
  v_add_f32_dpp v237, v203, v237 quad_perm:[3,3,3,3] row_mask:0xf bank_mask:0xf
  s_nop 1
  v_add_f32_dpp v237, v207, v224 quad_perm:[3,3,3,3] row_mask:0xc bank_mask:0xf
  buffer_load_dwordx4 a[44:47], v4, s[4:7], s57 offen offset:3200 nt
  buffer_load_dwordx4 a[48:51], v4, s[4:7], s57 offen offset:3328 nt
  v_mfma_f32_16x16x32_bf16 v[200:203], v[212:215], a[168:171], 0
  v_mfma_f32_16x16x32_bf16 v[204:207], v[212:215], a[180:183], 0
  v_mfma_f32_16x16x32_bf16 v[200:203], v[216:219], a[172:175], v[200:203]
  v_mov_b32_dpp v238, v192 quad_perm:[0,0,0,0] row_mask:0xf bank_mask:0xf
  v_mov_b32_dpp v224, v196 quad_perm:[0,0,0,0] row_mask:0xf bank_mask:0xf
  v_mfma_f32_16x16x32_bf16 v[204:207], v[216:219], a[184:187], v[204:207]
  v_add_f32_dpp v238, v193, v238 quad_perm:[1,1,1,1] row_mask:0xf bank_mask:0xf
  v_add_f32_dpp v224, v197, v224 quad_perm:[1,1,1,1] row_mask:0xf bank_mask:0xf
  v_mfma_f32_16x16x32_bf16 v[200:203], v[220:223], a[176:179], v[200:203]
  v_add_f32_dpp v238, v194, v238 quad_perm:[2,2,2,2] row_mask:0xf bank_mask:0xf
  v_add_f32_dpp v224, v198, v224 quad_perm:[2,2,2,2] row_mask:0xf bank_mask:0xf
  v_mfma_f32_16x16x32_bf16 v[204:207], v[220:223], a[188:191], v[204:207]
  v_add_f32_dpp v238, v195, v238 quad_perm:[3,3,3,3] row_mask:0xf bank_mask:0xf
  s_nop 1
  v_add_f32_dpp v238, v199, v224 quad_perm:[3,3,3,3] row_mask:0xc bank_mask:0xf
  s_nop 0
  v_mov_b32_dpp v239, v200 quad_perm:[0,0,0,0] row_mask:0xf bank_mask:0xf
  s_nop 1
  v_mov_b32_dpp v224, v204 quad_perm:[0,0,0,0] row_mask:0xf bank_mask:0xf
  v_add_f32_dpp v239, v201, v239 quad_perm:[1,1,1,1] row_mask:0xf bank_mask:0xf
  s_nop 0
  v_add_f32_dpp v224, v205, v224 quad_perm:[1,1,1,1] row_mask:0xf bank_mask:0xf
  v_add_f32_dpp v239, v202, v239 quad_perm:[2,2,2,2] row_mask:0xf bank_mask:0xf
  s_nop 0
  v_add_f32_dpp v224, v206, v224 quad_perm:[2,2,2,2] row_mask:0xf bank_mask:0xf
  v_add_f32_dpp v239, v203, v239 quad_perm:[3,3,3,3] row_mask:0xf bank_mask:0xf
  s_nop 1
  v_add_f32_dpp v239, v207, v224 quad_perm:[3,3,3,3] row_mask:0xc bank_mask:0xf
  v_max_f32 v224, v208, v209
  v_max3_f32 v224, v224, v210, v211
  v_max3_f32 v224, v224, v236, v237
  v_max3_f32 v224, v224, v238, v239
  s_nop 1
  v_max_f32_dpp v224, v224, v224 row_ror:4 row_mask:0xf bank_mask:0xf
  s_nop 1
  v_max_f32_dpp v224, v224, v224 row_ror:8 row_mask:0xf bank_mask:0xf
  s_nop 1
  v_max_f32_dpp v224, v224, v224 row_bcast:15 row_mask:0xa bank_mask:0xf
  s_nop 1
  v_max_f32_dpp v224, v224, v224 row_bcast:31 row_mask:0xc bank_mask:0xf
  s_nop 0
  v_readlane_b32 s58, v224, 63
  s_nop 1
  v_mul_f32_e64 v224, -s58, v226
  v_fma_f32 v208, v208, v226, v224
  v_fma_f32 v209, v209, v226, v224
  v_fma_f32 v210, v210, v226, v224
  v_fma_f32 v211, v211, v226, v224
  v_fma_f32 v236, v236, v226, v224
  v_fma_f32 v237, v237, v226, v224
  v_fma_f32 v238, v238, v226, v224
  v_fma_f32 v239, v239, v226, v224
  v_exp_f32 v208, v208
  v_exp_f32 v209, v209
  v_exp_f32 v210, v210
  v_exp_f32 v211, v211
  v_exp_f32 v236, v236
  v_exp_f32 v237, v237
  v_exp_f32 v238, v238
  v_exp_f32 v239, v239
  v_add_f32 v225, v208, v209
  v_add_f32 v225, v225, v210
  v_add_f32 v225, v225, v211
  v_add_f32 v225, v225, v236
  v_add_f32 v225, v225, v237
  v_add_f32 v225, v225, v238
  v_add_f32 v225, v225, v239
  v_cvt_pk_bf16_f32 v208, v208, v208
  v_cvt_pk_bf16_f32 v209, v209, v209
  v_cvt_pk_bf16_f32 v210, v210, v210
  v_cvt_pk_bf16_f32 v211, v211, v211
  v_cvt_pk_bf16_f32 v236, v236, v236
  v_cvt_pk_bf16_f32 v237, v237, v237
  v_cvt_pk_bf16_f32 v238, v238, v238
  v_cvt_pk_bf16_f32 v239, v239, v239
  v_and_b32 v194, v209, v230
  v_and_b32 v195, v209, v231
  v_and_b32_dpp v192, v209, v228 row_shl:4 row_mask:0xf bank_mask:0xf bound_ctrl:0
  v_and_b32_dpp v193, v209, v229 row_shl:4 row_mask:0xf bank_mask:0xf bound_ctrl:0
  ds_read_b128 a[52:55], v233 offset:0
  ds_read_b128 a[56:59], v233 offset:1024
  ds_read_b128 a[60:63], v233 offset:2048
  v_mfma_f32_16x16x32_bf16 v[196:199], a[192:195], v[192:195], 0
  v_and_b32 v200, v210, v228
  v_and_b32 v201, v210, v229
  v_mfma_f32_16x16x32_bf16 v[204:207], a[196:199], v[192:195], 0
  v_and_b32_dpp v202, v210, v230 row_shr:4 row_mask:0xf bank_mask:0xf bound_ctrl:0
  v_and_b32_dpp v203, v210, v231 row_shr:4 row_mask:0xf bank_mask:0xf bound_ctrl:0
  v_add_f32_dpp v225, v225, v225 row_ror:4 row_mask:0xf bank_mask:0xf
  v_mfma_f32_16x16x32_bf16 v[212:215], a[200:203], v[192:195], 0
  s_nop 0
  v_add_f32_dpp v225, v225, v225 row_ror:8 row_mask:0xf bank_mask:0xf
  ds_read_b128 a[64:67], v233 offset:3072
  ds_read_b128 a[68:71], v233 offset:4096
  ds_read_b128 a[72:75], v233 offset:5120
  v_mfma_f32_16x16x32_bf16 v[196:199], a[204:207], v[200:203], v[196:199]
  v_and_b32 v194, v210, v230
  v_and_b32 v195, v210, v231
  v_mfma_f32_16x16x32_bf16 v[204:207], a[208:211], v[200:203], v[204:207]
  v_and_b32_dpp v192, v210, v228 row_shl:4 row_mask:0xf bank_mask:0xf bound_ctrl:0
  v_and_b32_dpp v193, v210, v229 row_shl:4 row_mask:0xf bank_mask:0xf bound_ctrl:0
  v_add_f32_dpp v225, v225, v225 row_bcast:15 row_mask:0xa bank_mask:0xf
  v_mfma_f32_16x16x32_bf16 v[212:215], a[212:215], v[200:203], v[212:215]
  s_nop 0
  v_add_f32_dpp v225, v225, v225 row_bcast:31 row_mask:0xc bank_mask:0xf
  ds_read_b128 a[76:79], v233 offset:6144
  ds_read_b128 a[80:83], v233 offset:7168
  ds_read_b128 a[84:87], v233 offset:8192
  v_mfma_f32_16x16x32_bf16 v[196:199], a[216:219], v[192:195], v[196:199]
  v_and_b32 v200, v208, v228
  v_and_b32 v201, v208, v229
  v_mfma_f32_16x16x32_bf16 v[204:207], a[220:223], v[192:195], v[204:207]
  v_and_b32_dpp v202, v208, v230 row_shr:4 row_mask:0xf bank_mask:0xf bound_ctrl:0
  v_and_b32_dpp v203, v208, v231 row_shr:4 row_mask:0xf bank_mask:0xf bound_ctrl:0
  v_mfma_f32_16x16x32_bf16 v[212:215], a[224:227], v[192:195], v[212:215]
  s_mov_b32 exec_lo, 0x0
  s_mov_b32 exec_hi, 0x80000000
  ds_write_b64 v235, v[224:225]
  s_mov_b64 exec, -1
  s_mov_b32 s57, 0x3003000
  buffer_load_dwordx4 a[88:91], v4, s[4:7], s57 offen offset:0 nt
  buffer_load_dwordx4 a[92:95], v4, s[4:7], s57 offen offset:128 nt
  s_waitcnt lgkmcnt(7)
  v_mfma_f32_16x16x32_bf16 v[196:199], a[52:55], v[200:203], v[196:199]
  v_and_b32 v194, v208, v230
  v_and_b32 v195, v208, v231
  v_mfma_f32_16x16x32_bf16 v[204:207], a[56:59], v[200:203], v[204:207]
  v_and_b32_dpp v192, v208, v228 row_shl:4 row_mask:0xf bank_mask:0xf bound_ctrl:0
  v_and_b32_dpp v193, v208, v229 row_shl:4 row_mask:0xf bank_mask:0xf bound_ctrl:0
  v_mfma_f32_16x16x32_bf16 v[212:215], a[60:63], v[200:203], v[212:215]
  s_waitcnt lgkmcnt(4)
  v_mfma_f32_16x16x32_bf16 v[196:199], a[64:67], v[192:195], v[196:199]
  v_and_b32 v200, v209, v228
  v_and_b32 v201, v209, v229
  v_mfma_f32_16x16x32_bf16 v[204:207], a[68:71], v[192:195], v[204:207]
  v_and_b32_dpp v202, v209, v230 row_shr:4 row_mask:0xf bank_mask:0xf bound_ctrl:0
  v_and_b32_dpp v203, v209, v231 row_shr:4 row_mask:0xf bank_mask:0xf bound_ctrl:0
  v_mfma_f32_16x16x32_bf16 v[212:215], a[72:75], v[192:195], v[212:215]
  s_waitcnt lgkmcnt(1)
  v_mfma_f32_16x16x32_bf16 v[196:199], a[76:79], v[200:203], v[196:199]
  v_and_b32 v192, v211, v228
  v_and_b32 v193, v211, v229
  v_mfma_f32_16x16x32_bf16 v[204:207], a[80:83], v[200:203], v[204:207]
  v_and_b32_dpp v194, v211, v230 row_shr:4 row_mask:0xf bank_mask:0xf bound_ctrl:0
  v_and_b32_dpp v195, v211, v231 row_shr:4 row_mask:0xf bank_mask:0xf bound_ctrl:0
  v_mfma_f32_16x16x32_bf16 v[212:215], a[84:87], v[200:203], v[212:215]
  s_nop 0
  v_mfma_f32_16x16x32_bf16 v[196:199], a[228:231], v[192:195], v[196:199]
  v_and_b32 v202, v211, v230
  v_and_b32 v203, v211, v231
  v_mfma_f32_16x16x32_bf16 v[204:207], a[232:235], v[192:195], v[204:207]
  v_and_b32_dpp v200, v211, v228 row_shl:4 row_mask:0xf bank_mask:0xf bound_ctrl:0
  v_and_b32_dpp v201, v211, v229 row_shl:4 row_mask:0xf bank_mask:0xf bound_ctrl:0
  v_mfma_f32_16x16x32_bf16 v[212:215], a[236:239], v[192:195], v[212:215]
  buffer_load_dwordx4 a[52:55], v4, s[4:7], s57 offen offset:256 nt
  buffer_load_dwordx4 a[56:59], v4, s[4:7], s57 offen offset:3072 nt
  v_mfma_f32_16x16x32_bf16 v[196:199], a[240:243], v[200:203], v[196:199]
  v_and_b32 v192, v236, v228
  v_and_b32 v193, v236, v229
  v_mfma_f32_16x16x32_bf16 v[204:207], a[244:247], v[200:203], v[204:207]
  v_and_b32_dpp v194, v236, v230 row_shr:4 row_mask:0xf bank_mask:0xf bound_ctrl:0
  v_and_b32_dpp v195, v236, v231 row_shr:4 row_mask:0xf bank_mask:0xf bound_ctrl:0
  v_mfma_f32_16x16x32_bf16 v[212:215], a[248:251], v[200:203], v[212:215]
  s_nop 0
  v_mfma_f32_16x16x32_bf16 v[196:199], a[252:255], v[192:195], v[196:199]
  v_and_b32 v202, v236, v230
  v_and_b32 v203, v236, v231
  v_mfma_f32_16x16x32_bf16 v[204:207], v[24:27], v[192:195], v[204:207]
  v_and_b32_dpp v200, v236, v228 row_shl:4 row_mask:0xf bank_mask:0xf bound_ctrl:0
  v_and_b32_dpp v201, v236, v229 row_shl:4 row_mask:0xf bank_mask:0xf bound_ctrl:0
  v_mfma_f32_16x16x32_bf16 v[212:215], v[28:31], v[192:195], v[212:215]
  s_nop 0
  v_mfma_f32_16x16x32_bf16 v[196:199], v[32:35], v[200:203], v[196:199]
  v_and_b32 v24, v237, v228
  v_and_b32 v25, v237, v229
  v_mfma_f32_16x16x32_bf16 v[204:207], v[36:39], v[200:203], v[204:207]
  v_and_b32_dpp v26, v237, v230 row_shr:4 row_mask:0xf bank_mask:0xf bound_ctrl:0
  v_and_b32_dpp v27, v237, v231 row_shr:4 row_mask:0xf bank_mask:0xf bound_ctrl:0
  v_mfma_f32_16x16x32_bf16 v[212:215], v[40:43], v[200:203], v[212:215]
  s_nop 0
  v_mfma_f32_16x16x32_bf16 v[196:199], v[44:47], v[24:27], v[196:199]
  v_and_b32 v30, v237, v230
  v_and_b32 v31, v237, v231
  v_mfma_f32_16x16x32_bf16 v[204:207], v[48:51], v[24:27], v[204:207]
  v_and_b32_dpp v28, v237, v228 row_shl:4 row_mask:0xf bank_mask:0xf bound_ctrl:0
  v_and_b32_dpp v29, v237, v229 row_shl:4 row_mask:0xf bank_mask:0xf bound_ctrl:0
  v_mfma_f32_16x16x32_bf16 v[212:215], v[52:55], v[24:27], v[212:215]
  buffer_load_dwordx4 a[60:63], v4, s[4:7], s57 offen offset:3200 nt
  buffer_load_dwordx4 a[64:67], v4, s[4:7], s57 offen offset:3328 nt
  v_mfma_f32_16x16x32_bf16 v[196:199], v[56:59], v[28:31], v[196:199]
  v_and_b32 v24, v238, v228
  v_and_b32 v25, v238, v229
  v_mfma_f32_16x16x32_bf16 v[204:207], v[68:71], v[28:31], v[204:207]
  v_and_b32_dpp v26, v238, v230 row_shr:4 row_mask:0xf bank_mask:0xf bound_ctrl:0
  v_and_b32_dpp v27, v238, v231 row_shr:4 row_mask:0xf bank_mask:0xf bound_ctrl:0
  v_mfma_f32_16x16x32_bf16 v[212:215], v[60:63], v[28:31], v[212:215]
  s_nop 0
  v_mfma_f32_16x16x32_bf16 v[196:199], v[72:75], v[24:27], v[196:199]
  v_and_b32 v30, v238, v230
  v_and_b32 v31, v238, v231
  v_mfma_f32_16x16x32_bf16 v[204:207], v[64:67], v[24:27], v[204:207]
  v_and_b32_dpp v28, v238, v228 row_shl:4 row_mask:0xf bank_mask:0xf bound_ctrl:0
  v_and_b32_dpp v29, v238, v229 row_shl:4 row_mask:0xf bank_mask:0xf bound_ctrl:0
  v_mfma_f32_16x16x32_bf16 v[212:215], v[76:79], v[24:27], v[212:215]
  s_waitcnt vmcnt(16)
  v_mfma_f32_16x16x32_bf16 v[196:199], a[0:3], v[28:31], v[196:199]
  v_and_b32 v24, v239, v228
  v_and_b32 v25, v239, v229
  v_mfma_f32_16x16x32_bf16 v[204:207], a[4:7], v[28:31], v[204:207]
  v_and_b32_dpp v26, v239, v230 row_shr:4 row_mask:0xf bank_mask:0xf bound_ctrl:0
  v_and_b32_dpp v27, v239, v231 row_shr:4 row_mask:0xf bank_mask:0xf bound_ctrl:0
  v_mfma_f32_16x16x32_bf16 v[212:215], a[8:11], v[28:31], v[212:215]
  s_waitcnt vmcnt(13)
  v_mfma_f32_16x16x32_bf16 v[196:199], a[12:15], v[24:27], v[196:199]
  v_and_b32 v30, v239, v230
  v_and_b32 v31, v239, v231
  v_mfma_f32_16x16x32_bf16 v[204:207], a[16:19], v[24:27], v[204:207]
  v_and_b32_dpp v28, v239, v228 row_shl:4 row_mask:0xf bank_mask:0xf bound_ctrl:0
  v_and_b32_dpp v29, v239, v229 row_shl:4 row_mask:0xf bank_mask:0xf bound_ctrl:0
  v_mfma_f32_16x16x32_bf16 v[212:215], a[20:23], v[24:27], v[212:215]
  s_waitcnt vmcnt(10)
  v_mfma_f32_16x16x32_bf16 v[196:199], a[24:27], v[28:31], v[196:199]
  v_mfma_f32_16x16x32_bf16 v[204:207], a[28:31], v[28:31], v[204:207]
  v_mfma_f32_16x16x32_bf16 v[212:215], a[32:35], v[28:31], v[212:215]
  v_mov_b32 v24, 162816
  v_add_u32 v25, 159744, v5
  s_add_u32 s73, s64, 524288
  s_nop 2
  v_permlane32_swap_b32 v196, v197
  v_permlane32_swap_b32 v198, v199
  v_permlane32_swap_b32 v204, v205
  v_permlane32_swap_b32 v206, v207
  v_permlane32_swap_b32 v212, v213
  v_permlane32_swap_b32 v214, v215
  v_add_f32_dpp v28, v197, v196 row_shl:8 row_mask:0xf bank_mask:0x3
  v_add_f32_dpp v29, v205, v204 row_shl:8 row_mask:0xf bank_mask:0x3
  v_add_f32_dpp v30, v213, v212 row_shl:8 row_mask:0xf bank_mask:0x3
  v_add_f32_dpp v28, v198, v199 row_shr:8 row_mask:0xf bank_mask:0xc
  v_add_f32_dpp v29, v206, v207 row_shr:8 row_mask:0xf bank_mask:0xc
  v_add_f32_dpp v30, v214, v215 row_shr:8 row_mask:0xf bank_mask:0xc
  ds_write_b32 v232, v28 offset:0
  ds_write_b32 v232, v29 offset:256
  ds_write_b32 v232, v30 offset:512
  s_waitcnt lgkmcnt(0)
  s_barrier
  s_cmp_eq_u32 s56, 3
  s_cbranch_scc0 L_w_75
  ds_read_b128 v[28:31], v24
  ds_read_b128 v[32:35], v24 offset:16
  ds_read_b128 v[36:39], v25 offset:0
  ds_read_b128 v[40:43], v25 offset:768
  ds_read_b128 v[44:47], v25 offset:1536
  ds_read_b128 v[48:51], v25 offset:2304
  s_mov_b32 vcc_lo, 0
  s_mov_b32 vcc_hi, 0xffff0000
  s_mov_b32 exec_hi, 0x1ffff
  s_waitcnt lgkmcnt(4)
  v_min3_f32 v24, v28, v30, v32
  v_min_f32 v24, v24, v34
  v_sub_f32 v28, v24, v28
  v_sub_f32 v30, v24, v30
  v_sub_f32 v32, v24, v32
  v_sub_f32 v34, v24, v34
  v_exp_f32 v28, v28
  v_exp_f32 v30, v30
  v_exp_f32 v32, v32
  v_exp_f32 v34, v34
  s_waitcnt lgkmcnt(0)
  v_pk_mul_f32 v[36:37], v[36:37], v[28:29] op_sel_hi:[1,0]
  v_pk_mul_f32 v[38:39], v[38:39], v[28:29] op_sel_hi:[1,0]
  v_mul_f32 v29, v28, v29
  v_pk_mul_f32 v[44:45], v[44:45], v[32:33] op_sel_hi:[1,0]
  v_pk_mul_f32 v[46:47], v[46:47], v[32:33] op_sel_hi:[1,0]
  v_mul_f32 v33, v32, v33
  v_pk_fma_f32 v[36:37], v[40:41], v[30:31], v[36:37] op_sel_hi:[1,0,1]
  v_pk_fma_f32 v[38:39], v[42:43], v[30:31], v[38:39] op_sel_hi:[1,0,1]
  v_fmac_f32 v29, v30, v31
  v_pk_fma_f32 v[44:45], v[48:49], v[34:35], v[44:45] op_sel_hi:[1,0,1]
  v_pk_fma_f32 v[46:47], v[50:51], v[34:35], v[46:47] op_sel_hi:[1,0,1]
  v_fmac_f32 v33, v34, v35
  v_pk_add_f32 v[36:37], v[36:37], v[44:45]
  v_pk_add_f32 v[38:39], v[38:39], v[46:47]
  v_add_f32 v25, v29, v33
  v_cvt_pk_bf16_f32 v40, v36, v37
  v_cvt_pk_bf16_f32 v41, v38, v39
  v_cndmask_b32 v40, v40, v24, vcc
  v_cndmask_b32 v41, v41, v25, vcc
  s_cmp_eq_u32 s75, 0
  s_cbranch_scc1 L_slow_76
  buffer_store_dwordx2 v[40:41], v234, s[36:39], s73 offen
  s_branch L_pub_77
L_slow_76:
  buffer_store_dwordx2 v[40:41], v234, s[36:39], s73 offen sc1
L_pub_77:
  s_mov_b64 exec, -1
L_w_75:
  s_waitcnt vmcnt(7)
  s_mov_b32 s57, 0x3004800
  buffer_load_dwordx4 a[0:3], v4, s[4:7], s57 offen offset:0 nt
  s_waitcnt vmcnt(7)
  buffer_load_dwordx4 a[4:7], v4, s[4:7], s57 offen offset:128 nt
  s_waitcnt vmcnt(7)
  buffer_load_dwordx4 a[8:11], v4, s[4:7], s57 offen offset:256 nt
  s_waitcnt vmcnt(7)
  buffer_load_dwordx4 a[12:15], v4, s[4:7], s57 offen offset:3072 nt
  s_waitcnt vmcnt(7)
  buffer_load_dwordx4 a[16:19], v4, s[4:7], s57 offen offset:3200 nt
  s_waitcnt vmcnt(7)
  buffer_load_dwordx4 a[20:23], v4, s[4:7], s57 offen offset:3328 nt
  s_waitcnt vmcnt(7)
  s_mov_b32 s57, 0x3006000
  buffer_load_dwordx4 a[24:27], v4, s[4:7], s57 offen offset:0 nt
  s_waitcnt vmcnt(6)
  buffer_load_dwordx4 a[28:31], v4, s[4:7], s57 offen offset:128 nt
  s_waitcnt vmcnt(6)
  buffer_load_dwordx4 a[32:35], v4, s[4:7], s57 offen offset:256 nt
  s_waitcnt vmcnt(6)
  buffer_load_dwordx4 a[68:71], v4, s[4:7], s57 offen offset:3072 nt
  s_waitcnt vmcnt(6)
  buffer_load_dwordx4 a[72:75], v4, s[4:7], s57 offen offset:3200 nt
  s_waitcnt vmcnt(6)
  buffer_load_dwordx4 a[76:79], v4, s[4:7], s57 offen offset:3328 nt
  s_waitcnt vmcnt(6)
  s_mov_b32 s57, 0x3007800
  buffer_load_dwordx4 a[80:83], v4, s[4:7], s57 offen offset:0 nt
  s_waitcnt vmcnt(6)
  buffer_load_dwordx4 a[84:87], v4, s[4:7], s57 offen offset:128 nt
  v_and_b32 v24, 0x70, v5
  s_cmp_lt_u32 s56, 3
  s_cbranch_scc0 L_w_78
  s_add_u32 s73, s65, 524288
  buffer_load_dwordx2 v[28:29], v24, s[36:39], s73 offen offset:3072 sc1
  buffer_load_dwordx4 v[32:35], v5, s[36:39], s73 offen offset:0 sc1
  buffer_load_dwordx4 v[36:39], v5, s[36:39], s73 offen offset:1024 sc1
  buffer_load_dwordx4 v[40:43], v5, s[36:39], s73 offen offset:2048 sc1
  s_mov_b64 exec, -1
L_w_78:
  s_waitcnt vmcnt(10)
  s_mov_b32 s57, 0x3007800
  buffer_load_dwordx4 a[96:99], v4, s[4:7], s57 offen offset:256 nt
  s_waitcnt vmcnt(10)
  buffer_load_dwordx4 a[100:103], v4, s[4:7], s57 offen offset:3072 nt
  s_waitcnt vmcnt(10)
  buffer_load_dwordx4 a[104:107], v4, s[4:7], s57 offen offset:3200 nt
  s_waitcnt vmcnt(10)
  buffer_load_dwordx4 a[108:111], v4, s[4:7], s57 offen offset:3328 nt
  s_waitcnt vmcnt(10)
  s_mov_b32 s57, 0x3009000
  buffer_load_dwordx4 a[112:115], v4, s[4:7], s57 offen offset:0 nt
  s_waitcnt vmcnt(10)
  buffer_load_dwordx4 a[116:119], v4, s[4:7], s57 offen offset:128 nt
  s_waitcnt vmcnt(10)
  buffer_load_dwordx4 a[120:123], v4, s[4:7], s57 offen offset:256 nt
  s_waitcnt vmcnt(6)
  buffer_load_dwordx4 a[124:127], v4, s[4:7], s57 offen offset:3072 nt
  v_lshrrev_b32 v25, 8, v5
  v_bfe_u32 v26, v5, 7, 1
  v_mul_u32_u24 v26, 192, v26
  v_lshl_add_u32 v25, v25, 4, v26
  v_lshrrev_b32 v26, 6, v5
  v_mul_u32_u24 v26, 160, v26
  v_bfe_u32 v27, v5, 4, 2
  v_lshl_add_u32 v26, v27, 3, v26
  s_lshl_b32 s58, s56, 5
  s_add_u32 s58, s58, 30720
  v_add_u32 v26, s58, v26
  s_cmp_lt_u32 s56, 3
  s_cbranch_scc0 L_w_79
  ds_read_b64_tr_b16 v[44:45], v26 offset:0
  ds_read_b64_tr_b16 v[46:47], v26 offset:2560
  ds_read_b64_tr_b16 v[48:49], v26 offset:5120
  ds_read_b64_tr_b16 v[50:51], v26 offset:7680
  ds_read_b64_tr_b16 v[52:53], v26 offset:10240
  ds_read_b64_tr_b16 v[54:55], v26 offset:12800
  ds_read_b64_tr_b16 v[56:57], v26 offset:15360
  ds_read_b64_tr_b16 v[58:59], v26 offset:17920
  ds_read_b64_tr_b16 v[60:61], v26 offset:20480
  ds_read_b64_tr_b16 v[62:63], v26 offset:23040
  ds_read_b64_tr_b16 v[64:65], v26 offset:25600
  ds_read_b64_tr_b16 v[66:67], v26 offset:28160
  ds_read_b64_tr_b16 v[68:69], v26 offset:96
  ds_read_b64_tr_b16 v[70:71], v26 offset:2656
  ds_read_b64_tr_b16 v[72:73], v26 offset:5216
  ds_read_b64_tr_b16 v[74:75], v26 offset:7776
  ds_read_b64_tr_b16 v[76:77], v26 offset:10336
  ds_read_b64_tr_b16 v[78:79], v26 offset:12896
  ds_read_b64_tr_b16 v[192:193], v26 offset:15456
  ds_read_b64_tr_b16 v[194:195], v26 offset:18016
  ds_read_b64_tr_b16 v[196:197], v26 offset:20576
  ds_read_b64_tr_b16 v[198:199], v26 offset:23136
  ds_read_b64_tr_b16 v[200:201], v26 offset:25696
  ds_read_b64_tr_b16 v[202:203], v26 offset:28256
L_w_79:
  s_lshl_b32 s58, s56, 6
  s_add_u32 s74, s66, s58
  s_add_u32 s74, s74, 524288
  s_cmp_lt_u32 s56, 3
  s_cbranch_scc0 L_w_80
  s_mov_b32 s72, 0
  s_waitcnt vmcnt(8)
L_chk_81:
  v_max3_u32 v30, v28, v29, v32
  v_max3_u32 v31, v33, v34, v35
  v_max3_u32 v30, v30, v36, v37
  v_max3_u32 v31, v31, v38, v39
  v_max3_u32 v30, v30, v40, v41
  v_max3_u32 v31, v31, v42, v43
  v_max_u32 v30, v30, v31
  v_cmp_eq_u32 vcc, -1, v30
  s_cbranch_vccz L_ok_82
  s_add_u32 s72, s72, 1
  s_cmp_ge_u32 s72, 65536
  s_cbranch_scc1 L_ok_82
  s_add_u32 s73, s65, 524288
  buffer_load_dwordx2 v[28:29], v24, s[36:39], s73 offen offset:3072 sc1
  buffer_load_dwordx4 v[32:35], v5, s[36:39], s73 offen offset:0 sc1
  buffer_load_dwordx4 v[36:39], v5, s[36:39], s73 offen offset:1024 sc1
  buffer_load_dwordx4 v[40:43], v5, s[36:39], s73 offen offset:2048 sc1
  s_waitcnt vmcnt(0)
  s_branch L_chk_81
L_ok_82:
  s_waitcnt lgkmcnt(0)
  v_mfma_f32_16x16x32_bf16 v[204:207], v[44:47], v[32:35], 0
  v_min_f32_dpp v30, v28, v28 quad_perm:[1,0,3,2] row_mask:0xf bank_mask:0xf
  v_mfma_f32_16x16x32_bf16 v[44:47], v[48:51], v[32:35], 0
  s_nop 0
  v_min_f32_dpp v30, v30, v30 quad_perm:[2,3,0,1] row_mask:0xf bank_mask:0xf
  v_mfma_f32_16x16x32_bf16 v[204:207], v[52:55], v[36:39], v[204:207]
  s_nop 0
  v_min_f32_dpp v30, v30, v30 row_half_mirror row_mask:0xf bank_mask:0xf
  v_mfma_f32_16x16x32_bf16 v[44:47], v[56:59], v[36:39], v[44:47]
  v_sub_f32 v28, v30, v28
  v_exp_f32 v28, v28
  v_mfma_f32_16x16x32_bf16 v[204:207], v[60:63], v[40:43], v[204:207]
  v_mul_f32 v29, v28, v29
  v_mfma_f32_16x16x32_bf16 v[44:47], v[64:67], v[40:43], v[44:47]
  s_nop 0
  v_add_f32_dpp v29, v29, v29 quad_perm:[1,0,3,2] row_mask:0xf bank_mask:0xf
  v_mfma_f32_16x16x32_bf16 v[48:51], v[68:71], v[32:35], 0
  s_nop 0
  v_add_f32_dpp v29, v29, v29 quad_perm:[2,3,0,1] row_mask:0xf bank_mask:0xf
  v_mfma_f32_16x16x32_bf16 v[52:55], v[72:75], v[32:35], 0
  s_nop 0
  v_add_f32_dpp v29, v29, v29 row_half_mirror row_mask:0xf bank_mask:0xf
  v_mfma_f32_16x16x32_bf16 v[48:51], v[76:79], v[36:39], v[48:51]
  v_rcp_f32 v29, v29
  s_nop 0
  v_mul_f32 v28, v28, v29
  v_mfma_f32_16x16x32_bf16 v[52:55], v[192:195], v[36:39], v[52:55]
  v_add_f32_dpp v32, v44, v204 row_shl:8 row_mask:0xf bank_mask:0x3
  v_add_f32_dpp v33, v45, v205 row_shl:8 row_mask:0xf bank_mask:0x3
  v_mfma_f32_16x16x32_bf16 v[48:51], v[196:199], v[40:43], v[48:51]
  v_add_f32_dpp v34, v46, v206 row_shl:8 row_mask:0xf bank_mask:0x3
  v_add_f32_dpp v35, v47, v207 row_shl:8 row_mask:0xf bank_mask:0x3
  v_mfma_f32_16x16x32_bf16 v[52:55], v[200:203], v[40:43], v[52:55]
  s_cmp_lt_u32 s56, 2
  s_mov_b32 s58, 0x00010001
  s_cselect_b32 s58, 0x01010101, s58
  s_nop 4
  v_add_f32_dpp v32, v48, v52 row_shr:8 row_mask:0xf bank_mask:0xc
  v_add_f32_dpp v33, v49, v53 row_shr:8 row_mask:0xf bank_mask:0xc
  v_add_f32_dpp v34, v50, v54 row_shr:8 row_mask:0xf bank_mask:0xc
  v_add_f32_dpp v35, v51, v55 row_shr:8 row_mask:0xf bank_mask:0xc
  v_mul_f32 v32, v28, v32
  v_mul_f32 v33, v28, v33
  v_mul_f32 v34, v28, v34
  v_mul_f32 v35, v28, v35
  v_add_f32_dpp v32, v32, v32 quad_perm:[1,0,3,2] row_mask:0xf bank_mask:0xf
  v_add_f32_dpp v33, v33, v33 quad_perm:[1,0,3,2] row_mask:0xf bank_mask:0xf
  v_add_f32_dpp v34, v34, v34 quad_perm:[1,0,3,2] row_mask:0xf bank_mask:0xf
  v_add_f32_dpp v35, v35, v35 quad_perm:[1,0,3,2] row_mask:0xf bank_mask:0xf
  v_add_f32_dpp v32, v32, v32 quad_perm:[2,3,0,1] row_mask:0xf bank_mask:0xf
  v_add_f32_dpp v33, v33, v33 quad_perm:[2,3,0,1] row_mask:0xf bank_mask:0xf
  v_add_f32_dpp v34, v34, v34 quad_perm:[2,3,0,1] row_mask:0xf bank_mask:0xf
  v_add_f32_dpp v35, v35, v35 quad_perm:[2,3,0,1] row_mask:0xf bank_mask:0xf
  v_add_f32_dpp v32, v32, v32 row_half_mirror row_mask:0xf bank_mask:0xf
  v_add_f32_dpp v33, v33, v33 row_half_mirror row_mask:0xf bank_mask:0xf
  v_add_f32_dpp v34, v34, v34 row_half_mirror row_mask:0xf bank_mask:0xf
  v_add_f32_dpp v35, v35, v35 row_half_mirror row_mask:0xf bank_mask:0xf
  s_mov_b32 exec_lo, s58
  s_mov_b32 exec_hi, s58
  buffer_store_dwordx4 v[32:35], v25, s[36:39], s74 offen sc1
  s_mov_b64 exec, -1
L_w_80:
  s_barrier
  v_lshrrev_b32 v25, 2, v5
  s_lshl_b32 s73, s56, 8
  s_add_u32 s73, s73, s70
  s_add_u32 s73, s73, 262144
  buffer_load_dword v24, v25, s[36:39], s73 offen sc1
  v_lshlrev_b32 v26, 3, v5
  s_add_u32 s58, s68, 2359296
  s_add_u32 s59, s77, 786432
  s_cmp_eq_u32 s56, 1
  s_cselect_b32 s58, s59, s58
  s_mov_b32 exec_lo, 0x7f
  s_mov_b32 exec_hi, 0x0
  buffer_load_dword v27, v26, s[36:39], s58 offen sc1
  s_mov_b64 exec, -1
  s_waitcnt vmcnt(9)
  s_mov_b32 s57, 0x3009000
  buffer_load_dwordx4 a[128:131], v4, s[4:7], s57 offen offset:3200 nt
  s_waitcnt vmcnt(9)
  buffer_load_dwordx4 a[132:135], v4, s[4:7], s57 offen offset:3328 nt
  s_waitcnt vmcnt(9)
  s_mov_b32 s57, 0x300a800
  buffer_load_dwordx4 a[136:139], v4, s[4:7], s57 offen offset:0 nt
  s_waitcnt vmcnt(9)
  buffer_load_dwordx4 a[140:143], v4, s[4:7], s57 offen offset:128 nt
  s_waitcnt vmcnt(9)
  buffer_load_dwordx4 a[144:147], v4, s[4:7], s57 offen offset:256 nt
  s_waitcnt vmcnt(9)
  buffer_load_dwordx4 a[148:151], v4, s[4:7], s57 offen offset:3072 nt
  s_waitcnt vmcnt(9)
  buffer_load_dwordx4 a[152:155], v4, s[4:7], s57 offen offset:3200 nt
  s_waitcnt vmcnt(6)
  buffer_load_dwordx4 a[156:159], v4, s[4:7], s57 offen offset:3328 nt
  s_waitcnt vmcnt(6)
  s_add_u32 m0, s71, 0
  s_mov_b32 s57, 0x3000000
  buffer_load_dwordx4 v1, s[8:11], s57 offen offset:0 nt lds
  s_waitcnt vmcnt(6)
  s_add_u32 m0, s71, 896
  s_nop 0
  buffer_load_dwordx4 v1, s[8:11], s57 offen offset:128 nt lds
  s_waitcnt vmcnt(6)
  s_add_u32 m0, s71, 1792
  s_nop 0
  buffer_load_dwordx4 v1, s[8:11], s57 offen offset:256 nt lds
  s_waitcnt vmcnt(6)
  s_add_u32 m0, s71, 2688
  s_nop 0
  buffer_load_dwordx4 v1, s[8:11], s57 offen offset:384 nt lds
  s_waitcnt vmcnt(6)
  s_add_u32 m0, s71, 3584
  s_nop 0
  buffer_load_dwordx4 v1, s[8:11], s57 offen offset:512 nt lds
  s_waitcnt vmcnt(6)
  s_add_u32 m0, s71, 4480
  s_nop 0
  buffer_load_dwordx4 v1, s[8:11], s57 offen offset:640 nt lds
  v_bfe_u32 v28, v5, 5, 3
  v_add_u32 v29, -1, v28
  v_and_b32 v29, 3, v29
  v_add_u32 v29, 1, v29
  v_min_u32 v28, v29, v28
  v_lshrrev_b32 v29, 8, v5
  v_lshl_add_u32 v28, v28, 2, v29
  v_mul_u32_u24 v28, 16, v28
  v_add_u32 v28, 159744, v28
  v_and_b32 v29, 0x1f0, v5
  v_lshrrev_b32 v30, 9, v5
  v_lshl_add_u32 v29, v30, 2, v29
  s_mul_i32 s58, s56, 320
  s_add_u32 s58, s58, 159744
  v_add_u32 v29, s58, v29
  v_lshrrev_b32 v30, 9, v5
  v_mul_u32_u24 v30, 3072, v30
  v_bfe_u32 v31, v5, 6, 3
  v_lshl_add_u32 v30, v31, 7, v30
  v_bfe_u32 v31, v5, 4, 2
  v_lshl_add_u32 v30, v31, 3, v30
  s_max_u32 s58, s56, 1
  s_lshl_b32 s58, s58, 10
  s_add_u32 s58, s58, 0xec00
  v_add_u32 v30, s58, v30
  v_bfe_u32 v31, v5, 7, 2
  v_lshl_add_u32 v32, v31, 5, v30
  v_xor_b32 v33, 32, v32
  v_xor_b32 v34, 64, v32
  v_xor_b32 v35, 96, v32
  ds_read_b64_tr_b16 v[36:37], v32 offset:24576
  ds_read_b64_tr_b16 v[38:39], v33 offset:24576
  ds_read_b64_tr_b16 v[40:41], v34 offset:24576
  ds_read_b64_tr_b16 v[42:43], v35 offset:24576
  ds_read_b64_tr_b16 v[44:45], v32 offset:0
  ds_read_b64_tr_b16 v[48:49], v33 offset:0
  ds_read_b64_tr_b16 v[52:53], v34 offset:0
  ds_read_b64_tr_b16 v[56:57], v35 offset:0
  ds_read_b64_tr_b16 v[46:47], v32 offset:6144
  ds_read_b64_tr_b16 v[50:51], v33 offset:6144
  ds_read_b64_tr_b16 v[54:55], v34 offset:6144
  ds_read_b64_tr_b16 v[58:59], v35 offset:6144
  ds_read_b64_tr_b16 v[60:61], v32 offset:12288
  ds_read_b64_tr_b16 v[64:65], v33 offset:12288
  ds_read_b64_tr_b16 v[68:69], v34 offset:12288
  ds_read_b64_tr_b16 v[72:73], v35 offset:12288
  ds_read_b64_tr_b16 v[62:63], v32 offset:18432
  ds_read_b64_tr_b16 v[66:67], v33 offset:18432
  ds_read_b64_tr_b16 v[70:71], v34 offset:18432
  ds_read_b64_tr_b16 v[74:75], v35 offset:18432
  v_lshrrev_b32 v30, 2, v5
  v_mov_b32 v31, 0x3f803f80
  v_lshlrev_b32 v32, 16, v2
  v_and_b32 v33, 0xffff0000, v2
  v_lshlrev_b32 v34, 16, v3
  v_and_b32 v35, 0xffff0000, v3
  s_mov_b32 exec_lo, 0xfffff
  s_mov_b32 exec_hi, 0xfffff
  s_lshl_b32 s73, s56, 12
  s_add_u32 s73, s73, s67
  s_add_u32 s73, s73, 524288
  buffer_load_dwordx4 v[76:79], v5, s[36:39], s73 offen offset:0 sc1
  buffer_load_dwordx4 v[192:195], v5, s[36:39], s73 offen offset:1024 sc1
  buffer_load_dwordx4 v[196:199], v5, s[36:39], s73 offen offset:2048 sc1
  buffer_load_dwordx4 v[200:203], v5, s[36:39], s73 offen offset:3072 sc1
  s_mov_b64 exec, -1
  s_waitcnt vmcnt(10)
  s_add_u32 m0, s71, 6144
  s_mov_b32 s57, 0x3001800
  buffer_load_dwordx4 v1, s[8:11], s57 offen offset:0 nt lds
  s_waitcnt vmcnt(10)
  s_add_u32 m0, s71, 7040
  s_nop 0
  buffer_load_dwordx4 v1, s[8:11], s57 offen offset:128 nt lds
  s_waitcnt vmcnt(10)
  s_add_u32 m0, s71, 7936
  s_nop 0
  buffer_load_dwordx4 v1, s[8:11], s57 offen offset:256 nt lds
  s_waitcnt vmcnt(10)
  buffer_load_dwordx4 a[160:163], v1, s[8:11], s57 offen offset:384 nt
  s_waitcnt vmcnt(10)
  buffer_load_dwordx4 a[164:167], v1, s[8:11], s57 offen offset:512 nt
  s_waitcnt vmcnt(10)
  buffer_load_dwordx4 a[168:171], v1, s[8:11], s57 offen offset:640 nt
  s_waitcnt vmcnt(10)
  s_mov_b32 s57, 0x3003000
  buffer_load_dwordx4 a[172:175], v1, s[8:11], s57 offen offset:0 nt
  s_waitcnt vmcnt(6)
  buffer_load_dwordx4 a[176:179], v1, s[8:11], s57 offen offset:128 nt
  s_mov_b32 s72, 0
  s_waitcnt vmcnt(8)
L_chk_83:
  s_mov_b32 exec_lo, 0xfffff
  s_mov_b32 exec_hi, 0xfffff
  v_pk_add_f32 v[76:77], v[76:77], v[192:193]
  v_pk_add_f32 v[78:79], v[78:79], v[194:195]
  v_pk_add_f32 v[196:197], v[196:197], v[200:201]
  v_pk_add_f32 v[198:199], v[198:199], v[202:203]
  v_pk_add_f32 v[76:77], v[76:77], v[196:197]
  v_pk_add_f32 v[78:79], v[78:79], v[198:199]
  s_nop 0
  v_permlane32_swap_b32 v76, v77
  v_permlane32_swap_b32 v78, v79
  v_add_f32 v76, v76, v77
  v_add_f32 v78, v78, v79
  v_cmp_u_f32 vcc, v76, v78
  s_cbranch_vccz L_ok_84
  s_add_u32 s72, s72, 1
  s_cmp_ge_u32 s72, 65536
  s_cbranch_scc1 L_ok_84
  s_sleep 1
  s_mov_b32 exec_lo, 0xfffff
  s_mov_b32 exec_hi, 0xfffff
  s_lshl_b32 s73, s56, 12
  s_add_u32 s73, s73, s67
  s_add_u32 s73, s73, 524288
  buffer_load_dwordx4 v[76:79], v5, s[36:39], s73 offen offset:0 sc1
  buffer_load_dwordx4 v[192:195], v5, s[36:39], s73 offen offset:1024 sc1
  buffer_load_dwordx4 v[196:199], v5, s[36:39], s73 offen offset:2048 sc1
  buffer_load_dwordx4 v[200:203], v5, s[36:39], s73 offen offset:3072 sc1
  s_waitcnt vmcnt(0)
  s_branch L_chk_83
L_ok_84:
  ds_write2_b32 v29, v76, v78 offset0:0 offset1:2
  s_mov_b64 exec, -1
  s_waitcnt lgkmcnt(0)
  s_barrier
  ds_read_b128 v[76:79], v28 offset:0
  ds_read_b128 v[192:195], v28 offset:320
  ds_read_b128 v[196:199], v28 offset:640
  ds_read_b128 v[200:203], v28 offset:960
  s_mov_b32 exec_lo, 0x55555555
  s_mov_b32 exec_hi, 0x55555555
  s_mov_b32 vcc_lo, 0x44444444
  s_mov_b32 vcc_hi, 0x44444444
  s_waitcnt lgkmcnt(2)
  v_pk_add_f32 v[76:77], v[76:77], v[192:193]
  v_pk_add_f32 v[78:79], v[78:79], v[194:195]
  v_pk_add_f32 v[32:33], v[32:33], v[76:77]
  v_pk_add_f32 v[34:35], v[34:35], v[78:79]
  s_waitcnt lgkmcnt(0)
  v_pk_add_f32 v[196:197], v[196:197], v[200:201]
  v_pk_add_f32 v[198:199], v[198:199], v[202:203]
  v_pk_add_f32 v[32:33], v[32:33], v[196:197]
  v_pk_add_f32 v[34:35], v[34:35], v[198:199]
  v_cvt_pk_bf16_f32 v2, v32, v33
  v_cvt_pk_bf16_f32 v3, v34, v35
  s_mov_b64 exec, -1
  v_cndmask_b32_dpp v26, v2, v31, vcc row_newbcast:8 row_mask:0xf bank_mask:0xf
  v_cndmask_b32_dpp v27, v3, v31, vcc row_newbcast:8 row_mask:0xf bank_mask:0xf
  v_cndmask_b32_dpp v32, v2, v31, vcc row_newbcast:0 row_mask:0xf bank_mask:0xf
  v_cndmask_b32_dpp v33, v3, v31, vcc row_newbcast:0 row_mask:0xf bank_mask:0xf
  v_cndmask_b32_dpp v34, v2, v31, vcc row_newbcast:2 row_mask:0xf bank_mask:0xf
  v_cndmask_b32_dpp v35, v3, v31, vcc row_newbcast:2 row_mask:0xf bank_mask:0xf
  v_cndmask_b32_dpp v76, v2, v31, vcc row_newbcast:4 row_mask:0xf bank_mask:0xf
  v_cndmask_b32_dpp v77, v3, v31, vcc row_newbcast:4 row_mask:0xf bank_mask:0xf
  v_cndmask_b32_dpp v78, v2, v31, vcc row_newbcast:6 row_mask:0xf bank_mask:0xf
  v_cndmask_b32_dpp v79, v3, v31, vcc row_newbcast:6 row_mask:0xf bank_mask:0xf
  s_waitcnt lgkmcnt(0)
  s_cmp_eq_u32 s56, 0
  s_cbranch_scc1 L_q0_85
  v_mfma_f32_16x16x16_bf16 v[192:195], v[26:27], v[36:37], 0
  v_mfma_f32_16x16x16_bf16 v[196:199], v[26:27], v[38:39], 0
  v_mfma_f32_16x16x16_bf16 v[36:39], v[26:27], v[40:41], 0
  v_mfma_f32_16x16x16_bf16 v[200:203], v[26:27], v[42:43], 0
  s_lshl_b32 s58, s56, 8
  s_add_u32 s73, s68, 0x23ff00
  s_add_u32 s73, s73, s58
  s_nop 1
  v_mfma_f32_16x16x32_bf16 v[192:195], v[32:35], v[44:47], v[192:195]
  v_mfma_f32_16x16x32_bf16 v[196:199], v[32:35], v[48:51], v[196:199]
  v_mfma_f32_16x16x32_bf16 v[36:39], v[32:35], v[52:55], v[36:39]
  v_mfma_f32_16x16x32_bf16 v[200:203], v[32:35], v[56:59], v[200:203]
  v_mfma_f32_16x16x32_bf16 v[192:195], v[76:79], v[60:63], v[192:195]
  v_mfma_f32_16x16x32_bf16 v[196:199], v[76:79], v[64:67], v[196:199]
  v_mfma_f32_16x16x32_bf16 v[36:39], v[76:79], v[68:71], v[36:39]
  v_mfma_f32_16x16x32_bf16 v[200:203], v[76:79], v[72:75], v[200:203]
  s_nop 5
  v_mov_b32_dpp v192, v196 quad_perm:[0,1,2,3] row_mask:0x2 bank_mask:0xf
  s_nop 1
  v_mov_b32_dpp v192, v36 quad_perm:[0,1,2,3] row_mask:0x4 bank_mask:0xf
  s_nop 1
  v_mov_b32_dpp v192, v200 quad_perm:[0,1,2,3] row_mask:0x8 bank_mask:0xf
  s_cmp_eq_u32 s75, 0
  s_cbranch_scc1 L_slow_87
  buffer_store_dword v192, v30, s[36:39], s73 offen
  s_branch L_pub_88
L_slow_87:
  buffer_store_dword v192, v30, s[36:39], s73 offen sc1
L_pub_88:
  s_branch L_qe_86
L_q0_85:
  v_mfma_f32_16x16x16_bf16 v[192:195], v[26:27], v[26:27], 0
  v_mfma_f32_16x16x32_bf16 v[196:199], v[32:35], v[32:35], 0
  v_mfma_f32_16x16x32_bf16 v[196:199], v[76:79], v[76:79], v[196:199]
  s_add_u32 s73, s68, 2359296
  s_mov_b64 exec, 1
  s_nop 5
  v_add_f32 v192, v192, v196
  v_add_f32 v193, v194, v198
  s_cmp_eq_u32 s75, 0
  s_cbranch_scc1 L_slow_89
  buffer_store_dwordx2 v[192:193], v30, s[36:39], s73 offen offset:768
  s_branch L_pub_90
L_slow_89:
  buffer_store_dwordx2 v[192:193], v30, s[36:39], s73 offen offset:768 sc1
L_pub_90:
  s_mov_b64 exec, -1
L_qe_86:
  s_waitcnt vmcnt(7)
  buffer_load_dwordx4 a[180:183], v1, s[8:11], s57 offen offset:256 nt
  s_waitcnt vmcnt(7)
  buffer_load_dwordx4 a[184:187], v1, s[8:11], s57 offen offset:384 nt
  s_waitcnt vmcnt(7)
  buffer_load_dwordx4 a[188:191], v1, s[8:11], s57 offen offset:512 nt
  s_waitcnt vmcnt(7)
  buffer_load_dwordx4 a[192:195], v1, s[8:11], s57 offen offset:640 nt
  s_waitcnt vmcnt(7)
  s_mov_b32 s57, 0x3004800
  buffer_load_dwordx4 a[196:199], v1, s[8:11], s57 offen offset:0 nt
  s_waitcnt vmcnt(7)
  buffer_load_dwordx4 a[200:203], v1, s[8:11], s57 offen offset:128 nt
  s_waitcnt vmcnt(7)
  buffer_load_dwordx4 a[204:207], v1, s[8:11], s57 offen offset:256 nt
  s_waitcnt vmcnt(6)
  buffer_load_dwordx4 a[208:211], v1, s[8:11], s57 offen offset:384 nt
  s_waitcnt vmcnt(6)
  buffer_load_dwordx4 a[212:215], v1, s[8:11], s57 offen offset:512 nt
  s_waitcnt vmcnt(6)
  buffer_load_dwordx4 a[216:219], v1, s[8:11], s57 offen offset:640 nt
  s_waitcnt vmcnt(6)
  s_mov_b32 s57, 0x3006000
  buffer_load_dwordx4 a[220:223], v1, s[8:11], s57 offen offset:0 nt
  s_waitcnt vmcnt(6)
  buffer_load_dwordx4 a[224:227], v1, s[8:11], s57 offen offset:128 nt
  v_mov_b32 v28, 0
  v_mov_b32 v29, 0
  v_mov_b32 v30, 0
  v_mov_b32 v31, 0
  v_mov_b32 v32, 0
  v_mov_b32 v33, 0
  v_mov_b32 v34, 0
  v_mov_b32 v35, 0
  v_mov_b32 v36, 0
  v_mov_b32 v37, 0
  v_mov_b32 v38, 0
  v_mov_b32 v39, 0
  v_and_b32 v26, 0x30, v5
  v_bfe_u32 v27, v5, 8, 1
  v_lshl_add_u32 v26, v27, 6, v26
  v_add_u32 v26, 162880, v26
  v_mov_b32 v27, 163264
  v_and_b32 v40, 16, v5
  v_mov_b32 v41, 0xffff
  v_lshlrev_b32 v40, v40, v41
  v_bfe_u32 v41, v5, 5, 2
  v_cmp_eq_u32 vcc, 0, v41
  s_nop 1
  v_cndmask_b32 v44, 0, v40, vcc
  v_cmp_eq_u32 vcc, 1, v41
  s_nop 1
  v_cndmask_b32 v45, 0, v40, vcc
  v_cmp_eq_u32 vcc, 2, v41
  s_nop 1
  v_cndmask_b32 v46, 0, v40, vcc
  v_cmp_eq_u32 vcc, 3, v41
  s_nop 1
  v_cndmask_b32 v47, 0, v40, vcc
  v_bfe_u32 v40, v5, 7, 2
  v_lshlrev_b32 v40, 4, v40
  v_lshrrev_b32 v41, 9, v5
  v_lshl_add_u32 v40, v41, 3, v40
  v_bfe_u32 v41, v5, 4, 3
  v_add_lshl_u32 v40, v40, v41, 2
  s_mul_i32 s58, s56, 768
  s_add_u32 s58, s58, 159744
  v_add_u32 v40, s58, v40
  v_lshrrev_b32 v42, 8, v5
  v_bfe_u32 v41, v5, 4, 2
  v_lshl_add_u32 v42, v42, 2, v41
  v_bfe_u32 v41, v5, 7, 1
  v_lshl_add_u32 v42, v42, 1, v41
  v_lshlrev_b32 v42, 7, v42
  v_bfe_u32 v41, v5, 6, 1
  v_lshl_add_u32 v42, v41, 3, v42
  v_add_u32 v41, s71, v5
  s_lshl_b32 s58, s56, 3
  s_add_u32 s58, s58, 162816
  v_mov_b32 v43, s58
  v_lshrrev_b32 v49, 8, v5
  v_and_b32 v48, 0xf0, v5
  v_lshl_add_u32 v48, v49, 10, v48
  v_bfe_u32 v51, v5, 1, 7
  v_lshl_add_u32 v51, v49, 1, v51
  s_lshl_b32 s58, s56, 7
  s_add_u32 s58, s58, 162880
  v_add_u32 v51, s58, v51
  v_lshlrev_b32 v49, 6, v5
  v_mov_b32 v50, 163264
  v_mov_b32 v52, 0
  v_mov_b32 v53, 0
  s_cmp_lt_u32 s56, 3
  s_cbranch_scc0 L_w_91
  s_add_u32 s74, s69, 2359296
  s_mov_b32 exec_lo, 0xff
  s_mov_b32 exec_hi, 0x0
  buffer_load_dwordx2 v[52:53], v49, s[36:39], s74 offen offset:768 sc1
  s_mov_b64 exec, -1
  s_lshl_b32 s73, s56, 8
  s_add_u32 s73, s73, s74
  s_add_u32 s74, s73, 4096
  buffer_load_dwordx4 v[56:59], v48, s[36:39], s73 offen sc1
  buffer_load_dwordx4 v[60:63], v48, s[36:39], s74 offen sc1
  s_mov_b64 exec, -1
L_w_91:
  s_waitcnt vmcnt(9)
  s_mov_b32 s57, 0x3006000
  buffer_load_dwordx4 a[228:231], v1, s[8:11], s57 offen offset:256 nt
  s_waitcnt vmcnt(9)
  buffer_load_dwordx4 a[232:235], v1, s[8:11], s57 offen offset:384 nt
  s_waitcnt vmcnt(9)
  buffer_load_dwordx4 a[236:239], v1, s[8:11], s57 offen offset:512 nt
  s_waitcnt vmcnt(9)
  buffer_load_dwordx4 a[240:243], v1, s[8:11], s57 offen offset:640 nt
  s_waitcnt vmcnt(9)
  s_mov_b32 s57, 0x3007800
  buffer_load_dwordx4 a[244:247], v1, s[8:11], s57 offen offset:0 nt
  s_waitcnt vmcnt(9)
  buffer_load_dwordx4 a[248:251], v1, s[8:11], s57 offen offset:128 nt
  s_waitcnt vmcnt(9)
  buffer_load_dwordx4 a[252:255], v1, s[8:11], s57 offen offset:256 nt
  s_waitcnt vmcnt(6)
  buffer_load_dwordx4 v[64:67], v1, s[8:11], s57 offen offset:384 nt
  s_cmp_lt_u32 s56, 3
  s_cbranch_scc0 L_w_92
  s_mov_b32 s72, 0
  s_waitcnt vmcnt(8)
L_chk_93:
  v_pk_add_f32 v[56:57], v[56:57], v[60:61]
  v_pk_add_f32 v[58:59], v[58:59], v[62:63]
  v_add_f32_dpp v53, v53, v53 quad_perm:[1,0,3,2] row_mask:0xf bank_mask:0xf
  v_add_f32_dpp v52, v52, v52 quad_perm:[1,0,3,2] row_mask:0xf bank_mask:0xf
  v_permlane16_swap_b32 v56, v57
  v_permlane16_swap_b32 v58, v59
  v_add_f32 v56, v56, v57
  v_add_f32 v58, v58, v59
  v_add_f32_dpp v53, v53, v53 quad_perm:[2,3,0,1] row_mask:0xf bank_mask:0xf
  v_add_f32_dpp v52, v52, v52 quad_perm:[2,3,0,1] row_mask:0xf bank_mask:0xf
  v_permlane32_swap_b32 v56, v58
  v_add_f32_dpp v53, v53, v53 row_half_mirror row_mask:0xf bank_mask:0xf
  v_add_f32_dpp v52, v52, v52 row_half_mirror row_mask:0xf bank_mask:0xf
  v_add_f32 v56, v56, v58
  v_readfirstlane_b32 s58, v53
  s_nop 1
  v_fmac_f32 v56, s58, v24
  v_cmp_u_f32 vcc, v56, v52
  s_cbranch_vccz L_ok_94
  s_add_u32 s72, s72, 1
  s_cmp_ge_u32 s72, 65536
  s_cbranch_scc1 L_ok_94
  s_add_u32 s74, s69, 2359296
  s_mov_b32 exec_lo, 0xff
  s_mov_b32 exec_hi, 0x0
  buffer_load_dwordx2 v[52:53], v49, s[36:39], s74 offen offset:768 sc1
  s_mov_b64 exec, -1
  s_lshl_b32 s73, s56, 8
  s_add_u32 s73, s73, s74
  s_add_u32 s74, s73, 4096
  buffer_load_dwordx4 v[56:59], v48, s[36:39], s73 offen sc1
  buffer_load_dwordx4 v[60:63], v48, s[36:39], s74 offen sc1
  s_waitcnt vmcnt(0)
  s_branch L_chk_93
L_ok_94:
  v_cvt_pk_bf16_f32 v56, v56, v56
  ds_write_b16 v51, v56
  s_mov_b64 exec, 1
  ds_write_b64 v50, v[52:53]
  s_mov_b64 exec, -1
L_w_92:
  s_waitcnt lgkmcnt(0)
  s_barrier
  s_mov_b32 exec_lo, 0xf0f0f0f
  s_mov_b32 exec_hi, 0xf0f0f0f0
  ds_read_b128 v[28:31], v26 offset:0
  ds_read_b128 v[32:35], v26 offset:128
  ds_read_b128 v[36:39], v26 offset:256
  s_mov_b64 exec, -1
  ds_read_b64 v[24:25], v27
  s_waitcnt lgkmcnt(0)
  v_mfma_f32_16x16x32_bf16 v[48:51], v[28:31], v[20:23], 0
  v_mfma_f32_16x16x32_bf16 v[20:23], v[28:31], v[92:95], 0
  v_mfma_f32_16x16x32_bf16 v[48:51], v[32:35], v[16:19], v[48:51]
  v_mul_f32 v25, 0x3acccccd, v25
  v_mul_f32 v24, 0x3acccccd, v24
  v_mfma_f32_16x16x32_bf16 v[20:23], v[32:35], v[84:87], v[20:23]
  v_fma_f32 v24, -v25, v25, v24
  v_max_f32 v24, 0, v24
  v_mfma_f32_16x16x32_bf16 v[48:51], v[36:39], v[80:83], v[48:51]
  v_add_f32 v24, 0x3727c5ac, v24
  v_rsq_f32 v24, v24
  v_mfma_f32_16x16x32_bf16 v[20:23], v[36:39], v[96:99], v[20:23]
  v_mul_f32 v24, 0x3dd53b95, v24
  v_mfma_f32_16x16x32_bf16 v[16:19], v[28:31], v[104:107], 0
  v_mfma_f32_16x16x32_bf16 v[52:55], v[28:31], v[128:131], 0
  v_mfma_f32_16x16x32_bf16 v[16:19], v[32:35], v[108:111], v[16:19]
  s_nop 0
  v_mov_b32_dpp v26, v48 quad_perm:[0,0,0,0] row_mask:0xf bank_mask:0xf
  s_nop 1
  v_mov_b32_dpp v28, v20 quad_perm:[0,0,0,0] row_mask:0xf bank_mask:0xf
  v_mfma_f32_16x16x32_bf16 v[52:55], v[32:35], v[132:135], v[52:55]
  v_add_f32_dpp v26, v49, v26 quad_perm:[1,1,1,1] row_mask:0xf bank_mask:0xf
  v_add_f32_dpp v28, v21, v28 quad_perm:[1,1,1,1] row_mask:0xf bank_mask:0xf
  v_mfma_f32_16x16x32_bf16 v[16:19], v[36:39], v[120:123], v[16:19]
  v_add_f32_dpp v26, v50, v26 quad_perm:[2,2,2,2] row_mask:0xf bank_mask:0xf
  v_add_f32_dpp v28, v22, v28 quad_perm:[2,2,2,2] row_mask:0xf bank_mask:0xf
  v_mfma_f32_16x16x32_bf16 v[52:55], v[36:39], v[136:139], v[52:55]
  v_add_f32_dpp v26, v51, v26 quad_perm:[3,3,3,3] row_mask:0xf bank_mask:0xf
  s_nop 1
  v_add_f32_dpp v26, v23, v28 quad_perm:[3,3,3,3] row_mask:0xc bank_mask:0xf
  s_nop 0
  v_mov_b32_dpp v27, v16 quad_perm:[0,0,0,0] row_mask:0xf bank_mask:0xf
  s_nop 1
  v_mov_b32_dpp v20, v52 quad_perm:[0,0,0,0] row_mask:0xf bank_mask:0xf
  v_add_f32_dpp v27, v17, v27 quad_perm:[1,1,1,1] row_mask:0xf bank_mask:0xf
  s_nop 0
  v_add_f32_dpp v20, v53, v20 quad_perm:[1,1,1,1] row_mask:0xf bank_mask:0xf
  v_add_f32_dpp v27, v18, v27 quad_perm:[2,2,2,2] row_mask:0xf bank_mask:0xf
  s_nop 0
  v_add_f32_dpp v20, v54, v20 quad_perm:[2,2,2,2] row_mask:0xf bank_mask:0xf
  v_add_f32_dpp v27, v19, v27 quad_perm:[3,3,3,3] row_mask:0xf bank_mask:0xf
  s_nop 1
  v_add_f32_dpp v27, v55, v20 quad_perm:[3,3,3,3] row_mask:0xc bank_mask:0xf
  v_max_f32 v16, v26, v27
  s_nop 1
  v_max_f32_dpp v16, v16, v16 row_ror:4 row_mask:0xf bank_mask:0xf
  s_nop 1
  v_max_f32_dpp v16, v16, v16 row_ror:8 row_mask:0xf bank_mask:0xf
  s_nop 1
  v_max_f32_dpp v16, v16, v16 row_bcast:15 row_mask:0xa bank_mask:0xf
  s_nop 1
  v_max_f32_dpp v16, v16, v16 row_bcast:31 row_mask:0xc bank_mask:0xf
  s_nop 0
  v_readlane_b32 s58, v16, 63
  s_nop 1
  v_mul_f32_e64 v16, -s58, v24
  v_fma_f32 v26, v26, v24, v16
  v_fma_f32 v27, v27, v24, v16
  v_exp_f32 v26, v26
  v_exp_f32 v27, v27
  s_nop 0
  v_add_f32 v17, v26, v27
  v_cvt_pk_bf16_f32 v26, v26, v26
  v_cvt_pk_bf16_f32 v27, v27, v27
  v_and_b32 v20, v26, v44
  v_and_b32 v21, v26, v45
  v_and_b32_dpp v22, v26, v46 row_shr:4 row_mask:0xf bank_mask:0xf bound_ctrl:0
  v_and_b32_dpp v23, v26, v47 row_shr:4 row_mask:0xf bank_mask:0xf bound_ctrl:0
  s_nop 1
  v_mfma_f32_16x16x32_bf16 v[28:31], v[140:143], v[20:23], 0
  v_and_b32 v34, v26, v46
  v_and_b32 v35, v26, v47
  v_mfma_f32_16x16x32_bf16 v[36:39], v[144:147], v[20:23], 0
  v_and_b32_dpp v32, v26, v44 row_shl:4 row_mask:0xf bank_mask:0xf bound_ctrl:0
  v_and_b32_dpp v33, v26, v45 row_shl:4 row_mask:0xf bank_mask:0xf bound_ctrl:0
  v_add_f32_dpp v17, v17, v17 row_ror:4 row_mask:0xf bank_mask:0xf
  v_mfma_f32_16x16x32_bf16 v[48:51], v[148:151], v[20:23], 0
  s_nop 0
  v_add_f32_dpp v17, v17, v17 row_ror:8 row_mask:0xf bank_mask:0xf
  v_mfma_f32_16x16x32_bf16 v[28:31], v[152:155], v[32:35], v[28:31]
  v_and_b32 v20, v27, v44
  v_and_b32 v21, v27, v45
  v_mfma_f32_16x16x32_bf16 v[36:39], v[12:15], v[32:35], v[36:39]
  v_and_b32_dpp v22, v27, v46 row_shr:4 row_mask:0xf bank_mask:0xf bound_ctrl:0
  v_and_b32_dpp v23, v27, v47 row_shr:4 row_mask:0xf bank_mask:0xf bound_ctrl:0
  v_add_f32_dpp v17, v17, v17 row_bcast:15 row_mask:0xa bank_mask:0xf
  v_mfma_f32_16x16x32_bf16 v[48:51], v[88:91], v[32:35], v[48:51]
  s_nop 0
  v_add_f32_dpp v17, v17, v17 row_bcast:31 row_mask:0xc bank_mask:0xf
  v_mfma_f32_16x16x32_bf16 v[28:31], v[100:103], v[20:23], v[28:31]
  v_and_b32 v14, v27, v46
  v_and_b32 v15, v27, v47
  v_mfma_f32_16x16x32_bf16 v[36:39], v[112:115], v[20:23], v[36:39]
  v_and_b32_dpp v12, v27, v44 row_shl:4 row_mask:0xf bank_mask:0xf bound_ctrl:0
  v_and_b32_dpp v13, v27, v45 row_shl:4 row_mask:0xf bank_mask:0xf bound_ctrl:0
  v_mfma_f32_16x16x32_bf16 v[48:51], v[116:119], v[20:23], v[48:51]
  s_mov_b32 exec_lo, 0x0
  s_mov_b32 exec_hi, 0x80000000
  ds_write_b64 v43, v[16:17]
  s_mov_b64 exec, -1
  v_mfma_f32_16x16x32_bf16 v[28:31], v[124:127], v[12:15], v[28:31]
  v_mfma_f32_16x16x32_bf16 v[36:39], v[156:159], v[12:15], v[36:39]
  v_mfma_f32_16x16x32_bf16 v[48:51], v[160:163], v[12:15], v[48:51]
  v_mov_b32 v12, 162816
  v_add_u32 v13, 159744, v5
  s_add_u32 s73, s64, 786432
  s_nop 2
  v_permlane32_swap_b32 v28, v29
  v_permlane32_swap_b32 v30, v31
  v_permlane32_swap_b32 v36, v37
  v_permlane32_swap_b32 v38, v39
  v_permlane32_swap_b32 v48, v49
  v_permlane32_swap_b32 v50, v51
  v_add_f32_dpp v16, v29, v28 row_shl:8 row_mask:0xf bank_mask:0x3
  v_add_f32_dpp v17, v37, v36 row_shl:8 row_mask:0xf bank_mask:0x3
  v_add_f32_dpp v18, v49, v48 row_shl:8 row_mask:0xf bank_mask:0x3
  v_add_f32_dpp v16, v30, v31 row_shr:8 row_mask:0xf bank_mask:0xc
  v_add_f32_dpp v17, v38, v39 row_shr:8 row_mask:0xf bank_mask:0xc
  v_add_f32_dpp v18, v50, v51 row_shr:8 row_mask:0xf bank_mask:0xc
  ds_write_b32 v40, v16 offset:0
  ds_write_b32 v40, v17 offset:256
  ds_write_b32 v40, v18 offset:512
  s_waitcnt lgkmcnt(0)
  s_barrier
  s_cmp_eq_u32 s56, 3
  s_cbranch_scc0 L_w_95
  ds_read_b128 v[16:19], v12
  ds_read_b128 v[20:23], v12 offset:16
  ds_read_b128 v[24:27], v13 offset:0
  ds_read_b128 v[28:31], v13 offset:768
  ds_read_b128 v[32:35], v13 offset:1536
  ds_read_b128 v[36:39], v13 offset:2304
  s_mov_b32 vcc_lo, 0
  s_mov_b32 vcc_hi, 0xffff0000
  s_mov_b32 exec_hi, 0x1ffff
  s_waitcnt lgkmcnt(4)
  v_min3_f32 v12, v16, v18, v20
  v_min_f32 v12, v12, v22
  v_sub_f32 v16, v12, v16
  v_sub_f32 v18, v12, v18
  v_sub_f32 v20, v12, v20
  v_sub_f32 v22, v12, v22
  v_exp_f32 v16, v16
  v_exp_f32 v18, v18
  v_exp_f32 v20, v20
  v_exp_f32 v22, v22
  s_waitcnt lgkmcnt(0)
  v_pk_mul_f32 v[24:25], v[24:25], v[16:17] op_sel_hi:[1,0]
  v_pk_mul_f32 v[26:27], v[26:27], v[16:17] op_sel_hi:[1,0]
  v_mul_f32 v17, v16, v17
  v_pk_mul_f32 v[32:33], v[32:33], v[20:21] op_sel_hi:[1,0]
  v_pk_mul_f32 v[34:35], v[34:35], v[20:21] op_sel_hi:[1,0]
  v_mul_f32 v21, v20, v21
  v_pk_fma_f32 v[24:25], v[28:29], v[18:19], v[24:25] op_sel_hi:[1,0,1]
  v_pk_fma_f32 v[26:27], v[30:31], v[18:19], v[26:27] op_sel_hi:[1,0,1]
  v_fmac_f32 v17, v18, v19
  v_pk_fma_f32 v[32:33], v[36:37], v[22:23], v[32:33] op_sel_hi:[1,0,1]
  v_pk_fma_f32 v[34:35], v[38:39], v[22:23], v[34:35] op_sel_hi:[1,0,1]
  v_fmac_f32 v21, v22, v23
  v_pk_add_f32 v[24:25], v[24:25], v[32:33]
  v_pk_add_f32 v[26:27], v[26:27], v[34:35]
  v_add_f32 v13, v17, v21
  v_cvt_pk_bf16_f32 v28, v24, v25
  v_cvt_pk_bf16_f32 v29, v26, v27
  v_cndmask_b32 v28, v28, v12, vcc
  v_cndmask_b32 v29, v29, v13, vcc
  s_cmp_eq_u32 s75, 0
  s_cbranch_scc1 L_slow_96
  buffer_store_dwordx2 v[28:29], v42, s[36:39], s73 offen
  s_branch L_pub_97
L_slow_96:
  buffer_store_dwordx2 v[28:29], v42, s[36:39], s73 offen sc1
L_pub_97:
  s_mov_b64 exec, -1
L_w_95:
  v_mov_b32 v12, 0
  v_mov_b32 v13, 0
  v_mov_b32 v14, 0
  v_mov_b32 v15, 0
  v_mov_b32 v16, 0
  v_mov_b32 v17, 0
  v_mov_b32 v18, 0
  v_mov_b32 v19, 0
  v_mov_b32 v20, 0
  v_mov_b32 v21, 0
  v_mov_b32 v22, 0
  v_mov_b32 v23, 0
  v_and_b32 v24, 0x30, v5
  v_bfe_u32 v25, v5, 8, 1
  v_lshl_add_u32 v24, v25, 6, v24
  v_add_u32 v24, 163280, v24
  v_mov_b32 v25, 163664
  s_mov_b32 exec_lo, 0xf0f0f0f
  s_mov_b32 exec_hi, 0xf0f0f0f0
  ds_read_b128 v[12:15], v24 offset:0
  ds_read_b128 v[16:19], v24 offset:128
  ds_read_b128 v[20:23], v24 offset:256
  s_mov_b64 exec, -1
  ds_read_b64 v[26:27], v25
  s_waitcnt lgkmcnt(0)
  s_waitcnt vmcnt(7)
  s_mov_b32 s57, 0x3007800
  buffer_load_dwordx4 v[28:31], v1, s[8:11], s57 offen offset:512 nt
  v_mfma_f32_16x16x32_bf16 v[32:35], v[12:15], v[8:11], 0
  v_mfma_f32_16x16x32_bf16 v[36:39], v[12:15], v[172:175], 0
  v_mfma_f32_16x16x32_bf16 v[32:35], v[16:19], v[164:167], v[32:35]
  v_mul_f32 v27, 0x3acccccd, v27
  v_mul_f32 v26, 0x3acccccd, v26
  v_mfma_f32_16x16x32_bf16 v[36:39], v[16:19], v[176:179], v[36:39]
  v_fma_f32 v26, -v27, v27, v26
  v_max_f32 v26, 0, v26
  v_mfma_f32_16x16x32_bf16 v[32:35], v[20:23], v[168:171], v[32:35]
  v_add_f32 v26, 0x3727c5ac, v26
  v_rsq_f32 v26, v26
  v_mfma_f32_16x16x32_bf16 v[36:39], v[20:23], v[180:183], v[36:39]
  v_mul_f32 v26, 0x3dd53b95, v26
  s_waitcnt vmcnt(7)
  buffer_load_dwordx4 v[40:43], v1, s[8:11], s57 offen offset:640 nt
  v_mfma_f32_16x16x32_bf16 v[44:47], v[12:15], v[184:187], 0
  v_mfma_f32_16x16x32_bf16 v[48:51], v[12:15], a[40:43], 0
  v_mfma_f32_16x16x32_bf16 v[44:47], v[16:19], v[188:191], v[44:47]
  v_mov_b32_dpp v52, v32 quad_perm:[0,0,0,0] row_mask:0xf bank_mask:0xf
  s_nop 0
  v_mov_b32_dpp v24, v36 quad_perm:[0,0,0,0] row_mask:0xf bank_mask:0xf
  v_mfma_f32_16x16x32_bf16 v[48:51], v[16:19], a[44:47], v[48:51]
  v_add_f32_dpp v52, v33, v52 quad_perm:[1,1,1,1] row_mask:0xf bank_mask:0xf
  v_add_f32_dpp v24, v37, v24 quad_perm:[1,1,1,1] row_mask:0xf bank_mask:0xf
  v_mfma_f32_16x16x32_bf16 v[44:47], v[20:23], a[36:39], v[44:47]
  v_add_f32_dpp v52, v34, v52 quad_perm:[2,2,2,2] row_mask:0xf bank_mask:0xf
  v_add_f32_dpp v24, v38, v24 quad_perm:[2,2,2,2] row_mask:0xf bank_mask:0xf
  v_mfma_f32_16x16x32_bf16 v[48:51], v[20:23], a[48:51], v[48:51]
  v_add_f32_dpp v52, v35, v52 quad_perm:[3,3,3,3] row_mask:0xf bank_mask:0xf
  s_nop 1
  v_add_f32_dpp v52, v39, v24 quad_perm:[3,3,3,3] row_mask:0xc bank_mask:0xf
  s_waitcnt vmcnt(7)
  s_mov_b32 s57, 0x3009000
  buffer_load_dwordx4 v[32:35], v1, s[8:11], s57 offen offset:0 nt
  v_mfma_f32_16x16x32_bf16 v[36:39], v[12:15], a[88:91], 0
  v_mfma_f32_16x16x32_bf16 v[56:59], v[12:15], a[56:59], 0
  v_mfma_f32_16x16x32_bf16 v[36:39], v[16:19], a[92:95], v[36:39]
  v_mov_b32_dpp v53, v44 quad_perm:[0,0,0,0] row_mask:0xf bank_mask:0xf
  v_mov_b32_dpp v24, v48 quad_perm:[0,0,0,0] row_mask:0xf bank_mask:0xf
  v_mfma_f32_16x16x32_bf16 v[56:59], v[16:19], a[60:63], v[56:59]
  v_add_f32_dpp v53, v45, v53 quad_perm:[1,1,1,1] row_mask:0xf bank_mask:0xf
  v_add_f32_dpp v24, v49, v24 quad_perm:[1,1,1,1] row_mask:0xf bank_mask:0xf
  v_mfma_f32_16x16x32_bf16 v[36:39], v[20:23], a[52:55], v[36:39]
  v_add_f32_dpp v53, v46, v53 quad_perm:[2,2,2,2] row_mask:0xf bank_mask:0xf
  v_add_f32_dpp v24, v50, v24 quad_perm:[2,2,2,2] row_mask:0xf bank_mask:0xf
  v_mfma_f32_16x16x32_bf16 v[56:59], v[20:23], a[64:67], v[56:59]
  v_add_f32_dpp v53, v47, v53 quad_perm:[3,3,3,3] row_mask:0xf bank_mask:0xf
  s_nop 1
  v_add_f32_dpp v53, v51, v24 quad_perm:[3,3,3,3] row_mask:0xc bank_mask:0xf
  s_waitcnt vmcnt(7)
  buffer_load_dwordx4 v[44:47], v1, s[8:11], s57 offen offset:128 nt
  v_mfma_f32_16x16x32_bf16 v[48:51], v[12:15], a[0:3], 0
  v_mfma_f32_16x16x32_bf16 v[60:63], v[12:15], a[12:15], 0
  v_mfma_f32_16x16x32_bf16 v[48:51], v[16:19], a[4:7], v[48:51]
  v_mov_b32_dpp v54, v36 quad_perm:[0,0,0,0] row_mask:0xf bank_mask:0xf
  v_mov_b32_dpp v24, v56 quad_perm:[0,0,0,0] row_mask:0xf bank_mask:0xf
  v_mfma_f32_16x16x32_bf16 v[60:63], v[16:19], a[16:19], v[60:63]
  v_add_f32_dpp v54, v37, v54 quad_perm:[1,1,1,1] row_mask:0xf bank_mask:0xf
  v_add_f32_dpp v24, v57, v24 quad_perm:[1,1,1,1] row_mask:0xf bank_mask:0xf
  v_mfma_f32_16x16x32_bf16 v[48:51], v[20:23], a[8:11], v[48:51]
  v_add_f32_dpp v54, v38, v54 quad_perm:[2,2,2,2] row_mask:0xf bank_mask:0xf
  v_add_f32_dpp v24, v58, v24 quad_perm:[2,2,2,2] row_mask:0xf bank_mask:0xf
  v_mfma_f32_16x16x32_bf16 v[60:63], v[20:23], a[20:23], v[60:63]
  v_add_f32_dpp v54, v39, v54 quad_perm:[3,3,3,3] row_mask:0xf bank_mask:0xf
  s_nop 1
  v_add_f32_dpp v54, v59, v24 quad_perm:[3,3,3,3] row_mask:0xc bank_mask:0xf
  s_waitcnt vmcnt(7)
  buffer_load_dwordx4 v[36:39], v1, s[8:11], s57 offen offset:256 nt
  v_mfma_f32_16x16x32_bf16 v[56:59], v[12:15], a[24:27], 0
  v_mfma_f32_16x16x32_bf16 v[68:71], v[12:15], a[68:71], 0
  v_mfma_f32_16x16x32_bf16 v[56:59], v[16:19], a[28:31], v[56:59]
  v_mov_b32_dpp v55, v48 quad_perm:[0,0,0,0] row_mask:0xf bank_mask:0xf
  v_mov_b32_dpp v24, v60 quad_perm:[0,0,0,0] row_mask:0xf bank_mask:0xf
  v_mfma_f32_16x16x32_bf16 v[68:71], v[16:19], a[72:75], v[68:71]
  v_add_f32_dpp v55, v49, v55 quad_perm:[1,1,1,1] row_mask:0xf bank_mask:0xf
  v_add_f32_dpp v24, v61, v24 quad_perm:[1,1,1,1] row_mask:0xf bank_mask:0xf
  v_mfma_f32_16x16x32_bf16 v[56:59], v[20:23], a[32:35], v[56:59]
  v_add_f32_dpp v55, v50, v55 quad_perm:[2,2,2,2] row_mask:0xf bank_mask:0xf
  v_add_f32_dpp v24, v62, v24 quad_perm:[2,2,2,2] row_mask:0xf bank_mask:0xf
  v_mfma_f32_16x16x32_bf16 v[68:71], v[20:23], a[76:79], v[68:71]
  v_add_f32_dpp v55, v51, v55 quad_perm:[3,3,3,3] row_mask:0xf bank_mask:0xf
  s_nop 1
  v_add_f32_dpp v55, v63, v24 quad_perm:[3,3,3,3] row_mask:0xc bank_mask:0xf
  s_waitcnt vmcnt(7)
  s_mov_b32 s57, 0x3000000
  buffer_load_dwordx4 v[48:51], v4, s[12:15], s57 offen offset:0 nt
  v_mfma_f32_16x16x32_bf16 v[60:63], v[12:15], a[80:83], 0
  v_mfma_f32_16x16x32_bf16 v[72:75], v[12:15], a[100:103], 0
  v_mfma_f32_16x16x32_bf16 v[60:63], v[16:19], a[84:87], v[60:63]
  v_mov_b32_dpp v76, v56 quad_perm:[0,0,0,0] row_mask:0xf bank_mask:0xf
  v_mov_b32_dpp v24, v68 quad_perm:[0,0,0,0] row_mask:0xf bank_mask:0xf
  v_mfma_f32_16x16x32_bf16 v[72:75], v[16:19], a[104:107], v[72:75]
  v_add_f32_dpp v76, v57, v76 quad_perm:[1,1,1,1] row_mask:0xf bank_mask:0xf
  v_add_f32_dpp v24, v69, v24 quad_perm:[1,1,1,1] row_mask:0xf bank_mask:0xf
  v_mfma_f32_16x16x32_bf16 v[60:63], v[20:23], a[96:99], v[60:63]
  v_add_f32_dpp v76, v58, v76 quad_perm:[2,2,2,2] row_mask:0xf bank_mask:0xf
  v_add_f32_dpp v24, v70, v24 quad_perm:[2,2,2,2] row_mask:0xf bank_mask:0xf
  v_mfma_f32_16x16x32_bf16 v[72:75], v[20:23], a[108:111], v[72:75]
  v_add_f32_dpp v76, v59, v76 quad_perm:[3,3,3,3] row_mask:0xf bank_mask:0xf
  s_nop 1
  v_add_f32_dpp v76, v71, v24 quad_perm:[3,3,3,3] row_mask:0xc bank_mask:0xf
  s_waitcnt vmcnt(7)
  buffer_load_dwordx4 v[56:59], v4, s[12:15], s57 offen offset:128 nt
  v_mfma_f32_16x16x32_bf16 v[68:71], v[12:15], a[112:115], 0
  v_mfma_f32_16x16x32_bf16 v[80:83], v[12:15], a[124:127], 0
  v_mfma_f32_16x16x32_bf16 v[68:71], v[16:19], a[116:119], v[68:71]
  v_mov_b32_dpp v77, v60 quad_perm:[0,0,0,0] row_mask:0xf bank_mask:0xf
  v_mov_b32_dpp v24, v72 quad_perm:[0,0,0,0] row_mask:0xf bank_mask:0xf
  v_mfma_f32_16x16x32_bf16 v[80:83], v[16:19], a[128:131], v[80:83]
  v_add_f32_dpp v77, v61, v77 quad_perm:[1,1,1,1] row_mask:0xf bank_mask:0xf
  v_add_f32_dpp v24, v73, v24 quad_perm:[1,1,1,1] row_mask:0xf bank_mask:0xf
  v_mfma_f32_16x16x32_bf16 v[68:71], v[20:23], a[120:123], v[68:71]
  v_add_f32_dpp v77, v62, v77 quad_perm:[2,2,2,2] row_mask:0xf bank_mask:0xf
  v_add_f32_dpp v24, v74, v24 quad_perm:[2,2,2,2] row_mask:0xf bank_mask:0xf
  v_mfma_f32_16x16x32_bf16 v[80:83], v[20:23], a[132:135], v[80:83]
  v_add_f32_dpp v77, v63, v77 quad_perm:[3,3,3,3] row_mask:0xf bank_mask:0xf
  s_nop 1
  v_add_f32_dpp v77, v75, v24 quad_perm:[3,3,3,3] row_mask:0xc bank_mask:0xf
  s_waitcnt vmcnt(6)
  buffer_load_dwordx4 v[60:63], v4, s[12:15], s57 offen offset:256 nt
  v_mfma_f32_16x16x32_bf16 v[72:75], v[12:15], a[136:139], 0
  v_mfma_f32_16x16x32_bf16 v[84:87], v[12:15], a[148:151], 0
  v_mfma_f32_16x16x32_bf16 v[72:75], v[16:19], a[140:143], v[72:75]
  v_mov_b32_dpp v78, v68 quad_perm:[0,0,0,0] row_mask:0xf bank_mask:0xf
  v_mov_b32_dpp v24, v80 quad_perm:[0,0,0,0] row_mask:0xf bank_mask:0xf
  v_mfma_f32_16x16x32_bf16 v[84:87], v[16:19], a[152:155], v[84:87]
  v_add_f32_dpp v78, v69, v78 quad_perm:[1,1,1,1] row_mask:0xf bank_mask:0xf
  v_add_f32_dpp v24, v81, v24 quad_perm:[1,1,1,1] row_mask:0xf bank_mask:0xf
  v_mfma_f32_16x16x32_bf16 v[72:75], v[20:23], a[144:147], v[72:75]
  v_add_f32_dpp v78, v70, v78 quad_perm:[2,2,2,2] row_mask:0xf bank_mask:0xf
  v_add_f32_dpp v24, v82, v24 quad_perm:[2,2,2,2] row_mask:0xf bank_mask:0xf
  v_mfma_f32_16x16x32_bf16 v[84:87], v[20:23], a[156:159], v[84:87]
  v_add_f32_dpp v78, v71, v78 quad_perm:[3,3,3,3] row_mask:0xf bank_mask:0xf
  s_nop 1
  v_add_f32_dpp v78, v83, v24 quad_perm:[3,3,3,3] row_mask:0xc bank_mask:0xf
  s_waitcnt vmcnt(6)
  buffer_load_dwordx4 v[12:15], v4, s[12:15], s57 offen offset:3072 nt
  v_mov_b32_dpp v79, v72 quad_perm:[0,0,0,0] row_mask:0xf bank_mask:0xf
  s_nop 0
  v_mov_b32_dpp v24, v84 quad_perm:[0,0,0,0] row_mask:0xf bank_mask:0xf
  v_add_f32_dpp v79, v73, v79 quad_perm:[1,1,1,1] row_mask:0xf bank_mask:0xf
  s_nop 0
  v_add_f32_dpp v24, v85, v24 quad_perm:[1,1,1,1] row_mask:0xf bank_mask:0xf
  v_add_f32_dpp v79, v74, v79 quad_perm:[2,2,2,2] row_mask:0xf bank_mask:0xf
  s_nop 0
  v_add_f32_dpp v24, v86, v24 quad_perm:[2,2,2,2] row_mask:0xf bank_mask:0xf
  v_add_f32_dpp v79, v75, v79 quad_perm:[3,3,3,3] row_mask:0xf bank_mask:0xf
  s_nop 1
  v_add_f32_dpp v79, v87, v24 quad_perm:[3,3,3,3] row_mask:0xc bank_mask:0xf
  v_max_f32 v24, v52, v53
  v_max3_f32 v24, v24, v54, v55
  v_max3_f32 v24, v24, v76, v77
  v_max3_f32 v24, v24, v78, v79
  s_nop 1
  v_max_f32_dpp v24, v24, v24 row_ror:4 row_mask:0xf bank_mask:0xf
  s_nop 1
  v_max_f32_dpp v24, v24, v24 row_ror:8 row_mask:0xf bank_mask:0xf
  s_nop 1
  v_max_f32_dpp v24, v24, v24 row_bcast:15 row_mask:0xa bank_mask:0xf
  s_nop 1
  v_max_f32_dpp v24, v24, v24 row_bcast:31 row_mask:0xc bank_mask:0xf
  s_nop 0
  v_readlane_b32 s58, v24, 63
  s_nop 1
  v_mul_f32_e64 v24, -s58, v26
  v_fma_f32 v52, v52, v26, v24
  v_fma_f32 v53, v53, v26, v24
  v_fma_f32 v54, v54, v26, v24
  v_fma_f32 v55, v55, v26, v24
  v_fma_f32 v76, v76, v26, v24
  v_fma_f32 v77, v77, v26, v24
  v_fma_f32 v78, v78, v26, v24
  v_fma_f32 v79, v79, v26, v24
  v_exp_f32 v52, v52
  v_exp_f32 v53, v53
  v_exp_f32 v54, v54
  v_exp_f32 v55, v55
  v_exp_f32 v76, v76
  v_exp_f32 v77, v77
  v_exp_f32 v78, v78
  v_exp_f32 v79, v79
  v_add_f32 v25, v52, v53
  v_add_f32 v25, v25, v54
  v_add_f32 v25, v25, v55
  v_add_f32 v25, v25, v76
  v_add_f32 v25, v25, v77
  v_add_f32 v25, v25, v78
  v_add_f32 v25, v25, v79
  v_cvt_pk_bf16_f32 v52, v52, v52
  v_cvt_pk_bf16_f32 v53, v53, v53
  v_cvt_pk_bf16_f32 v54, v54, v54
  v_cvt_pk_bf16_f32 v55, v55, v55
  v_cvt_pk_bf16_f32 v76, v76, v76
  v_cvt_pk_bf16_f32 v77, v77, v77
  v_cvt_pk_bf16_f32 v78, v78, v78
  v_cvt_pk_bf16_f32 v79, v79, v79
  s_waitcnt vmcnt(6)
  buffer_load_dwordx4 v[16:19], v4, s[12:15], s57 offen offset:3200 nt
  v_and_b32 v26, 16, v5
  v_mov_b32 v27, 0xffff
  v_lshlrev_b32 v26, v26, v27
  v_bfe_u32 v27, v5, 5, 2
  v_cmp_eq_u32 vcc, 0, v27
  s_nop 1
  v_cndmask_b32 v20, 0, v26, vcc
  v_cmp_eq_u32 vcc, 1, v27
  s_nop 1
  v_cndmask_b32 v21, 0, v26, vcc
  v_cmp_eq_u32 vcc, 2, v27
  s_nop 1
  v_cndmask_b32 v22, 0, v26, vcc
  v_cmp_eq_u32 vcc, 3, v27
  s_nop 1
  v_cndmask_b32 v23, 0, v26, vcc
  v_bfe_u32 v68, v5, 7, 2
  v_lshlrev_b32 v68, 4, v68
  v_lshrrev_b32 v69, 9, v5
  v_lshl_add_u32 v68, v69, 3, v68
  v_bfe_u32 v69, v5, 4, 3
  v_add_lshl_u32 v68, v68, v69, 2
  s_mul_i32 s58, s56, 768
  s_add_u32 s58, s58, 159744
  v_add_u32 v68, s58, v68
  v_lshrrev_b32 v70, 8, v5
  v_bfe_u32 v69, v5, 4, 2
  v_lshl_add_u32 v70, v70, 2, v69
  v_bfe_u32 v69, v5, 7, 1
  v_lshl_add_u32 v70, v70, 1, v69
  v_lshlrev_b32 v70, 7, v70
  v_bfe_u32 v69, v5, 6, 1
  v_lshl_add_u32 v70, v69, 3, v70
  v_add_u32 v69, s71, v5
  s_lshl_b32 s58, s56, 3
  s_add_u32 s58, s58, 162848
  v_mov_b32 v71, s58
  v_and_b32 v72, v52, v20
  v_and_b32 v73, v52, v21
  v_and_b32_dpp v74, v52, v22 row_shr:4 row_mask:0xf bank_mask:0xf bound_ctrl:0
  v_and_b32_dpp v75, v52, v23 row_shr:4 row_mask:0xf bank_mask:0xf bound_ctrl:0
  ds_read_b128 v[80:83], v69 offset:0
  ds_read_b128 v[84:87], v69 offset:1024
  ds_read_b128 v[88:91], v69 offset:2048
  s_waitcnt lgkmcnt(0)
  ds_read_b128 v[92:95], v69 offset:3072
  ds_read_b128 v[96:99], v69 offset:4096
  ds_read_b128 v[100:103], v69 offset:5120
  v_mfma_f32_16x16x32_bf16 v[104:107], v[80:83], v[72:75], 0
  v_and_b32 v82, v52, v22
  v_and_b32 v83, v52, v23
  v_mfma_f32_16x16x32_bf16 v[108:111], v[84:87], v[72:75], 0
  v_and_b32_dpp v80, v52, v20 row_shl:4 row_mask:0xf bank_mask:0xf bound_ctrl:0
  v_and_b32_dpp v81, v52, v21 row_shl:4 row_mask:0xf bank_mask:0xf bound_ctrl:0
  v_add_f32_dpp v25, v25, v25 row_ror:4 row_mask:0xf bank_mask:0xf
  v_mfma_f32_16x16x32_bf16 v[84:87], v[88:91], v[72:75], 0
  s_nop 0
  v_add_f32_dpp v25, v25, v25 row_ror:8 row_mask:0xf bank_mask:0xf
  s_waitcnt vmcnt(6)
  buffer_load_dwordx4 v[72:75], v4, s[12:15], s57 offen offset:3328 nt
  s_waitcnt lgkmcnt(0)
  ds_read_b128 v[88:91], v69 offset:6144
  ds_read_b128 v[112:115], v69 offset:7168
  ds_read_b128 v[116:119], v69 offset:8192
  v_mfma_f32_16x16x32_bf16 v[104:107], v[92:95], v[80:83], v[104:107]
  v_and_b32 v92, v53, v20
  v_and_b32 v93, v53, v21
  v_mfma_f32_16x16x32_bf16 v[108:111], v[96:99], v[80:83], v[108:111]
  v_and_b32_dpp v94, v53, v22 row_shr:4 row_mask:0xf bank_mask:0xf bound_ctrl:0
  v_and_b32_dpp v95, v53, v23 row_shr:4 row_mask:0xf bank_mask:0xf bound_ctrl:0
  v_add_f32_dpp v25, v25, v25 row_bcast:15 row_mask:0xa bank_mask:0xf
  v_mfma_f32_16x16x32_bf16 v[84:87], v[100:103], v[80:83], v[84:87]
  s_nop 0
  v_add_f32_dpp v25, v25, v25 row_bcast:31 row_mask:0xc bank_mask:0xf
  s_waitcnt vmcnt(6)
  s_mov_b32 s57, 0x3001800
  buffer_load_dwordx4 v[80:83], v4, s[12:15], s57 offen offset:0 nt
  s_waitcnt lgkmcnt(0)
  v_mfma_f32_16x16x32_bf16 v[104:107], v[88:91], v[92:95], v[104:107]
  v_and_b32 v90, v53, v22
  v_and_b32 v91, v53, v23
  v_mfma_f32_16x16x32_bf16 v[108:111], v[112:115], v[92:95], v[108:111]
  v_and_b32_dpp v88, v53, v20 row_shl:4 row_mask:0xf bank_mask:0xf bound_ctrl:0
  v_and_b32_dpp v89, v53, v21 row_shl:4 row_mask:0xf bank_mask:0xf bound_ctrl:0
  v_mfma_f32_16x16x32_bf16 v[84:87], v[116:119], v[92:95], v[84:87]
  s_mov_b32 exec_lo, 0x0
  s_mov_b32 exec_hi, 0x80000000
  ds_write_b64 v71, v[24:25]
  s_mov_b64 exec, -1
  s_waitcnt vmcnt(6)
  buffer_load_dwordx4 v[24:27], v4, s[12:15], s57 offen offset:128 nt
  v_mfma_f32_16x16x32_bf16 v[104:107], a[160:163], v[88:91], v[104:107]
  v_and_b32 v92, v54, v20
  v_and_b32 v93, v54, v21
  v_mfma_f32_16x16x32_bf16 v[108:111], a[164:167], v[88:91], v[108:111]
  v_and_b32_dpp v94, v54, v22 row_shr:4 row_mask:0xf bank_mask:0xf bound_ctrl:0
  v_and_b32_dpp v95, v54, v23 row_shr:4 row_mask:0xf bank_mask:0xf bound_ctrl:0
  v_mfma_f32_16x16x32_bf16 v[84:87], a[168:171], v[88:91], v[84:87]
  s_mov_b32 exec_lo, 0x1010101
  s_mov_b32 exec_hi, 0x0
  buffer_load_dword v88, v5, s[96:99], s55 offen
  s_mov_b64 exec, -1
  v_lshlrev_b32 v90, 3, v5
  s_add_u32 s58, s77, 131072
  s_mov_b32 exec_lo, 0x7f
  s_mov_b32 exec_hi, 0x0
  buffer_load_dword v91, v90, s[36:39], s58 offen sc1
  s_mov_b64 exec, -1
  v_and_b32 v96, 0x70, v5
  s_cmp_lt_u32 s56, 3
  s_cbranch_scc0 L_w_98
  s_add_u32 s73, s65, 786432
  buffer_load_dwordx2 v[100:101], v96, s[36:39], s73 offen offset:3072 sc1
  buffer_load_dwordx4 v[112:115], v5, s[36:39], s73 offen offset:0 sc1
  buffer_load_dwordx4 v[116:119], v5, s[36:39], s73 offen offset:1024 sc1
  buffer_load_dwordx4 v[120:123], v5, s[36:39], s73 offen offset:2048 sc1
  s_mov_b64 exec, -1
L_w_98:
  s_waitcnt vmcnt(12)
  s_mov_b32 s57, 0x3001800
  buffer_load_dwordx4 v[124:127], v4, s[12:15], s57 offen offset:256 nt
  s_waitcnt vmcnt(12)
  buffer_load_dwordx4 v[128:131], v4, s[12:15], s57 offen offset:3072 nt
  s_waitcnt vmcnt(12)
  buffer_load_dwordx4 v[132:135], v4, s[12:15], s57 offen offset:3200 nt
  s_waitcnt vmcnt(12)
  buffer_load_dwordx4 v[136:139], v4, s[12:15], s57 offen offset:3328 nt
  s_waitcnt vmcnt(12)
  s_mov_b32 s57, 0x3009000
  buffer_load_dwordx4 v[140:143], v1, s[8:11], s57 offen offset:384
  s_waitcnt vmcnt(12)
  buffer_load_dwordx4 v[144:147], v1, s[8:11], s57 offen offset:512
  s_waitcnt vmcnt(12)
  buffer_load_dwordx4 v[148:151], v1, s[8:11], s57 offen offset:640
  s_waitcnt vmcnt(6)
  s_mov_b32 s57, 0x300a800
  buffer_load_dwordx4 v[152:155], v1, s[8:11], s57 offen offset:0
  v_lshrrev_b32 v97, 8, v5
  v_bfe_u32 v98, v5, 7, 1
  v_mul_u32_u24 v98, 192, v98
  v_lshl_add_u32 v97, v97, 4, v98
  v_lshrrev_b32 v98, 6, v5
  v_mul_u32_u24 v98, 160, v98
  v_bfe_u32 v99, v5, 4, 2
  v_lshl_add_u32 v98, v99, 3, v98
  s_lshl_b32 s58, s56, 5
  s_add_u32 s58, s58, 92160
  v_add_u32 v98, s58, v98
  s_cmp_lt_u32 s56, 3
  s_cbranch_scc0 L_w_99
  ds_read_b64_tr_b16 v[156:157], v98 offset:0
  ds_read_b64_tr_b16 v[158:159], v98 offset:2560
  ds_read_b64_tr_b16 v[160:161], v98 offset:5120
  ds_read_b64_tr_b16 v[162:163], v98 offset:7680
  ds_read_b64_tr_b16 v[192:193], v98 offset:10240
  ds_read_b64_tr_b16 v[194:195], v98 offset:12800
  ds_read_b64_tr_b16 v[196:197], v98 offset:15360
  ds_read_b64_tr_b16 v[198:199], v98 offset:17920
  ds_read_b64_tr_b16 v[200:201], v98 offset:20480
  ds_read_b64_tr_b16 v[202:203], v98 offset:23040
  ds_read_b64_tr_b16 v[204:205], v98 offset:25600
  ds_read_b64_tr_b16 v[206:207], v98 offset:28160
  ds_read_b64_tr_b16 v[208:209], v98 offset:96
  ds_read_b64_tr_b16 v[210:211], v98 offset:2656
  ds_read_b64_tr_b16 v[212:213], v98 offset:5216
  ds_read_b64_tr_b16 v[214:215], v98 offset:7776
  ds_read_b64_tr_b16 v[216:217], v98 offset:10336
  ds_read_b64_tr_b16 v[218:219], v98 offset:12896
  ds_read_b64_tr_b16 v[220:221], v98 offset:15456
  ds_read_b64_tr_b16 v[222:223], v98 offset:18016
  ds_read_b64_tr_b16 v[224:225], v98 offset:20576
  ds_read_b64_tr_b16 v[226:227], v98 offset:23136
  ds_read_b64_tr_b16 v[228:229], v98 offset:25696
  ds_read_b64_tr_b16 v[230:231], v98 offset:28256
L_w_99:
  s_lshl_b32 s58, s56, 6
  s_add_u32 s74, s66, s58
  s_add_u32 s74, s74, 786432
  s_cmp_lt_u32 s56, 3
  s_cbranch_scc0 L_w_100
  s_mov_b32 s72, 0
  s_waitcnt vmcnt(8)
L_chk_101:
  v_max3_u32 v102, v100, v101, v112
  v_max3_u32 v103, v113, v114, v115
  v_max3_u32 v102, v102, v116, v117
  v_max3_u32 v103, v103, v118, v119
  v_max3_u32 v102, v102, v120, v121
  v_max3_u32 v103, v103, v122, v123
  v_max_u32 v102, v102, v103
  v_cmp_eq_u32 vcc, -1, v102
  s_cbranch_vccz L_ok_102
  s_add_u32 s72, s72, 1
  s_cmp_ge_u32 s72, 65536
  s_cbranch_scc1 L_ok_102
  s_add_u32 s73, s65, 786432
  buffer_load_dwordx2 v[100:101], v96, s[36:39], s73 offen offset:3072 sc1
  buffer_load_dwordx4 v[112:115], v5, s[36:39], s73 offen offset:0 sc1
  buffer_load_dwordx4 v[116:119], v5, s[36:39], s73 offen offset:1024 sc1
  buffer_load_dwordx4 v[120:123], v5, s[36:39], s73 offen offset:2048 sc1
  s_waitcnt vmcnt(0)
  s_branch L_chk_101
L_ok_102:
  s_waitcnt lgkmcnt(0)
  v_mfma_f32_16x16x32_bf16 v[232:235], v[156:159], v[112:115], 0
  v_min_f32_dpp v102, v100, v100 quad_perm:[1,0,3,2] row_mask:0xf bank_mask:0xf
  v_mfma_f32_16x16x32_bf16 v[156:159], v[160:163], v[112:115], 0
  s_nop 0
  v_min_f32_dpp v102, v102, v102 quad_perm:[2,3,0,1] row_mask:0xf bank_mask:0xf
  v_mfma_f32_16x16x32_bf16 v[232:235], v[192:195], v[116:119], v[232:235]
  s_nop 0
  v_min_f32_dpp v102, v102, v102 row_half_mirror row_mask:0xf bank_mask:0xf
  v_mfma_f32_16x16x32_bf16 v[156:159], v[196:199], v[116:119], v[156:159]
  v_sub_f32 v100, v102, v100
  v_exp_f32 v100, v100
  v_mfma_f32_16x16x32_bf16 v[232:235], v[200:203], v[120:123], v[232:235]
  v_mul_f32 v101, v100, v101
  v_mfma_f32_16x16x32_bf16 v[156:159], v[204:207], v[120:123], v[156:159]
  s_nop 0
  v_add_f32_dpp v101, v101, v101 quad_perm:[1,0,3,2] row_mask:0xf bank_mask:0xf
  v_mfma_f32_16x16x32_bf16 v[160:163], v[208:211], v[112:115], 0
  s_nop 0
  v_add_f32_dpp v101, v101, v101 quad_perm:[2,3,0,1] row_mask:0xf bank_mask:0xf
  v_mfma_f32_16x16x32_bf16 v[192:195], v[212:215], v[112:115], 0
  s_nop 0
  v_add_f32_dpp v101, v101, v101 row_half_mirror row_mask:0xf bank_mask:0xf
  v_mfma_f32_16x16x32_bf16 v[160:163], v[216:219], v[116:119], v[160:163]
  v_rcp_f32 v101, v101
  s_nop 0
  v_mul_f32 v100, v100, v101
  v_mfma_f32_16x16x32_bf16 v[192:195], v[220:223], v[116:119], v[192:195]
  v_add_f32_dpp v112, v156, v232 row_shl:8 row_mask:0xf bank_mask:0x3
  v_add_f32_dpp v113, v157, v233 row_shl:8 row_mask:0xf bank_mask:0x3
  v_mfma_f32_16x16x32_bf16 v[160:163], v[224:227], v[120:123], v[160:163]
  v_add_f32_dpp v114, v158, v234 row_shl:8 row_mask:0xf bank_mask:0x3
  v_add_f32_dpp v115, v159, v235 row_shl:8 row_mask:0xf bank_mask:0x3
  v_mfma_f32_16x16x32_bf16 v[192:195], v[228:231], v[120:123], v[192:195]
  s_cmp_lt_u32 s56, 2
  s_mov_b32 s58, 0x00010001
  s_cselect_b32 s58, 0x01010101, s58
  s_nop 4
  v_add_f32_dpp v112, v160, v192 row_shr:8 row_mask:0xf bank_mask:0xc
  v_add_f32_dpp v113, v161, v193 row_shr:8 row_mask:0xf bank_mask:0xc
  v_add_f32_dpp v114, v162, v194 row_shr:8 row_mask:0xf bank_mask:0xc
  v_add_f32_dpp v115, v163, v195 row_shr:8 row_mask:0xf bank_mask:0xc
  v_mul_f32 v112, v100, v112
  v_mul_f32 v113, v100, v113
  v_mul_f32 v114, v100, v114
  v_mul_f32 v115, v100, v115
  v_add_f32_dpp v112, v112, v112 quad_perm:[1,0,3,2] row_mask:0xf bank_mask:0xf
  v_add_f32_dpp v113, v113, v113 quad_perm:[1,0,3,2] row_mask:0xf bank_mask:0xf
  v_add_f32_dpp v114, v114, v114 quad_perm:[1,0,3,2] row_mask:0xf bank_mask:0xf
  v_add_f32_dpp v115, v115, v115 quad_perm:[1,0,3,2] row_mask:0xf bank_mask:0xf
  v_add_f32_dpp v112, v112, v112 quad_perm:[2,3,0,1] row_mask:0xf bank_mask:0xf
  v_add_f32_dpp v113, v113, v113 quad_perm:[2,3,0,1] row_mask:0xf bank_mask:0xf
  v_add_f32_dpp v114, v114, v114 quad_perm:[2,3,0,1] row_mask:0xf bank_mask:0xf
  v_add_f32_dpp v115, v115, v115 quad_perm:[2,3,0,1] row_mask:0xf bank_mask:0xf
  v_add_f32_dpp v112, v112, v112 row_half_mirror row_mask:0xf bank_mask:0xf
  v_add_f32_dpp v113, v113, v113 row_half_mirror row_mask:0xf bank_mask:0xf
  v_add_f32_dpp v114, v114, v114 row_half_mirror row_mask:0xf bank_mask:0xf
  v_add_f32_dpp v115, v115, v115 row_half_mirror row_mask:0xf bank_mask:0xf
  s_mov_b32 exec_lo, s58
  s_mov_b32 exec_hi, s58
  buffer_store_dwordx4 v[112:115], v97, s[36:39], s74 offen sc1
  s_mov_b64 exec, -1
L_w_100:
  s_waitcnt vmcnt(7)
  s_mov_b32 s57, 0x300a800
  buffer_load_dwordx4 v[88:91], v1, s[8:11], s57 offen offset:128
  v_mfma_f32_16x16x32_bf16 v[104:107], a[172:175], v[92:95], v[104:107]
  v_and_b32 v98, v54, v22
  v_and_b32 v99, v54, v23
  v_mfma_f32_16x16x32_bf16 v[108:111], a[176:179], v[92:95], v[108:111]
  v_and_b32_dpp v96, v54, v20 row_shl:4 row_mask:0xf bank_mask:0xf bound_ctrl:0
  v_and_b32_dpp v97, v54, v21 row_shl:4 row_mask:0xf bank_mask:0xf bound_ctrl:0
  v_mfma_f32_16x16x32_bf16 v[84:87], a[180:183], v[92:95], v[84:87]
  s_waitcnt vmcnt(7)
  buffer_load_dwordx4 v[92:95], v1, s[8:11], s57 offen offset:256
  v_mfma_f32_16x16x32_bf16 v[104:107], a[184:187], v[96:99], v[104:107]
  v_and_b32 v100, v55, v20
  v_and_b32 v101, v55, v21
  v_mfma_f32_16x16x32_bf16 v[108:111], a[188:191], v[96:99], v[108:111]
  v_and_b32_dpp v102, v55, v22 row_shr:4 row_mask:0xf bank_mask:0xf bound_ctrl:0
  v_and_b32_dpp v103, v55, v23 row_shr:4 row_mask:0xf bank_mask:0xf bound_ctrl:0
  v_mfma_f32_16x16x32_bf16 v[84:87], a[192:195], v[96:99], v[84:87]
  s_waitcnt vmcnt(7)
  buffer_load_dwordx4 v[96:99], v1, s[8:11], s57 offen offset:384
  v_mfma_f32_16x16x32_bf16 v[104:107], a[196:199], v[100:103], v[104:107]
  v_and_b32 v114, v55, v22
  v_and_b32 v115, v55, v23
  v_mfma_f32_16x16x32_bf16 v[108:111], a[200:203], v[100:103], v[108:111]
  v_and_b32_dpp v112, v55, v20 row_shl:4 row_mask:0xf bank_mask:0xf bound_ctrl:0
  v_and_b32_dpp v113, v55, v21 row_shl:4 row_mask:0xf bank_mask:0xf bound_ctrl:0
  v_mfma_f32_16x16x32_bf16 v[84:87], a[204:207], v[100:103], v[84:87]
  s_waitcnt vmcnt(7)
  buffer_load_dwordx4 v[52:55], v1, s[8:11], s57 offen offset:512
  v_mfma_f32_16x16x32_bf16 v[104:107], a[208:211], v[112:115], v[104:107]
  v_and_b32 v100, v76, v20
  v_and_b32 v101, v76, v21
  v_mfma_f32_16x16x32_bf16 v[108:111], a[212:215], v[112:115], v[108:111]
  v_and_b32_dpp v102, v76, v22 row_shr:4 row_mask:0xf bank_mask:0xf bound_ctrl:0
  v_and_b32_dpp v103, v76, v23 row_shr:4 row_mask:0xf bank_mask:0xf bound_ctrl:0
  v_mfma_f32_16x16x32_bf16 v[84:87], a[216:219], v[112:115], v[84:87]
  s_waitcnt vmcnt(7)
  buffer_load_dwordx4 v[112:115], v1, s[8:11], s57 offen offset:640
  v_mfma_f32_16x16x32_bf16 v[104:107], a[220:223], v[100:103], v[104:107]
  v_and_b32 v118, v76, v22
  v_and_b32 v119, v76, v23
  v_mfma_f32_16x16x32_bf16 v[108:111], a[224:227], v[100:103], v[108:111]
  v_and_b32_dpp v116, v76, v20 row_shl:4 row_mask:0xf bank_mask:0xf bound_ctrl:0
  v_and_b32_dpp v117, v76, v21 row_shl:4 row_mask:0xf bank_mask:0xf bound_ctrl:0
  v_mfma_f32_16x16x32_bf16 v[84:87], a[228:231], v[100:103], v[84:87]
  s_nop 0
  v_mfma_f32_16x16x32_bf16 v[104:107], a[232:235], v[116:119], v[104:107]
  v_and_b32 v100, v77, v20
  v_and_b32 v101, v77, v21
  v_mfma_f32_16x16x32_bf16 v[108:111], a[236:239], v[116:119], v[108:111]
  v_and_b32_dpp v102, v77, v22 row_shr:4 row_mask:0xf bank_mask:0xf bound_ctrl:0
  v_and_b32_dpp v103, v77, v23 row_shr:4 row_mask:0xf bank_mask:0xf bound_ctrl:0
  v_mfma_f32_16x16x32_bf16 v[84:87], a[240:243], v[116:119], v[84:87]
  s_nop 0
  v_mfma_f32_16x16x32_bf16 v[104:107], a[244:247], v[100:103], v[104:107]
  v_and_b32 v118, v77, v22
  v_and_b32 v119, v77, v23
  v_mfma_f32_16x16x32_bf16 v[108:111], a[248:251], v[100:103], v[108:111]
  v_and_b32_dpp v116, v77, v20 row_shl:4 row_mask:0xf bank_mask:0xf bound_ctrl:0
  v_and_b32_dpp v117, v77, v21 row_shl:4 row_mask:0xf bank_mask:0xf bound_ctrl:0
  v_mfma_f32_16x16x32_bf16 v[84:87], a[252:255], v[100:103], v[84:87]
  s_nop 0
  v_mfma_f32_16x16x32_bf16 v[104:107], v[64:67], v[116:119], v[104:107]
  v_and_b32 v100, v78, v20
  v_and_b32 v101, v78, v21
  v_mfma_f32_16x16x32_bf16 v[108:111], v[28:31], v[116:119], v[108:111]
  v_and_b32_dpp v102, v78, v22 row_shr:4 row_mask:0xf bank_mask:0xf bound_ctrl:0
  v_and_b32_dpp v103, v78, v23 row_shr:4 row_mask:0xf bank_mask:0xf bound_ctrl:0
  v_mfma_f32_16x16x32_bf16 v[84:87], v[40:43], v[116:119], v[84:87]
  s_nop 0
  v_mfma_f32_16x16x32_bf16 v[104:107], v[32:35], v[100:103], v[104:107]
  v_and_b32 v118, v78, v22
  v_and_b32 v119, v78, v23
  v_mfma_f32_16x16x32_bf16 v[108:111], v[44:47], v[100:103], v[108:111]
  v_and_b32_dpp v116, v78, v20 row_shl:4 row_mask:0xf bank_mask:0xf bound_ctrl:0
  v_and_b32_dpp v117, v78, v21 row_shl:4 row_mask:0xf bank_mask:0xf bound_ctrl:0
  v_mfma_f32_16x16x32_bf16 v[84:87], v[36:39], v[100:103], v[84:87]
  s_waitcnt vmcnt(6)
  v_mfma_f32_16x16x32_bf16 v[104:107], v[140:143], v[116:119], v[104:107]
  v_and_b32 v100, v79, v20
  v_and_b32 v101, v79, v21
  v_mfma_f32_16x16x32_bf16 v[108:111], v[144:147], v[116:119], v[108:111]
  v_and_b32_dpp v102, v79, v22 row_shr:4 row_mask:0xf bank_mask:0xf bound_ctrl:0
  v_and_b32_dpp v103, v79, v23 row_shr:4 row_mask:0xf bank_mask:0xf bound_ctrl:0
  v_mfma_f32_16x16x32_bf16 v[84:87], v[148:151], v[116:119], v[84:87]
  s_waitcnt vmcnt(3)
  v_mfma_f32_16x16x32_bf16 v[104:107], v[152:155], v[100:103], v[104:107]
  v_and_b32 v118, v79, v22
  v_and_b32 v119, v79, v23
  v_mfma_f32_16x16x32_bf16 v[108:111], v[88:91], v[100:103], v[108:111]
  v_and_b32_dpp v116, v79, v20 row_shl:4 row_mask:0xf bank_mask:0xf bound_ctrl:0
  v_and_b32_dpp v117, v79, v21 row_shl:4 row_mask:0xf bank_mask:0xf bound_ctrl:0
  v_mfma_f32_16x16x32_bf16 v[84:87], v[92:95], v[100:103], v[84:87]
  s_waitcnt vmcnt(0)
  v_mfma_f32_16x16x32_bf16 v[104:107], v[96:99], v[116:119], v[104:107]
  v_mfma_f32_16x16x32_bf16 v[108:111], v[52:55], v[116:119], v[108:111]
  v_mfma_f32_16x16x32_bf16 v[84:87], v[112:115], v[116:119], v[84:87]
  v_mov_b32 v20, 162848
  v_add_u32 v21, 159744, v5
  s_add_u32 s73, s64, 131072
  s_nop 2
  v_permlane32_swap_b32 v104, v105
  v_permlane32_swap_b32 v106, v107
  v_permlane32_swap_b32 v108, v109
  v_permlane32_swap_b32 v110, v111
  v_permlane32_swap_b32 v84, v85
  v_permlane32_swap_b32 v86, v87
  v_add_f32_dpp v52, v105, v104 row_shl:8 row_mask:0xf bank_mask:0x3
  v_add_f32_dpp v53, v109, v108 row_shl:8 row_mask:0xf bank_mask:0x3
  v_add_f32_dpp v54, v85, v84 row_shl:8 row_mask:0xf bank_mask:0x3
  v_add_f32_dpp v52, v106, v107 row_shr:8 row_mask:0xf bank_mask:0xc
  v_add_f32_dpp v53, v110, v111 row_shr:8 row_mask:0xf bank_mask:0xc
  v_add_f32_dpp v54, v86, v87 row_shr:8 row_mask:0xf bank_mask:0xc
  ds_write_b32 v68, v52 offset:0
  ds_write_b32 v68, v53 offset:256
  ds_write_b32 v68, v54 offset:512
  s_waitcnt lgkmcnt(0)
  s_barrier
  s_cmp_eq_u32 s56, 3
  s_cbranch_scc0 L_w_103
  ds_read_b128 v[52:55], v20
  ds_read_b128 v[76:79], v20 offset:16
  ds_read_b128 v[84:87], v21 offset:0
  ds_read_b128 v[88:91], v21 offset:768
  ds_read_b128 v[92:95], v21 offset:1536
  ds_read_b128 v[96:99], v21 offset:2304
  s_mov_b32 vcc_lo, 0
  s_mov_b32 vcc_hi, 0xffff0000
  s_mov_b32 exec_hi, 0x1ffff
  s_waitcnt lgkmcnt(4)
  v_min3_f32 v20, v52, v54, v76
  v_min_f32 v20, v20, v78
  v_sub_f32 v52, v20, v52
  v_sub_f32 v54, v20, v54
  v_sub_f32 v76, v20, v76
  v_sub_f32 v78, v20, v78
  v_exp_f32 v52, v52
  v_exp_f32 v54, v54
  v_exp_f32 v76, v76
  v_exp_f32 v78, v78
  s_waitcnt lgkmcnt(0)
  v_pk_mul_f32 v[84:85], v[84:85], v[52:53] op_sel_hi:[1,0]
  v_pk_mul_f32 v[86:87], v[86:87], v[52:53] op_sel_hi:[1,0]
  v_mul_f32 v53, v52, v53
  v_pk_mul_f32 v[92:93], v[92:93], v[76:77] op_sel_hi:[1,0]
  v_pk_mul_f32 v[94:95], v[94:95], v[76:77] op_sel_hi:[1,0]
  v_mul_f32 v77, v76, v77
  v_pk_fma_f32 v[84:85], v[88:89], v[54:55], v[84:85] op_sel_hi:[1,0,1]
  v_pk_fma_f32 v[86:87], v[90:91], v[54:55], v[86:87] op_sel_hi:[1,0,1]
  v_fmac_f32 v53, v54, v55
  v_pk_fma_f32 v[92:93], v[96:97], v[78:79], v[92:93] op_sel_hi:[1,0,1]
  v_pk_fma_f32 v[94:95], v[98:99], v[78:79], v[94:95] op_sel_hi:[1,0,1]
  v_fmac_f32 v77, v78, v79
  v_pk_add_f32 v[84:85], v[84:85], v[92:93]
  v_pk_add_f32 v[86:87], v[86:87], v[94:95]
  v_add_f32 v21, v53, v77
  v_cvt_pk_bf16_f32 v88, v84, v85
  v_cvt_pk_bf16_f32 v89, v86, v87
  v_cndmask_b32 v88, v88, v20, vcc
  v_cndmask_b32 v89, v89, v21, vcc
  s_cmp_eq_u32 s75, 0
  s_cbranch_scc1 L_slow_104
  buffer_store_dwordx2 v[88:89], v70, s[36:39], s73 offen
  s_branch L_pub_105
L_slow_104:
  buffer_store_dwordx2 v[88:89], v70, s[36:39], s73 offen sc1
L_pub_105:
  s_mov_b64 exec, -1
L_w_103:
  v_and_b32 v20, 0x70, v5
  s_sleep 3
  v_lshrrev_b32 v21, 8, v5
  v_bfe_u32 v22, v5, 7, 1
  v_mul_u32_u24 v22, 192, v22
  v_lshl_add_u32 v21, v21, 4, v22
  v_lshrrev_b32 v22, 6, v5
  v_mul_u32_u24 v22, 160, v22
  v_bfe_u32 v23, v5, 4, 2
  v_lshl_add_u32 v22, v23, 3, v22
  s_lshl_b32 s58, s56, 5
  s_add_u32 s58, s58, 30720
  v_add_u32 v22, s58, v22
  s_cmp_lt_u32 s56, 3
  s_cbranch_scc0 L_w_106
  ds_read_b64_tr_b16 v[52:53], v22 offset:0
  ds_read_b64_tr_b16 v[54:55], v22 offset:2560
  ds_read_b64_tr_b16 v[68:69], v22 offset:5120
  ds_read_b64_tr_b16 v[70:71], v22 offset:7680
  ds_read_b64_tr_b16 v[76:77], v22 offset:10240
  ds_read_b64_tr_b16 v[78:79], v22 offset:12800
  ds_read_b64_tr_b16 v[84:85], v22 offset:15360
  ds_read_b64_tr_b16 v[86:87], v22 offset:17920
  ds_read_b64_tr_b16 v[88:89], v22 offset:20480
  ds_read_b64_tr_b16 v[90:91], v22 offset:23040
  ds_read_b64_tr_b16 v[92:93], v22 offset:25600
  ds_read_b64_tr_b16 v[94:95], v22 offset:28160
  ds_read_b64_tr_b16 v[96:97], v22 offset:96
  ds_read_b64_tr_b16 v[98:99], v22 offset:2656
  ds_read_b64_tr_b16 v[100:101], v22 offset:5216
  ds_read_b64_tr_b16 v[102:103], v22 offset:7776
  ds_read_b64_tr_b16 v[104:105], v22 offset:10336
  ds_read_b64_tr_b16 v[106:107], v22 offset:12896
  ds_read_b64_tr_b16 v[108:109], v22 offset:15456
  ds_read_b64_tr_b16 v[110:111], v22 offset:18016
  ds_read_b64_tr_b16 v[112:113], v22 offset:20576
  ds_read_b64_tr_b16 v[114:115], v22 offset:23136
  ds_read_b64_tr_b16 v[116:117], v22 offset:25696
  ds_read_b64_tr_b16 v[118:119], v22 offset:28256
L_w_106:
  s_lshl_b32 s58, s56, 6
  s_add_u32 s74, s66, s58
  s_add_u32 s74, s74, 131072
  s_cmp_lt_u32 s56, 3
  s_cbranch_scc0 L_w_107
  s_mov_b32 s72, 0
L_poll_108:
  s_add_u32 s73, s65, 131072
  buffer_load_dwordx2 v[120:121], v20, s[36:39], s73 offen offset:3072 sc1
  buffer_load_dwordx4 v[140:143], v5, s[36:39], s73 offen offset:0 sc1
  buffer_load_dwordx4 v[144:147], v5, s[36:39], s73 offen offset:1024 sc1
  buffer_load_dwordx4 v[148:151], v5, s[36:39], s73 offen offset:2048 sc1
  s_add_u32 s72, s72, 1
  s_cmp_lt_u32 s72, 65536
  s_cselect_b64 s[60:61], -1, 0
  s_waitcnt vmcnt(0)
  v_max3_u32 v122, v120, v121, v140
  v_max3_u32 v123, v141, v142, v143
  v_max3_u32 v122, v122, v144, v145
  v_max3_u32 v123, v123, v146, v147
  v_max3_u32 v122, v122, v148, v149
  v_max3_u32 v123, v123, v150, v151
  v_max_u32 v122, v122, v123
  v_cmp_eq_u32 vcc, -1, v122
  s_and_b64 vcc, vcc, s[60:61]
  s_cbranch_vccnz L_poll_108
  s_waitcnt lgkmcnt(0)
  v_mfma_f32_16x16x32_bf16 v[152:155], v[52:55], v[140:143], 0
  v_min_f32_dpp v122, v120, v120 quad_perm:[1,0,3,2] row_mask:0xf bank_mask:0xf
  v_mfma_f32_16x16x32_bf16 v[52:55], v[68:71], v[140:143], 0
  s_nop 0
  v_min_f32_dpp v122, v122, v122 quad_perm:[2,3,0,1] row_mask:0xf bank_mask:0xf
  v_mfma_f32_16x16x32_bf16 v[152:155], v[76:79], v[144:147], v[152:155]
  s_nop 0
  v_min_f32_dpp v122, v122, v122 row_half_mirror row_mask:0xf bank_mask:0xf
  v_mfma_f32_16x16x32_bf16 v[52:55], v[84:87], v[144:147], v[52:55]
  v_sub_f32 v120, v122, v120
  v_exp_f32 v120, v120
  v_mfma_f32_16x16x32_bf16 v[152:155], v[88:91], v[148:151], v[152:155]
  v_mul_f32 v121, v120, v121
  v_mfma_f32_16x16x32_bf16 v[52:55], v[92:95], v[148:151], v[52:55]
  s_nop 0
  v_add_f32_dpp v121, v121, v121 quad_perm:[1,0,3,2] row_mask:0xf bank_mask:0xf
  v_mfma_f32_16x16x32_bf16 v[68:71], v[96:99], v[140:143], 0
  s_nop 0
  v_add_f32_dpp v121, v121, v121 quad_perm:[2,3,0,1] row_mask:0xf bank_mask:0xf
  v_mfma_f32_16x16x32_bf16 v[76:79], v[100:103], v[140:143], 0
  s_nop 0
  v_add_f32_dpp v121, v121, v121 row_half_mirror row_mask:0xf bank_mask:0xf
  v_mfma_f32_16x16x32_bf16 v[68:71], v[104:107], v[144:147], v[68:71]
  v_rcp_f32 v121, v121
  s_nop 0
  v_mul_f32 v120, v120, v121
  v_mfma_f32_16x16x32_bf16 v[76:79], v[108:111], v[144:147], v[76:79]
  v_add_f32_dpp v84, v52, v152 row_shl:8 row_mask:0xf bank_mask:0x3
  v_add_f32_dpp v85, v53, v153 row_shl:8 row_mask:0xf bank_mask:0x3
  v_mfma_f32_16x16x32_bf16 v[68:71], v[112:115], v[148:151], v[68:71]
  v_add_f32_dpp v86, v54, v154 row_shl:8 row_mask:0xf bank_mask:0x3
  v_add_f32_dpp v87, v55, v155 row_shl:8 row_mask:0xf bank_mask:0x3
  v_mfma_f32_16x16x32_bf16 v[76:79], v[116:119], v[148:151], v[76:79]
  s_cmp_lt_u32 s56, 2
  s_mov_b32 s58, 0x00010001
  s_cselect_b32 s58, 0x01010101, s58
  s_nop 4
  v_add_f32_dpp v84, v68, v76 row_shr:8 row_mask:0xf bank_mask:0xc
  v_add_f32_dpp v85, v69, v77 row_shr:8 row_mask:0xf bank_mask:0xc
  v_add_f32_dpp v86, v70, v78 row_shr:8 row_mask:0xf bank_mask:0xc
  v_add_f32_dpp v87, v71, v79 row_shr:8 row_mask:0xf bank_mask:0xc
  v_mul_f32 v84, v120, v84
  v_mul_f32 v85, v120, v85
  v_mul_f32 v86, v120, v86
  v_mul_f32 v87, v120, v87
  v_add_f32_dpp v84, v84, v84 quad_perm:[1,0,3,2] row_mask:0xf bank_mask:0xf
  v_add_f32_dpp v85, v85, v85 quad_perm:[1,0,3,2] row_mask:0xf bank_mask:0xf
  v_add_f32_dpp v86, v86, v86 quad_perm:[1,0,3,2] row_mask:0xf bank_mask:0xf
  v_add_f32_dpp v87, v87, v87 quad_perm:[1,0,3,2] row_mask:0xf bank_mask:0xf
  v_add_f32_dpp v84, v84, v84 quad_perm:[2,3,0,1] row_mask:0xf bank_mask:0xf
  v_add_f32_dpp v85, v85, v85 quad_perm:[2,3,0,1] row_mask:0xf bank_mask:0xf
  v_add_f32_dpp v86, v86, v86 quad_perm:[2,3,0,1] row_mask:0xf bank_mask:0xf
  v_add_f32_dpp v87, v87, v87 quad_perm:[2,3,0,1] row_mask:0xf bank_mask:0xf
  v_add_f32_dpp v84, v84, v84 row_half_mirror row_mask:0xf bank_mask:0xf
  v_add_f32_dpp v85, v85, v85 row_half_mirror row_mask:0xf bank_mask:0xf
  v_add_f32_dpp v86, v86, v86 row_half_mirror row_mask:0xf bank_mask:0xf
  v_add_f32_dpp v87, v87, v87 row_half_mirror row_mask:0xf bank_mask:0xf
  s_mov_b32 exec_lo, s58
  s_mov_b32 exec_hi, s58
  buffer_store_dwordx4 v[84:87], v21, s[36:39], s74 offen sc1
  s_mov_b64 exec, -1
L_w_107:
  s_barrier
  v_lshrrev_b32 v21, 2, v5
  s_lshl_b32 s73, s56, 8
  s_add_u32 s73, s73, s70
  s_add_u32 s73, s73, 262144
  buffer_load_dword v20, v21, s[36:39], s73 offen sc1
  v_lshlrev_b32 v22, 3, v5
  s_add_u32 s58, s68, 794624
  s_add_u32 s59, s77, 393216
  s_cmp_eq_u32 s56, 1
  s_cselect_b32 s58, s59, s58
  s_mov_b32 exec_lo, 0x7f
  s_mov_b32 exec_hi, 0x0
  buffer_load_dword v23, v22, s[36:39], s58 offen sc1
  s_mov_b64 exec, -1
  s_mov_b32 s57, 0x3000000
  buffer_load_dwordx4 v[52:55], v1, s[16:19], s57 offen offset:0 nt
  buffer_load_dwordx4 v[68:71], v1, s[16:19], s57 offen offset:128 nt
  buffer_load_dwordx4 v[76:79], v1, s[16:19], s57 offen offset:256 nt
  buffer_load_dwordx4 v[84:87], v1, s[16:19], s57 offen offset:384 nt
  buffer_load_dwordx4 v[88:91], v1, s[16:19], s57 offen offset:512 nt
  buffer_load_dwordx4 v[92:95], v1, s[16:19], s57 offen offset:640 nt
  s_mov_b32 s57, 0x3001800
  buffer_load_dwordx4 v[96:99], v1, s[16:19], s57 offen offset:0 nt
  buffer_load_dwordx4 v[100:103], v1, s[16:19], s57 offen offset:128 nt
  buffer_load_dwordx4 v[104:107], v1, s[16:19], s57 offen offset:256 nt
  buffer_load_dwordx4 v[108:111], v1, s[16:19], s57 offen offset:384 nt
  buffer_load_dwordx4 v[112:115], v1, s[16:19], s57 offen offset:512 nt
  buffer_load_dwordx4 v[116:119], v1, s[16:19], s57 offen offset:640 nt
  v_bfe_u32 v120, v5, 5, 3
  v_add_u32 v121, -1, v120
  v_and_b32 v121, 3, v121
  v_add_u32 v121, 1, v121
  v_min_u32 v120, v121, v120
  v_lshrrev_b32 v121, 8, v5
  v_lshl_add_u32 v120, v120, 2, v121
  v_mul_u32_u24 v120, 16, v120
  v_bfe_u32 v121, v5, 4, 1
  v_mul_u32_u24 v121, 1280, v121
  v_add_u32 v120, v120, v121
  v_add_u32 v120, 159744, v120
  v_and_b32 v121, 0x1f0, v5
  v_lshrrev_b32 v122, 9, v5
  v_lshl_add_u32 v121, v122, 2, v121
  s_mul_i32 s58, s56, 320
  s_add_u32 s58, s58, 159744
  v_add_u32 v121, s58, v121
  v_lshrrev_b32 v122, 9, v5
  v_mul_u32_u24 v122, 3072, v122
  v_bfe_u32 v123, v5, 6, 3
  v_lshl_add_u32 v122, v123, 7, v122
  v_bfe_u32 v123, v5, 4, 2
  v_lshl_add_u32 v122, v123, 3, v122
  s_max_u32 s58, s56, 1
  s_lshl_b32 s58, s58, 10
  s_add_u32 s58, s58, 0xec00
  v_add_u32 v122, s58, v122
  v_bfe_u32 v123, v5, 7, 2
  v_lshl_add_u32 v140, v123, 5, v122
  v_xor_b32 v141, 32, v140
  v_xor_b32 v142, 64, v140
  v_xor_b32 v143, 96, v140
  ds_read_b64_tr_b16 v[144:145], v140 offset:24576
  ds_read_b64_tr_b16 v[146:147], v141 offset:24576
  ds_read_b64_tr_b16 v[148:149], v142 offset:24576
  ds_read_b64_tr_b16 v[150:151], v143 offset:24576
  ds_read_b64_tr_b16 v[152:153], v140 offset:0
  ds_read_b64_tr_b16 v[156:157], v141 offset:0
  ds_read_b64_tr_b16 v[160:161], v142 offset:0
  ds_read_b64_tr_b16 v[192:193], v143 offset:0
  ds_read_b64_tr_b16 v[154:155], v140 offset:6144
  ds_read_b64_tr_b16 v[158:159], v141 offset:6144
  ds_read_b64_tr_b16 v[162:163], v142 offset:6144
  ds_read_b64_tr_b16 v[194:195], v143 offset:6144
  ds_read_b64_tr_b16 v[196:197], v140 offset:12288
  ds_read_b64_tr_b16 v[200:201], v141 offset:12288
  ds_read_b64_tr_b16 v[204:205], v142 offset:12288
  ds_read_b64_tr_b16 v[208:209], v143 offset:12288
  ds_read_b64_tr_b16 v[198:199], v140 offset:18432
  ds_read_b64_tr_b16 v[202:203], v141 offset:18432
  ds_read_b64_tr_b16 v[206:207], v142 offset:18432
  ds_read_b64_tr_b16 v[210:211], v143 offset:18432
  v_lshrrev_b32 v122, 2, v5
  v_mov_b32 v123, 0x3f803f80
  v_lshlrev_b32 v140, 16, v2
  v_and_b32 v141, 0xffff0000, v2
  v_lshlrev_b32 v142, 16, v3
  v_and_b32 v143, 0xffff0000, v3
  s_mov_b32 exec_lo, 0xfffff
  s_mov_b32 exec_hi, 0xfffff
  s_lshl_b32 s73, s56, 12
  s_add_u32 s73, s73, s67
  s_add_u32 s73, s73, 786432
  buffer_load_dwordx4 v[212:215], v5, s[36:39], s73 offen offset:0 sc1
  buffer_load_dwordx4 v[216:219], v5, s[36:39], s73 offen offset:1024 sc1
  buffer_load_dwordx4 v[220:223], v5, s[36:39], s73 offen offset:2048 sc1
  buffer_load_dwordx4 v[224:227], v5, s[36:39], s73 offen offset:3072 sc1
  s_lshl_b32 s73, s56, 12
  s_add_u32 s73, s73, s67
  s_add_u32 s73, s73, 131072
  buffer_load_dwordx4 v[228:231], v5, s[36:39], s73 offen offset:0 sc1
  buffer_load_dwordx4 v[232:235], v5, s[36:39], s73 offen offset:1024 sc1
  buffer_load_dwordx4 v[236:239], v5, s[36:39], s73 offen offset:2048 sc1
  buffer_load_dwordx4 v[240:243], v5, s[36:39], s73 offen offset:3072 sc1
  s_mov_b64 exec, -1
  s_mov_b32 s72, 0
  s_waitcnt vmcnt(0)
L_chk_110:
  s_mov_b32 exec_lo, 0xfffff
  s_mov_b32 exec_hi, 0xfffff
  v_pk_add_f32 v[212:213], v[212:213], v[216:217]
  v_pk_add_f32 v[214:215], v[214:215], v[218:219]
  v_pk_add_f32 v[220:221], v[220:221], v[224:225]
  v_pk_add_f32 v[222:223], v[222:223], v[226:227]
  v_pk_add_f32 v[212:213], v[212:213], v[220:221]
  v_pk_add_f32 v[214:215], v[214:215], v[222:223]
  s_nop 0
  v_permlane32_swap_b32 v212, v213
  v_permlane32_swap_b32 v214, v215
  v_add_f32 v212, v212, v213
  v_add_f32 v214, v214, v215
  v_pk_add_f32 v[228:229], v[228:229], v[232:233]
  v_pk_add_f32 v[230:231], v[230:231], v[234:235]
  v_pk_add_f32 v[236:237], v[236:237], v[240:241]
  v_pk_add_f32 v[238:239], v[238:239], v[242:243]
  v_pk_add_f32 v[228:229], v[228:229], v[236:237]
  v_pk_add_f32 v[230:231], v[230:231], v[238:239]
  s_nop 0
  v_permlane32_swap_b32 v228, v229
  v_permlane32_swap_b32 v230, v231
  v_add_f32 v228, v228, v229
  v_add_f32 v230, v230, v231
  v_add_f32 v216, v212, v214
  v_add_f32 v217, v228, v230
  v_cmp_u_f32 vcc, v216, v217
  s_cbranch_vccz L_ok_111
  s_add_u32 s72, s72, 1
  s_cmp_ge_u32 s72, 65536
  s_cbranch_scc1 L_ok_111
  s_sleep 1
  s_mov_b32 exec_lo, 0xfffff
  s_mov_b32 exec_hi, 0xfffff
  s_lshl_b32 s73, s56, 12
  s_add_u32 s73, s73, s67
  s_add_u32 s73, s73, 786432
  buffer_load_dwordx4 v[212:215], v5, s[36:39], s73 offen offset:0 sc1
  buffer_load_dwordx4 v[216:219], v5, s[36:39], s73 offen offset:1024 sc1
  buffer_load_dwordx4 v[220:223], v5, s[36:39], s73 offen offset:2048 sc1
  buffer_load_dwordx4 v[224:227], v5, s[36:39], s73 offen offset:3072 sc1
  s_lshl_b32 s73, s56, 12
  s_add_u32 s73, s73, s67
  s_add_u32 s73, s73, 131072
  buffer_load_dwordx4 v[228:231], v5, s[36:39], s73 offen offset:0 sc1
  buffer_load_dwordx4 v[232:235], v5, s[36:39], s73 offen offset:1024 sc1
  buffer_load_dwordx4 v[236:239], v5, s[36:39], s73 offen offset:2048 sc1
  buffer_load_dwordx4 v[240:243], v5, s[36:39], s73 offen offset:3072 sc1
  s_waitcnt vmcnt(0)
  s_branch L_chk_110
L_ok_111:
  ds_write2_b32 v121, v212, v214 offset0:0 offset1:2
  v_add_u32 v121, 1280, v121
  ds_write2_b32 v121, v228, v230 offset0:0 offset1:2
  s_mov_b64 exec, -1
  s_waitcnt lgkmcnt(0)
  s_barrier
  ds_read_b128 v[212:215], v120 offset:0
  ds_read_b128 v[216:219], v120 offset:320
  ds_read_b128 v[220:223], v120 offset:640
  ds_read_b128 v[224:227], v120 offset:960
  s_mov_b32 vcc_lo, 0x44444444
  s_mov_b32 vcc_hi, 0x44444444
  s_waitcnt lgkmcnt(2)
  v_pk_add_f32 v[212:213], v[212:213], v[216:217]
  v_pk_add_f32 v[214:215], v[214:215], v[218:219]
  v_pk_add_f32 v[140:141], v[140:141], v[212:213]
  v_pk_add_f32 v[142:143], v[142:143], v[214:215]
  s_waitcnt lgkmcnt(0)
  v_pk_add_f32 v[220:221], v[220:221], v[224:225]
  v_pk_add_f32 v[222:223], v[222:223], v[226:227]
  v_pk_add_f32 v[140:141], v[140:141], v[220:221]
  v_pk_add_f32 v[142:143], v[142:143], v[222:223]
  v_cvt_pk_bf16_f32 v2, v140, v141
  v_cvt_pk_bf16_f32 v3, v142, v143
  s_nop 0
  v_cndmask_b32_dpp v22, v2, v123, vcc row_newbcast:9 row_mask:0xf bank_mask:0xf
  v_cndmask_b32_dpp v23, v3, v123, vcc row_newbcast:9 row_mask:0xf bank_mask:0xf
  v_cndmask_b32_dpp v140, v2, v123, vcc row_newbcast:1 row_mask:0xf bank_mask:0xf
  v_cndmask_b32_dpp v141, v3, v123, vcc row_newbcast:1 row_mask:0xf bank_mask:0xf
  v_cndmask_b32_dpp v142, v2, v123, vcc row_newbcast:3 row_mask:0xf bank_mask:0xf
  v_cndmask_b32_dpp v143, v3, v123, vcc row_newbcast:3 row_mask:0xf bank_mask:0xf
  v_cndmask_b32_dpp v212, v2, v123, vcc row_newbcast:5 row_mask:0xf bank_mask:0xf
  v_cndmask_b32_dpp v213, v3, v123, vcc row_newbcast:5 row_mask:0xf bank_mask:0xf
  v_cndmask_b32_dpp v214, v2, v123, vcc row_newbcast:7 row_mask:0xf bank_mask:0xf
  v_cndmask_b32_dpp v215, v3, v123, vcc row_newbcast:7 row_mask:0xf bank_mask:0xf
  s_waitcnt lgkmcnt(0)
  s_cmp_eq_u32 s56, 0
  s_cbranch_scc1 L_q0_112
  v_mfma_f32_16x16x16_bf16 v[216:219], v[22:23], v[144:145], 0
  v_mfma_f32_16x16x16_bf16 v[220:223], v[22:23], v[146:147], 0
  v_mfma_f32_16x16x16_bf16 v[144:147], v[22:23], v[148:149], 0
  v_mfma_f32_16x16x16_bf16 v[224:227], v[22:23], v[150:151], 0
  s_lshl_b32 s58, s56, 8
  s_add_u32 s73, s68, 0xc1f00
  s_add_u32 s73, s73, s58
  s_nop 1
  v_mfma_f32_16x16x32_bf16 v[216:219], v[140:143], v[152:155], v[216:219]
  v_mfma_f32_16x16x32_bf16 v[220:223], v[140:143], v[156:159], v[220:223]
  v_mfma_f32_16x16x32_bf16 v[144:147], v[140:143], v[160:163], v[144:147]
  v_mfma_f32_16x16x32_bf16 v[224:227], v[140:143], v[192:195], v[224:227]
  v_mfma_f32_16x16x32_bf16 v[216:219], v[212:215], v[196:199], v[216:219]
  v_mfma_f32_16x16x32_bf16 v[220:223], v[212:215], v[200:203], v[220:223]
  v_mfma_f32_16x16x32_bf16 v[144:147], v[212:215], v[204:207], v[144:147]
  v_mfma_f32_16x16x32_bf16 v[224:227], v[212:215], v[208:211], v[224:227]
  s_nop 5
  v_mov_b32_dpp v216, v220 quad_perm:[0,1,2,3] row_mask:0x2 bank_mask:0xf
  s_nop 1
  v_mov_b32_dpp v216, v144 quad_perm:[0,1,2,3] row_mask:0x4 bank_mask:0xf
  s_nop 1
  v_mov_b32_dpp v216, v224 quad_perm:[0,1,2,3] row_mask:0x8 bank_mask:0xf
  s_cmp_eq_u32 s75, 0
  s_cbranch_scc1 L_slow_114
  buffer_store_dword v216, v122, s[36:39], s73 offen
  s_branch L_pub_115
L_slow_114:
  buffer_store_dword v216, v122, s[36:39], s73 offen sc1
L_pub_115:
  s_branch L_qe_113
L_q0_112:
  v_mfma_f32_16x16x16_bf16 v[216:219], v[22:23], v[22:23], 0
  v_mfma_f32_16x16x32_bf16 v[220:223], v[140:143], v[140:143], 0
  v_mfma_f32_16x16x32_bf16 v[220:223], v[212:215], v[212:215], v[220:223]
  s_add_u32 s73, s68, 794624
  s_mov_b64 exec, 1
  s_nop 5
  v_add_f32 v216, v216, v220
  v_add_f32 v217, v218, v222
  s_cmp_eq_u32 s75, 0
  s_cbranch_scc1 L_slow_116
  buffer_store_dwordx2 v[216:217], v122, s[36:39], s73 offen offset:768
  s_branch L_pub_117
L_slow_116:
  buffer_store_dwordx2 v[216:217], v122, s[36:39], s73 offen offset:768 sc1
L_pub_117:
  s_mov_b64 exec, -1
L_qe_113:
  v_mov_b32 v120, 0
  v_mov_b32 v121, 0
  v_mov_b32 v122, 0
  v_mov_b32 v123, 0
  v_mov_b32 v140, 0
  v_mov_b32 v141, 0
  v_mov_b32 v142, 0
  v_mov_b32 v143, 0
  v_mov_b32 v144, 0
  v_mov_b32 v145, 0
  v_mov_b32 v146, 0
  v_mov_b32 v147, 0
  v_and_b32 v22, 0x30, v5
  v_bfe_u32 v23, v5, 8, 1
  v_lshl_add_u32 v22, v23, 6, v22
  v_add_u32 v22, 163280, v22
  v_mov_b32 v23, 163664
  v_and_b32 v148, 16, v5
  v_mov_b32 v149, 0xffff
  v_lshlrev_b32 v148, v148, v149
  v_bfe_u32 v149, v5, 5, 2
  v_cmp_eq_u32 vcc, 0, v149
  s_nop 1
  v_cndmask_b32 v152, 0, v148, vcc
  v_cmp_eq_u32 vcc, 1, v149
  s_nop 1
  v_cndmask_b32 v153, 0, v148, vcc
  v_cmp_eq_u32 vcc, 2, v149
  s_nop 1
  v_cndmask_b32 v154, 0, v148, vcc
  v_cmp_eq_u32 vcc, 3, v149
  s_nop 1
  v_cndmask_b32 v155, 0, v148, vcc
  v_bfe_u32 v148, v5, 7, 2
  v_lshlrev_b32 v148, 4, v148
  v_lshrrev_b32 v149, 9, v5
  v_lshl_add_u32 v148, v149, 3, v148
  v_bfe_u32 v149, v5, 4, 3
  v_add_lshl_u32 v148, v148, v149, 2
  s_mul_i32 s58, s56, 768
  s_add_u32 s58, s58, 159744
  v_add_u32 v148, s58, v148
  v_lshrrev_b32 v150, 8, v5
  v_bfe_u32 v149, v5, 4, 2
  v_lshl_add_u32 v150, v150, 2, v149
  v_bfe_u32 v149, v5, 7, 1
  v_lshl_add_u32 v150, v150, 1, v149
  v_lshlrev_b32 v150, 7, v150
  v_bfe_u32 v149, v5, 6, 1
  v_lshl_add_u32 v150, v149, 3, v150
  v_add_u32 v149, s71, v5
  s_lshl_b32 s58, s56, 3
  s_add_u32 s58, s58, 162848
  v_mov_b32 v151, s58
  v_lshrrev_b32 v157, 8, v5
  v_and_b32 v156, 0xf0, v5
  v_lshl_add_u32 v156, v157, 10, v156
  v_bfe_u32 v159, v5, 1, 7
  v_lshl_add_u32 v159, v157, 1, v159
  s_lshl_b32 s58, s56, 7
  s_add_u32 s58, s58, 163280
  v_add_u32 v159, s58, v159
  v_lshlrev_b32 v157, 6, v5
  v_mov_b32 v158, 163664
  v_mov_b32 v160, 0
  v_mov_b32 v161, 0
  s_sleep 2
  s_cmp_lt_u32 s56, 3
  s_cbranch_scc0 L_w_118
  s_mov_b32 s72, 0
L_poll_119:
  s_add_u32 s74, s69, 794624
  s_mov_b32 exec_lo, 0xff
  s_mov_b32 exec_hi, 0x0
  buffer_load_dwordx2 v[160:161], v157, s[36:39], s74 offen offset:768 sc1
  s_mov_b64 exec, -1
  s_lshl_b32 s73, s56, 8
  s_add_u32 s73, s73, s74
  s_add_u32 s74, s73, 4096
  buffer_load_dwordx4 v[192:195], v156, s[36:39], s73 offen sc1
  buffer_load_dwordx4 v[196:199], v156, s[36:39], s74 offen sc1
  s_add_u32 s72, s72, 1
  s_cmp_lt_u32 s72, 65536
  s_cselect_b64 s[60:61], -1, 0
  s_waitcnt vmcnt(0)
  v_pk_add_f32 v[192:193], v[192:193], v[196:197]
  v_pk_add_f32 v[194:195], v[194:195], v[198:199]
  v_add_f32_dpp v161, v161, v161 quad_perm:[1,0,3,2] row_mask:0xf bank_mask:0xf
  v_add_f32_dpp v160, v160, v160 quad_perm:[1,0,3,2] row_mask:0xf bank_mask:0xf
  v_permlane16_swap_b32 v192, v193
  v_permlane16_swap_b32 v194, v195
  v_add_f32 v192, v192, v193
  v_add_f32 v194, v194, v195
  v_add_f32_dpp v161, v161, v161 quad_perm:[2,3,0,1] row_mask:0xf bank_mask:0xf
  v_add_f32_dpp v160, v160, v160 quad_perm:[2,3,0,1] row_mask:0xf bank_mask:0xf
  v_permlane32_swap_b32 v192, v194
  v_add_f32_dpp v161, v161, v161 row_half_mirror row_mask:0xf bank_mask:0xf
  v_add_f32_dpp v160, v160, v160 row_half_mirror row_mask:0xf bank_mask:0xf
  v_add_f32 v192, v192, v194
  v_readfirstlane_b32 s58, v161
  s_nop 1
  v_fmac_f32 v192, s58, v20
  v_cmp_u_f32 vcc, v192, v160
  s_and_b64 vcc, vcc, s[60:61]
  s_cbranch_vccnz L_poll_119
  v_cvt_pk_bf16_f32 v192, v192, v192
  ds_write_b16 v159, v192
  s_mov_b64 exec, 1
  ds_write_b64 v158, v[160:161]
  s_mov_b64 exec, -1
L_w_118:
  s_waitcnt lgkmcnt(0)
  s_barrier
  s_mov_b32 exec_lo, 0xf0f0f0f
  s_mov_b32 exec_hi, 0xf0f0f0f0
  ds_read_b128 v[120:123], v22 offset:0
  ds_read_b128 v[140:143], v22 offset:128
  ds_read_b128 v[144:147], v22 offset:256
  s_mov_b64 exec, -1
  ds_read_b64 v[20:21], v23
  s_waitcnt lgkmcnt(0)
  v_mfma_f32_16x16x32_bf16 v[156:159], v[120:123], v[48:51], 0
  v_mfma_f32_16x16x32_bf16 v[160:163], v[120:123], v[12:15], 0
  v_mfma_f32_16x16x32_bf16 v[156:159], v[140:143], v[56:59], v[156:159]
  v_mul_f32 v21, 0x3acccccd, v21
  v_mul_f32 v20, 0x3acccccd, v20
  v_mfma_f32_16x16x32_bf16 v[160:163], v[140:143], v[16:19], v[160:163]
  v_fma_f32 v20, -v21, v21, v20
  v_max_f32 v20, 0, v20
  v_mfma_f32_16x16x32_bf16 v[156:159], v[144:147], v[60:63], v[156:159]
  v_add_f32 v20, 0x3727c5ac, v20
  v_rsq_f32 v20, v20
  v_mfma_f32_16x16x32_bf16 v[160:163], v[144:147], v[72:75], v[160:163]
  v_mul_f32 v20, 0x3dd53b95, v20
  v_mfma_f32_16x16x32_bf16 v[192:195], v[120:123], v[80:83], 0
  v_mfma_f32_16x16x32_bf16 v[196:199], v[120:123], v[128:131], 0
  v_mfma_f32_16x16x32_bf16 v[192:195], v[140:143], v[24:27], v[192:195]
  s_nop 0
  v_mov_b32_dpp v22, v156 quad_perm:[0,0,0,0] row_mask:0xf bank_mask:0xf
  s_nop 1
  v_mov_b32_dpp v120, v160 quad_perm:[0,0,0,0] row_mask:0xf bank_mask:0xf
  v_mfma_f32_16x16x32_bf16 v[196:199], v[140:143], v[132:135], v[196:199]
  v_add_f32_dpp v22, v157, v22 quad_perm:[1,1,1,1] row_mask:0xf bank_mask:0xf
  v_add_f32_dpp v120, v161, v120 quad_perm:[1,1,1,1] row_mask:0xf bank_mask:0xf
  v_mfma_f32_16x16x32_bf16 v[192:195], v[144:147], v[124:127], v[192:195]
  v_add_f32_dpp v22, v158, v22 quad_perm:[2,2,2,2] row_mask:0xf bank_mask:0xf
  v_add_f32_dpp v120, v162, v120 quad_perm:[2,2,2,2] row_mask:0xf bank_mask:0xf
  v_mfma_f32_16x16x32_bf16 v[196:199], v[144:147], v[136:139], v[196:199]
  v_add_f32_dpp v22, v159, v22 quad_perm:[3,3,3,3] row_mask:0xf bank_mask:0xf
  s_nop 1
  v_add_f32_dpp v22, v163, v120 quad_perm:[3,3,3,3] row_mask:0xc bank_mask:0xf
  s_nop 0
  v_mov_b32_dpp v23, v192 quad_perm:[0,0,0,0] row_mask:0xf bank_mask:0xf
  s_nop 1
  v_mov_b32_dpp v120, v196 quad_perm:[0,0,0,0] row_mask:0xf bank_mask:0xf
  v_add_f32_dpp v23, v193, v23 quad_perm:[1,1,1,1] row_mask:0xf bank_mask:0xf
  s_nop 0
  v_add_f32_dpp v120, v197, v120 quad_perm:[1,1,1,1] row_mask:0xf bank_mask:0xf
  v_add_f32_dpp v23, v194, v23 quad_perm:[2,2,2,2] row_mask:0xf bank_mask:0xf
  s_nop 0
  v_add_f32_dpp v120, v198, v120 quad_perm:[2,2,2,2] row_mask:0xf bank_mask:0xf
  v_add_f32_dpp v23, v195, v23 quad_perm:[3,3,3,3] row_mask:0xf bank_mask:0xf
  s_nop 1
  v_add_f32_dpp v23, v199, v120 quad_perm:[3,3,3,3] row_mask:0xc bank_mask:0xf
  v_max_f32 v120, v22, v23
  s_nop 1
  v_max_f32_dpp v120, v120, v120 row_ror:4 row_mask:0xf bank_mask:0xf
  s_nop 1
  v_max_f32_dpp v120, v120, v120 row_ror:8 row_mask:0xf bank_mask:0xf
  s_nop 1
  v_max_f32_dpp v120, v120, v120 row_bcast:15 row_mask:0xa bank_mask:0xf
  s_nop 1
  v_max_f32_dpp v120, v120, v120 row_bcast:31 row_mask:0xc bank_mask:0xf
  s_nop 0
  v_readlane_b32 s58, v120, 63
  s_nop 1
  v_mul_f32_e64 v120, -s58, v20
  v_fma_f32 v22, v22, v20, v120
  v_fma_f32 v23, v23, v20, v120
  v_exp_f32 v22, v22
  v_exp_f32 v23, v23
  s_nop 0
  v_add_f32 v121, v22, v23
  v_cvt_pk_bf16_f32 v22, v22, v22
  v_cvt_pk_bf16_f32 v23, v23, v23
  v_and_b32 v140, v22, v152
  v_and_b32 v141, v22, v153
  v_and_b32_dpp v142, v22, v154 row_shr:4 row_mask:0xf bank_mask:0xf bound_ctrl:0
  v_and_b32_dpp v143, v22, v155 row_shr:4 row_mask:0xf bank_mask:0xf bound_ctrl:0
  s_nop 1
  v_mfma_f32_16x16x32_bf16 v[144:147], v[52:55], v[140:143], 0
  v_and_b32 v158, v22, v154
  v_and_b32 v159, v22, v155
  v_mfma_f32_16x16x32_bf16 v[160:163], v[68:71], v[140:143], 0
  v_and_b32_dpp v156, v22, v152 row_shl:4 row_mask:0xf bank_mask:0xf bound_ctrl:0
  v_and_b32_dpp v157, v22, v153 row_shl:4 row_mask:0xf bank_mask:0xf bound_ctrl:0
  v_add_f32_dpp v121, v121, v121 row_ror:4 row_mask:0xf bank_mask:0xf
  v_mfma_f32_16x16x32_bf16 v[192:195], v[76:79], v[140:143], 0
  s_nop 0
  v_add_f32_dpp v121, v121, v121 row_ror:8 row_mask:0xf bank_mask:0xf
  v_mfma_f32_16x16x32_bf16 v[144:147], v[84:87], v[156:159], v[144:147]
  v_and_b32 v140, v23, v152
  v_and_b32 v141, v23, v153
  v_mfma_f32_16x16x32_bf16 v[160:163], v[88:91], v[156:159], v[160:163]
  v_and_b32_dpp v142, v23, v154 row_shr:4 row_mask:0xf bank_mask:0xf bound_ctrl:0
  v_and_b32_dpp v143, v23, v155 row_shr:4 row_mask:0xf bank_mask:0xf bound_ctrl:0
  v_add_f32_dpp v121, v121, v121 row_bcast:15 row_mask:0xa bank_mask:0xf
  v_mfma_f32_16x16x32_bf16 v[192:195], v[92:95], v[156:159], v[192:195]
  s_nop 0
  v_add_f32_dpp v121, v121, v121 row_bcast:31 row_mask:0xc bank_mask:0xf
  v_mfma_f32_16x16x32_bf16 v[144:147], v[96:99], v[140:143], v[144:147]
  v_and_b32 v158, v23, v154
  v_and_b32 v159, v23, v155
  v_mfma_f32_16x16x32_bf16 v[160:163], v[100:103], v[140:143], v[160:163]
  v_and_b32_dpp v156, v23, v152 row_shl:4 row_mask:0xf bank_mask:0xf bound_ctrl:0
  v_and_b32_dpp v157, v23, v153 row_shl:4 row_mask:0xf bank_mask:0xf bound_ctrl:0
  v_mfma_f32_16x16x32_bf16 v[192:195], v[104:107], v[140:143], v[192:195]
  s_mov_b32 exec_lo, 0x0
  s_mov_b32 exec_hi, 0x80000000
  ds_write_b64 v151, v[120:121]
  s_mov_b64 exec, -1
  v_mfma_f32_16x16x32_bf16 v[144:147], v[108:111], v[156:159], v[144:147]
  v_mfma_f32_16x16x32_bf16 v[160:163], v[112:115], v[156:159], v[160:163]
  v_mfma_f32_16x16x32_bf16 v[192:195], v[116:119], v[156:159], v[192:195]
  v_mov_b32 v20, 162848
  v_add_u32 v21, 159744, v5
  s_add_u32 s73, s64, 393216
  s_nop 2
  v_permlane32_swap_b32 v144, v145
  v_permlane32_swap_b32 v146, v147
  v_permlane32_swap_b32 v160, v161
  v_permlane32_swap_b32 v162, v163
  v_permlane32_swap_b32 v192, v193
  v_permlane32_swap_b32 v194, v195
  v_add_f32_dpp v120, v145, v144 row_shl:8 row_mask:0xf bank_mask:0x3
  v_add_f32_dpp v121, v161, v160 row_shl:8 row_mask:0xf bank_mask:0x3
  v_add_f32_dpp v122, v193, v192 row_shl:8 row_mask:0xf bank_mask:0x3
  v_add_f32_dpp v120, v146, v147 row_shr:8 row_mask:0xf bank_mask:0xc
  v_add_f32_dpp v121, v162, v163 row_shr:8 row_mask:0xf bank_mask:0xc
  v_add_f32_dpp v122, v194, v195 row_shr:8 row_mask:0xf bank_mask:0xc
  ds_write_b32 v148, v120 offset:0
  ds_write_b32 v148, v121 offset:256
  ds_write_b32 v148, v122 offset:512
  s_waitcnt lgkmcnt(0)
  s_barrier
  s_cmp_eq_u32 s56, 3
  s_cbranch_scc0 L_w_121
  ds_read_b128 v[120:123], v20
  ds_read_b128 v[140:143], v20 offset:16
  ds_read_b128 v[144:147], v21 offset:0
  ds_read_b128 v[152:155], v21 offset:768
  ds_read_b128 v[156:159], v21 offset:1536
  ds_read_b128 v[160:163], v21 offset:2304
  s_mov_b32 vcc_lo, 0
  s_mov_b32 vcc_hi, 0xffff0000
  s_mov_b32 exec_hi, 0x1ffff
  s_waitcnt lgkmcnt(4)
  v_min3_f32 v20, v120, v122, v140
  v_min_f32 v20, v20, v142
  v_sub_f32 v120, v20, v120
  v_sub_f32 v122, v20, v122
  v_sub_f32 v140, v20, v140
  v_sub_f32 v142, v20, v142
  v_exp_f32 v120, v120
  v_exp_f32 v122, v122
  v_exp_f32 v140, v140
  v_exp_f32 v142, v142
  s_waitcnt lgkmcnt(0)
  v_pk_mul_f32 v[144:145], v[144:145], v[120:121] op_sel_hi:[1,0]
  v_pk_mul_f32 v[146:147], v[146:147], v[120:121] op_sel_hi:[1,0]
  v_mul_f32 v121, v120, v121
  v_pk_mul_f32 v[156:157], v[156:157], v[140:141] op_sel_hi:[1,0]
  v_pk_mul_f32 v[158:159], v[158:159], v[140:141] op_sel_hi:[1,0]
  v_mul_f32 v141, v140, v141
  v_pk_fma_f32 v[144:145], v[152:153], v[122:123], v[144:145] op_sel_hi:[1,0,1]
  v_pk_fma_f32 v[146:147], v[154:155], v[122:123], v[146:147] op_sel_hi:[1,0,1]
  v_fmac_f32 v121, v122, v123
  v_pk_fma_f32 v[156:157], v[160:161], v[142:143], v[156:157] op_sel_hi:[1,0,1]
  v_pk_fma_f32 v[158:159], v[162:163], v[142:143], v[158:159] op_sel_hi:[1,0,1]
  v_fmac_f32 v141, v142, v143
  v_pk_add_f32 v[144:145], v[144:145], v[156:157]
  v_pk_add_f32 v[146:147], v[146:147], v[158:159]
  v_add_f32 v21, v121, v141
  v_cvt_pk_bf16_f32 v152, v144, v145
  v_cvt_pk_bf16_f32 v153, v146, v147
  v_cndmask_b32 v152, v152, v20, vcc
  v_cndmask_b32 v153, v153, v21, vcc
  s_cmp_eq_u32 s75, 0
  s_cbranch_scc1 L_slow_122
  buffer_store_dwordx2 v[152:153], v150, s[36:39], s73 offen
  s_branch L_pub_123
L_slow_122:
  buffer_store_dwordx2 v[152:153], v150, s[36:39], s73 offen sc1
L_pub_123:
  s_mov_b64 exec, -1
L_w_121:
  v_and_b32 v20, 0x70, v5
  s_sleep 3
  v_lshrrev_b32 v21, 8, v5
  v_bfe_u32 v22, v5, 7, 1
  v_mul_u32_u24 v22, 192, v22
  v_lshl_add_u32 v21, v21, 4, v22
  v_lshrrev_b32 v22, 6, v5
  v_mul_u32_u24 v22, 160, v22
  v_bfe_u32 v23, v5, 4, 2
  v_lshl_add_u32 v22, v23, 3, v22
  s_lshl_b32 s58, s56, 5
  s_add_u32 s58, s58, 92160
  v_add_u32 v22, s58, v22
  s_cmp_lt_u32 s56, 3
  s_cbranch_scc0 L_w_124
  ds_read_b64_tr_b16 v[120:121], v22 offset:0
  ds_read_b64_tr_b16 v[122:123], v22 offset:2560
  ds_read_b64_tr_b16 v[140:141], v22 offset:5120
  ds_read_b64_tr_b16 v[142:143], v22 offset:7680
  ds_read_b64_tr_b16 v[144:145], v22 offset:10240
  ds_read_b64_tr_b16 v[146:147], v22 offset:12800
  ds_read_b64_tr_b16 v[148:149], v22 offset:15360
  ds_read_b64_tr_b16 v[150:151], v22 offset:17920
  ds_read_b64_tr_b16 v[152:153], v22 offset:20480
  ds_read_b64_tr_b16 v[154:155], v22 offset:23040
  ds_read_b64_tr_b16 v[156:157], v22 offset:25600
  ds_read_b64_tr_b16 v[158:159], v22 offset:28160
  ds_read_b64_tr_b16 v[160:161], v22 offset:96
  ds_read_b64_tr_b16 v[162:163], v22 offset:2656
  ds_read_b64_tr_b16 v[192:193], v22 offset:5216
  ds_read_b64_tr_b16 v[194:195], v22 offset:7776
  ds_read_b64_tr_b16 v[196:197], v22 offset:10336
  ds_read_b64_tr_b16 v[198:199], v22 offset:12896
  ds_read_b64_tr_b16 v[200:201], v22 offset:15456
  ds_read_b64_tr_b16 v[202:203], v22 offset:18016
  ds_read_b64_tr_b16 v[204:205], v22 offset:20576
  ds_read_b64_tr_b16 v[206:207], v22 offset:23136
  ds_read_b64_tr_b16 v[208:209], v22 offset:25696
  ds_read_b64_tr_b16 v[210:211], v22 offset:28256
L_w_124:
  s_lshl_b32 s58, s56, 6
  s_add_u32 s74, s66, s58
  s_add_u32 s74, s74, 393216
  s_cmp_lt_u32 s56, 3
  s_cbranch_scc0 L_w_125
  s_mov_b32 s72, 0
L_poll_126:
  s_add_u32 s73, s65, 393216
  buffer_load_dwordx2 v[212:213], v20, s[36:39], s73 offen offset:3072 sc1
  buffer_load_dwordx4 v[216:219], v5, s[36:39], s73 offen offset:0 sc1
  buffer_load_dwordx4 v[220:223], v5, s[36:39], s73 offen offset:1024 sc1
  buffer_load_dwordx4 v[224:227], v5, s[36:39], s73 offen offset:2048 sc1
  s_add_u32 s72, s72, 1
  s_cmp_lt_u32 s72, 65536
  s_cselect_b64 s[60:61], -1, 0
  s_waitcnt vmcnt(0)
  v_max3_u32 v214, v212, v213, v216
  v_max3_u32 v215, v217, v218, v219
  v_max3_u32 v214, v214, v220, v221
  v_max3_u32 v215, v215, v222, v223
  v_max3_u32 v214, v214, v224, v225
  v_max3_u32 v215, v215, v226, v227
  v_max_u32 v214, v214, v215
  v_cmp_eq_u32 vcc, -1, v214
  s_and_b64 vcc, vcc, s[60:61]
  s_cbranch_vccnz L_poll_126
  s_waitcnt lgkmcnt(0)
  v_mfma_f32_16x16x32_bf16 v[228:231], v[120:123], v[216:219], 0
  v_min_f32_dpp v214, v212, v212 quad_perm:[1,0,3,2] row_mask:0xf bank_mask:0xf
  v_mfma_f32_16x16x32_bf16 v[120:123], v[140:143], v[216:219], 0
  s_nop 0
  v_min_f32_dpp v214, v214, v214 quad_perm:[2,3,0,1] row_mask:0xf bank_mask:0xf
  v_mfma_f32_16x16x32_bf16 v[228:231], v[144:147], v[220:223], v[228:231]
  s_nop 0
  v_min_f32_dpp v214, v214, v214 row_half_mirror row_mask:0xf bank_mask:0xf
  v_mfma_f32_16x16x32_bf16 v[120:123], v[148:151], v[220:223], v[120:123]
  v_sub_f32 v212, v214, v212
  v_exp_f32 v212, v212
  v_mfma_f32_16x16x32_bf16 v[228:231], v[152:155], v[224:227], v[228:231]
  v_mul_f32 v213, v212, v213
  v_mfma_f32_16x16x32_bf16 v[120:123], v[156:159], v[224:227], v[120:123]
  s_nop 0
  v_add_f32_dpp v213, v213, v213 quad_perm:[1,0,3,2] row_mask:0xf bank_mask:0xf
  v_mfma_f32_16x16x32_bf16 v[140:143], v[160:163], v[216:219], 0
  s_nop 0
  v_add_f32_dpp v213, v213, v213 quad_perm:[2,3,0,1] row_mask:0xf bank_mask:0xf
  v_mfma_f32_16x16x32_bf16 v[144:147], v[192:195], v[216:219], 0
  s_nop 0
  v_add_f32_dpp v213, v213, v213 row_half_mirror row_mask:0xf bank_mask:0xf
  v_mfma_f32_16x16x32_bf16 v[140:143], v[196:199], v[220:223], v[140:143]
  v_rcp_f32 v213, v213
  s_nop 0
  v_mul_f32 v212, v212, v213
  v_mfma_f32_16x16x32_bf16 v[144:147], v[200:203], v[220:223], v[144:147]
  v_add_f32_dpp v148, v120, v228 row_shl:8 row_mask:0xf bank_mask:0x3
  v_add_f32_dpp v149, v121, v229 row_shl:8 row_mask:0xf bank_mask:0x3
  v_mfma_f32_16x16x32_bf16 v[140:143], v[204:207], v[224:227], v[140:143]
  v_add_f32_dpp v150, v122, v230 row_shl:8 row_mask:0xf bank_mask:0x3
  v_add_f32_dpp v151, v123, v231 row_shl:8 row_mask:0xf bank_mask:0x3
  v_mfma_f32_16x16x32_bf16 v[144:147], v[208:211], v[224:227], v[144:147]
  s_cmp_lt_u32 s56, 2
  s_mov_b32 s58, 0x00010001
  s_cselect_b32 s58, 0x01010101, s58
  s_nop 4
  v_add_f32_dpp v148, v140, v144 row_shr:8 row_mask:0xf bank_mask:0xc
  v_add_f32_dpp v149, v141, v145 row_shr:8 row_mask:0xf bank_mask:0xc
  v_add_f32_dpp v150, v142, v146 row_shr:8 row_mask:0xf bank_mask:0xc
  v_add_f32_dpp v151, v143, v147 row_shr:8 row_mask:0xf bank_mask:0xc
  v_mul_f32 v148, v212, v148
  v_mul_f32 v149, v212, v149
  v_mul_f32 v150, v212, v150
  v_mul_f32 v151, v212, v151
  v_add_f32_dpp v148, v148, v148 quad_perm:[1,0,3,2] row_mask:0xf bank_mask:0xf
  v_add_f32_dpp v149, v149, v149 quad_perm:[1,0,3,2] row_mask:0xf bank_mask:0xf
  v_add_f32_dpp v150, v150, v150 quad_perm:[1,0,3,2] row_mask:0xf bank_mask:0xf
  v_add_f32_dpp v151, v151, v151 quad_perm:[1,0,3,2] row_mask:0xf bank_mask:0xf
  v_add_f32_dpp v148, v148, v148 quad_perm:[2,3,0,1] row_mask:0xf bank_mask:0xf
  v_add_f32_dpp v149, v149, v149 quad_perm:[2,3,0,1] row_mask:0xf bank_mask:0xf
  v_add_f32_dpp v150, v150, v150 quad_perm:[2,3,0,1] row_mask:0xf bank_mask:0xf
  v_add_f32_dpp v151, v151, v151 quad_perm:[2,3,0,1] row_mask:0xf bank_mask:0xf
  v_add_f32_dpp v148, v148, v148 row_half_mirror row_mask:0xf bank_mask:0xf
  v_add_f32_dpp v149, v149, v149 row_half_mirror row_mask:0xf bank_mask:0xf
  v_add_f32_dpp v150, v150, v150 row_half_mirror row_mask:0xf bank_mask:0xf
  v_add_f32_dpp v151, v151, v151 row_half_mirror row_mask:0xf bank_mask:0xf
  s_mov_b32 exec_lo, s58
  s_mov_b32 exec_hi, s58
  buffer_store_dwordx4 v[148:151], v21, s[36:39], s74 offen sc1
  s_mov_b64 exec, -1
L_w_125:
  s_barrier
  v_lshrrev_b32 v21, 2, v5
  s_lshl_b32 s73, s56, 8
  s_add_u32 s73, s73, s70
  s_add_u32 s73, s73, 0
  buffer_load_dword v20, v21, s[36:39], s73 offen sc1
  v_lshlrev_b32 v22, 3, v5
  s_add_u32 s58, s68, 1581056
  s_add_u32 s59, s77, 655360
  s_cmp_eq_u32 s56, 1
  s_cselect_b32 s58, s59, s58
  s_mov_b32 exec_lo, 0x7f
  s_mov_b32 exec_hi, 0x0
  buffer_load_dword v23, v22, s[36:39], s58 offen sc1
  s_mov_b64 exec, -1
  v_bfe_u32 v120, v5, 5, 3
  v_add_u32 v121, -1, v120
  v_and_b32 v121, 3, v121
  v_add_u32 v121, 1, v121
  v_min_u32 v120, v121, v120
  v_lshrrev_b32 v121, 8, v5
  v_lshl_add_u32 v120, v120, 2, v121
  v_mul_u32_u24 v120, 16, v120
  v_add_u32 v120, 159744, v120
  v_and_b32 v121, 0x1f0, v5
  v_lshrrev_b32 v122, 9, v5
  v_lshl_add_u32 v121, v122, 2, v121
  s_mul_i32 s58, s56, 320
  s_add_u32 s58, s58, 159744
  v_add_u32 v121, s58, v121
  v_lshrrev_b32 v122, 9, v5
  v_mul_u32_u24 v122, 3072, v122
  v_bfe_u32 v123, v5, 6, 3
  v_lshl_add_u32 v122, v123, 7, v122
  v_bfe_u32 v123, v5, 4, 2
  v_lshl_add_u32 v122, v123, 3, v122
  s_max_u32 s58, s56, 1
  s_lshl_b32 s58, s58, 10
  s_add_u32 s58, s58, 0xfffffc00
  v_add_u32 v122, s58, v122
  v_bfe_u32 v123, v5, 7, 2
  v_lshl_add_u32 v140, v123, 5, v122
  v_xor_b32 v141, 32, v140
  v_xor_b32 v142, 64, v140
  v_xor_b32 v143, 96, v140
  ds_read_b64_tr_b16 v[144:145], v140 offset:24576
  ds_read_b64_tr_b16 v[146:147], v141 offset:24576
  ds_read_b64_tr_b16 v[148:149], v142 offset:24576
  ds_read_b64_tr_b16 v[150:151], v143 offset:24576
  ds_read_b64_tr_b16 v[152:153], v140 offset:0
  ds_read_b64_tr_b16 v[156:157], v141 offset:0
  ds_read_b64_tr_b16 v[160:161], v142 offset:0
  ds_read_b64_tr_b16 v[192:193], v143 offset:0
  ds_read_b64_tr_b16 v[154:155], v140 offset:6144
  ds_read_b64_tr_b16 v[158:159], v141 offset:6144
  ds_read_b64_tr_b16 v[162:163], v142 offset:6144
  ds_read_b64_tr_b16 v[194:195], v143 offset:6144
  ds_read_b64_tr_b16 v[196:197], v140 offset:12288
  ds_read_b64_tr_b16 v[200:201], v141 offset:12288
  ds_read_b64_tr_b16 v[204:205], v142 offset:12288
  ds_read_b64_tr_b16 v[208:209], v143 offset:12288
  ds_read_b64_tr_b16 v[198:199], v140 offset:18432
  ds_read_b64_tr_b16 v[202:203], v141 offset:18432
  ds_read_b64_tr_b16 v[206:207], v142 offset:18432
  ds_read_b64_tr_b16 v[210:211], v143 offset:18432
  v_lshrrev_b32 v122, 2, v5
  v_mov_b32 v123, 0x3f803f80
  v_lshlrev_b32 v140, 16, v2
  v_and_b32 v141, 0xffff0000, v2
  v_lshlrev_b32 v142, 16, v3
  v_and_b32 v143, 0xffff0000, v3
  v_mov_b32 v212, 0
  v_mov_b32 v213, 0
  v_mov_b32 v214, 0
  v_mov_b32 v215, 0
  v_mov_b32 v216, 0
  v_mov_b32 v217, 0
  v_mov_b32 v218, 0
  v_mov_b32 v219, 0
  v_mov_b32 v220, 0
  v_mov_b32 v221, 0
  v_mov_b32 v222, 0
  v_mov_b32 v223, 0
  v_and_b32 v224, 0x30, v5
  v_bfe_u32 v225, v5, 8, 1
  v_lshl_add_u32 v224, v225, 6, v224
  v_add_u32 v224, 163280, v224
  v_mov_b32 v225, 163664
  v_and_b32 v226, 16, v5
  v_mov_b32 v227, 0xffff
  v_lshlrev_b32 v226, v226, v227
  v_bfe_u32 v227, v5, 5, 2
  v_cmp_eq_u32 vcc, 0, v227
  s_nop 1
  v_cndmask_b32 v228, 0, v226, vcc
  v_cmp_eq_u32 vcc, 1, v227
  s_nop 1
  v_cndmask_b32 v229, 0, v226, vcc
  v_cmp_eq_u32 vcc, 2, v227
  s_nop 1
  v_cndmask_b32 v230, 0, v226, vcc
  v_cmp_eq_u32 vcc, 3, v227
  s_nop 1
  v_cndmask_b32 v231, 0, v226, vcc
  v_bfe_u32 v232, v5, 7, 2
  v_lshlrev_b32 v232, 4, v232
  v_lshrrev_b32 v233, 9, v5
  v_lshl_add_u32 v232, v233, 3, v232
  v_bfe_u32 v233, v5, 4, 3
  v_add_lshl_u32 v232, v232, v233, 2
  s_mul_i32 s58, s56, 768
  s_add_u32 s58, s58, 159744
  v_add_u32 v232, s58, v232
  v_lshrrev_b32 v234, 8, v5
  v_bfe_u32 v233, v5, 4, 2
  v_lshl_add_u32 v234, v234, 2, v233
  v_bfe_u32 v233, v5, 7, 1
  v_lshl_add_u32 v234, v234, 1, v233
  v_lshlrev_b32 v234, 7, v234
  v_bfe_u32 v233, v5, 6, 1
  v_lshl_add_u32 v234, v233, 3, v234
  v_add_u32 v233, s71, v5
  s_lshl_b32 s58, s56, 3
  s_add_u32 s58, s58, 162848
  v_mov_b32 v235, s58
  s_sleep 2
  s_mov_b32 exec_lo, 0xfffff
  s_mov_b32 exec_hi, 0xfffff
  s_lshl_b32 s73, s56, 12
  s_add_u32 s73, s73, s67
  s_add_u32 s73, s73, 393216
  buffer_load_dwordx4 v[236:239], v5, s[36:39], s73 offen offset:0 sc1
  buffer_load_dwordx4 v[240:243], v5, s[36:39], s73 offen offset:1024 sc1
  buffer_load_dwordx4 v[244:247], v5, s[36:39], s73 offen offset:2048 sc1
  buffer_load_dwordx4 v[248:251], v5, s[36:39], s73 offen offset:3072 sc1
  s_mov_b64 exec, -1
  s_mov_b32 s72, 0
  s_waitcnt vmcnt(0)
L_chk_128:
  s_mov_b32 exec_lo, 0xfffff
  s_mov_b32 exec_hi, 0xfffff
  v_pk_add_f32 v[236:237], v[236:237], v[240:241]
  v_pk_add_f32 v[238:239], v[238:239], v[242:243]
  v_pk_add_f32 v[244:245], v[244:245], v[248:249]
  v_pk_add_f32 v[246:247], v[246:247], v[250:251]
  v_pk_add_f32 v[236:237], v[236:237], v[244:245]
  v_pk_add_f32 v[238:239], v[238:239], v[246:247]
  s_nop 0
  v_permlane32_swap_b32 v236, v237
  v_permlane32_swap_b32 v238, v239
  v_add_f32 v236, v236, v237
  v_add_f32 v238, v238, v239
  v_cmp_u_f32 vcc, v236, v238
  s_cbranch_vccz L_ok_129
  s_add_u32 s72, s72, 1
  s_cmp_ge_u32 s72, 65536
  s_cbranch_scc1 L_ok_129
  s_sleep 1
  s_mov_b32 exec_lo, 0xfffff
  s_mov_b32 exec_hi, 0xfffff
  s_lshl_b32 s73, s56, 12
  s_add_u32 s73, s73, s67
  s_add_u32 s73, s73, 393216
  buffer_load_dwordx4 v[236:239], v5, s[36:39], s73 offen offset:0 sc1
  buffer_load_dwordx4 v[240:243], v5, s[36:39], s73 offen offset:1024 sc1
  buffer_load_dwordx4 v[244:247], v5, s[36:39], s73 offen offset:2048 sc1
  buffer_load_dwordx4 v[248:251], v5, s[36:39], s73 offen offset:3072 sc1
  s_waitcnt vmcnt(0)
  s_branch L_chk_128
L_ok_129:
  ds_write2_b32 v121, v236, v238 offset0:0 offset1:2
  s_mov_b64 exec, -1
  s_waitcnt lgkmcnt(0)
  s_barrier
  ds_read_b128 v[236:239], v120 offset:0
  ds_read_b128 v[240:243], v120 offset:320
  ds_read_b128 v[244:247], v120 offset:640
  ds_read_b128 v[248:251], v120 offset:960
  s_mov_b32 exec_lo, 0xaaaaaaaa
  s_mov_b32 exec_hi, 0xaaaaaaaa
  s_mov_b32 vcc_lo, 0x44444444
  s_mov_b32 vcc_hi, 0x44444444
  s_waitcnt lgkmcnt(2)
  v_pk_add_f32 v[236:237], v[236:237], v[240:241]
  v_pk_add_f32 v[238:239], v[238:239], v[242:243]
  v_pk_add_f32 v[140:141], v[140:141], v[236:237]
  v_pk_add_f32 v[142:143], v[142:143], v[238:239]
  s_waitcnt lgkmcnt(0)
  v_pk_add_f32 v[244:245], v[244:245], v[248:249]
  v_pk_add_f32 v[246:247], v[246:247], v[250:251]
  v_pk_add_f32 v[140:141], v[140:141], v[244:245]
  v_pk_add_f32 v[142:143], v[142:143], v[246:247]
  v_cvt_pk_bf16_f32 v2, v140, v141
  v_cvt_pk_bf16_f32 v3, v142, v143
  s_mov_b64 exec, -1
  v_cndmask_b32_dpp v22, v2, v123, vcc row_newbcast:9 row_mask:0xf bank_mask:0xf
  v_cndmask_b32_dpp v23, v3, v123, vcc row_newbcast:9 row_mask:0xf bank_mask:0xf
  v_cndmask_b32_dpp v140, v2, v123, vcc row_newbcast:1 row_mask:0xf bank_mask:0xf
  v_cndmask_b32_dpp v141, v3, v123, vcc row_newbcast:1 row_mask:0xf bank_mask:0xf
  v_cndmask_b32_dpp v142, v2, v123, vcc row_newbcast:3 row_mask:0xf bank_mask:0xf
  v_cndmask_b32_dpp v143, v3, v123, vcc row_newbcast:3 row_mask:0xf bank_mask:0xf
  v_cndmask_b32_dpp v236, v2, v123, vcc row_newbcast:5 row_mask:0xf bank_mask:0xf
  v_cndmask_b32_dpp v237, v3, v123, vcc row_newbcast:5 row_mask:0xf bank_mask:0xf
  v_cndmask_b32_dpp v238, v2, v123, vcc row_newbcast:7 row_mask:0xf bank_mask:0xf
  v_cndmask_b32_dpp v239, v3, v123, vcc row_newbcast:7 row_mask:0xf bank_mask:0xf
  s_waitcnt lgkmcnt(0)
  s_cmp_eq_u32 s56, 0
  s_cbranch_scc1 L_q0_130
  v_mfma_f32_16x16x16_bf16 v[240:243], v[22:23], v[144:145], 0
  v_mfma_f32_16x16x16_bf16 v[244:247], v[22:23], v[146:147], 0
  v_mfma_f32_16x16x16_bf16 v[144:147], v[22:23], v[148:149], 0
  v_mfma_f32_16x16x16_bf16 v[248:251], v[22:23], v[150:151], 0
  s_lshl_b32 s58, s56, 8
  s_add_u32 s73, s68, 0x181f00
  s_add_u32 s73, s73, s58
  s_nop 1
  v_mfma_f32_16x16x32_bf16 v[240:243], v[140:143], v[152:155], v[240:243]
  v_mfma_f32_16x16x32_bf16 v[244:247], v[140:143], v[156:159], v[244:247]
  v_mfma_f32_16x16x32_bf16 v[144:147], v[140:143], v[160:163], v[144:147]
  v_mfma_f32_16x16x32_bf16 v[248:251], v[140:143], v[192:195], v[248:251]
  v_mfma_f32_16x16x32_bf16 v[240:243], v[236:239], v[196:199], v[240:243]
  v_mfma_f32_16x16x32_bf16 v[244:247], v[236:239], v[200:203], v[244:247]
  v_mfma_f32_16x16x32_bf16 v[144:147], v[236:239], v[204:207], v[144:147]
  v_mfma_f32_16x16x32_bf16 v[248:251], v[236:239], v[208:211], v[248:251]
  s_nop 5
  v_mov_b32_dpp v240, v244 quad_perm:[0,1,2,3] row_mask:0x2 bank_mask:0xf
  s_nop 1
  v_mov_b32_dpp v240, v144 quad_perm:[0,1,2,3] row_mask:0x4 bank_mask:0xf
  s_nop 1
  v_mov_b32_dpp v240, v248 quad_perm:[0,1,2,3] row_mask:0x8 bank_mask:0xf
  s_cmp_eq_u32 s75, 0
  s_cbranch_scc1 L_slow_132
  buffer_store_dword v240, v122, s[36:39], s73 offen
  s_branch L_pub_133
L_slow_132:
  buffer_store_dword v240, v122, s[36:39], s73 offen sc1
L_pub_133:
  s_branch L_qe_131
L_q0_130:
  v_mfma_f32_16x16x16_bf16 v[240:243], v[22:23], v[22:23], 0
  v_mfma_f32_16x16x32_bf16 v[244:247], v[140:143], v[140:143], 0
  v_mfma_f32_16x16x32_bf16 v[244:247], v[236:239], v[236:239], v[244:247]
  s_add_u32 s73, s68, 1581056
  s_mov_b64 exec, 1
  s_nop 5
  v_add_f32 v240, v240, v244
  v_add_f32 v241, v242, v246
  s_cmp_eq_u32 s75, 0
  s_cbranch_scc1 L_slow_134
  buffer_store_dwordx2 v[240:241], v122, s[36:39], s73 offen offset:768
  s_branch L_pub_135
L_slow_134:
  buffer_store_dwordx2 v[240:241], v122, s[36:39], s73 offen offset:768 sc1
L_pub_135:
  s_mov_b64 exec, -1
L_qe_131:
  v_lshrrev_b32 v121, 8, v5
  v_and_b32 v120, 0xf0, v5
  v_lshl_add_u32 v120, v121, 10, v120
  v_bfe_u32 v123, v5, 1, 7
  v_lshl_add_u32 v123, v121, 1, v123
  s_lshl_b32 s58, s56, 7
  s_add_u32 s58, s58, 163280
  v_add_u32 v123, s58, v123
  v_lshlrev_b32 v121, 6, v5
  v_mov_b32 v122, 163664
  v_mov_b32 v22, 0
  v_mov_b32 v23, 0
  s_sleep 2
  s_cmp_lt_u32 s56, 3
  s_cbranch_scc0 L_w_136
  s_mov_b32 s72, 0
L_poll_137:
  s_add_u32 s74, s69, 1581056
  s_mov_b32 exec_lo, 0xff
  s_mov_b32 exec_hi, 0x0
  buffer_load_dwordx2 v[22:23], v121, s[36:39], s74 offen offset:768 sc1
  s_mov_b64 exec, -1
  s_lshl_b32 s73, s56, 8
  s_add_u32 s73, s73, s74
  s_add_u32 s74, s73, 4096
  buffer_load_dwordx4 v[140:143], v120, s[36:39], s73 offen sc1
  buffer_load_dwordx4 v[144:147], v120, s[36:39], s74 offen sc1
  s_add_u32 s72, s72, 1
  s_cmp_lt_u32 s72, 65536
  s_cselect_b64 s[60:61], -1, 0
  s_waitcnt vmcnt(0)
  v_pk_add_f32 v[140:141], v[140:141], v[144:145]
  v_pk_add_f32 v[142:143], v[142:143], v[146:147]
  v_add_f32_dpp v23, v23, v23 quad_perm:[1,0,3,2] row_mask:0xf bank_mask:0xf
  v_add_f32_dpp v22, v22, v22 quad_perm:[1,0,3,2] row_mask:0xf bank_mask:0xf
  v_permlane16_swap_b32 v140, v141
  v_permlane16_swap_b32 v142, v143
  v_add_f32 v140, v140, v141
  v_add_f32 v142, v142, v143
  v_add_f32_dpp v23, v23, v23 quad_perm:[2,3,0,1] row_mask:0xf bank_mask:0xf
  v_add_f32_dpp v22, v22, v22 quad_perm:[2,3,0,1] row_mask:0xf bank_mask:0xf
  v_permlane32_swap_b32 v140, v142
  v_add_f32_dpp v23, v23, v23 row_half_mirror row_mask:0xf bank_mask:0xf
  v_add_f32_dpp v22, v22, v22 row_half_mirror row_mask:0xf bank_mask:0xf
  v_add_f32 v140, v140, v142
  v_readfirstlane_b32 s58, v23
  s_nop 1
  v_fmac_f32 v140, s58, v20
  v_cmp_u_f32 vcc, v140, v22
  s_and_b64 vcc, vcc, s[60:61]
  s_cbranch_vccnz L_poll_137
  v_cvt_pk_bf16_f32 v140, v140, v140
  ds_write_b16 v123, v140
  s_mov_b64 exec, 1
  ds_write_b64 v122, v[22:23]
  s_mov_b64 exec, -1
L_w_136:
  s_waitcnt lgkmcnt(0)
  s_barrier
  s_mov_b32 exec_lo, 0xf0f0f0f
  s_mov_b32 exec_hi, 0xf0f0f0f0
  ds_read_b128 v[212:215], v224 offset:0
  ds_read_b128 v[216:219], v224 offset:128
  ds_read_b128 v[220:223], v224 offset:256
  s_mov_b64 exec, -1
  ds_read_b64 v[226:227], v225
  s_waitcnt lgkmcnt(0)
  v_mfma_f32_16x16x32_bf16 v[20:23], v[212:215], v[8:11], 0
  v_mfma_f32_16x16x32_bf16 v[8:11], v[212:215], v[172:175], 0
  v_mfma_f32_16x16x32_bf16 v[20:23], v[216:219], v[164:167], v[20:23]
  v_mul_f32 v227, 0x3acccccd, v227
  v_mul_f32 v226, 0x3acccccd, v226
  v_mfma_f32_16x16x32_bf16 v[8:11], v[216:219], v[176:179], v[8:11]
  v_fma_f32 v226, -v227, v227, v226
  v_max_f32 v226, 0, v226
  v_mfma_f32_16x16x32_bf16 v[20:23], v[220:223], v[168:171], v[20:23]
  v_add_f32 v226, 0x3727c5ac, v226
  v_rsq_f32 v226, v226
  v_mfma_f32_16x16x32_bf16 v[8:11], v[220:223], v[180:183], v[8:11]
  v_mul_f32 v226, 0x3dd53b95, v226
  s_mov_b32 s57, 0x3009000
  buffer_load_dwordx4 v[120:123], v1, s[8:11], s57 offen offset:384 nt
  buffer_load_dwordx4 v[140:143], v1, s[8:11], s57 offen offset:512 nt
  v_mfma_f32_16x16x32_bf16 v[144:147], v[212:215], v[184:187], 0
  v_mfma_f32_16x16x32_bf16 v[148:151], v[212:215], a[40:43], 0
  v_mfma_f32_16x16x32_bf16 v[144:147], v[216:219], v[188:191], v[144:147]
  v_mov_b32_dpp v152, v20 quad_perm:[0,0,0,0] row_mask:0xf bank_mask:0xf
  v_mov_b32_dpp v224, v8 quad_perm:[0,0,0,0] row_mask:0xf bank_mask:0xf
  v_mfma_f32_16x16x32_bf16 v[148:151], v[216:219], a[44:47], v[148:151]
  v_add_f32_dpp v152, v21, v152 quad_perm:[1,1,1,1] row_mask:0xf bank_mask:0xf
  v_add_f32_dpp v224, v9, v224 quad_perm:[1,1,1,1] row_mask:0xf bank_mask:0xf
  v_mfma_f32_16x16x32_bf16 v[144:147], v[220:223], a[36:39], v[144:147]
  v_add_f32_dpp v152, v22, v152 quad_perm:[2,2,2,2] row_mask:0xf bank_mask:0xf
  v_add_f32_dpp v224, v10, v224 quad_perm:[2,2,2,2] row_mask:0xf bank_mask:0xf
  v_mfma_f32_16x16x32_bf16 v[148:151], v[220:223], a[48:51], v[148:151]
  v_add_f32_dpp v152, v23, v152 quad_perm:[3,3,3,3] row_mask:0xf bank_mask:0xf
  s_nop 1
  v_add_f32_dpp v152, v11, v224 quad_perm:[3,3,3,3] row_mask:0xc bank_mask:0xf
  buffer_load_dwordx4 a[36:39], v1, s[8:11], s57 offen offset:640 nt
  s_mov_b32 s57, 0x300a800
  buffer_load_dwordx4 a[40:43], v1, s[8:11], s57 offen offset:0 nt
  v_mfma_f32_16x16x32_bf16 v[8:11], v[212:215], a[88:91], 0
  v_mfma_f32_16x16x32_bf16 v[20:23], v[212:215], a[56:59], 0
  v_mfma_f32_16x16x32_bf16 v[8:11], v[216:219], a[92:95], v[8:11]
  v_mov_b32_dpp v153, v144 quad_perm:[0,0,0,0] row_mask:0xf bank_mask:0xf
  v_mov_b32_dpp v224, v148 quad_perm:[0,0,0,0] row_mask:0xf bank_mask:0xf
  v_mfma_f32_16x16x32_bf16 v[20:23], v[216:219], a[60:63], v[20:23]
  v_add_f32_dpp v153, v145, v153 quad_perm:[1,1,1,1] row_mask:0xf bank_mask:0xf
  v_add_f32_dpp v224, v149, v224 quad_perm:[1,1,1,1] row_mask:0xf bank_mask:0xf
  v_mfma_f32_16x16x32_bf16 v[8:11], v[220:223], a[52:55], v[8:11]
  v_add_f32_dpp v153, v146, v153 quad_perm:[2,2,2,2] row_mask:0xf bank_mask:0xf
  v_add_f32_dpp v224, v150, v224 quad_perm:[2,2,2,2] row_mask:0xf bank_mask:0xf
  v_mfma_f32_16x16x32_bf16 v[20:23], v[220:223], a[64:67], v[20:23]
  v_add_f32_dpp v153, v147, v153 quad_perm:[3,3,3,3] row_mask:0xf bank_mask:0xf
  s_nop 1
  v_add_f32_dpp v153, v151, v224 quad_perm:[3,3,3,3] row_mask:0xc bank_mask:0xf
  buffer_load_dwordx4 a[44:47], v1, s[8:11], s57 offen offset:128 nt
  buffer_load_dwordx4 a[48:51], v1, s[8:11], s57 offen offset:256 nt
  v_mfma_f32_16x16x32_bf16 v[144:147], v[212:215], a[0:3], 0
  v_mfma_f32_16x16x32_bf16 v[148:151], v[212:215], a[12:15], 0
  v_mfma_f32_16x16x32_bf16 v[144:147], v[216:219], a[4:7], v[144:147]
  v_mov_b32_dpp v154, v8 quad_perm:[0,0,0,0] row_mask:0xf bank_mask:0xf
  v_mov_b32_dpp v224, v20 quad_perm:[0,0,0,0] row_mask:0xf bank_mask:0xf
  v_mfma_f32_16x16x32_bf16 v[148:151], v[216:219], a[16:19], v[148:151]
  v_add_f32_dpp v154, v9, v154 quad_perm:[1,1,1,1] row_mask:0xf bank_mask:0xf
  v_add_f32_dpp v224, v21, v224 quad_perm:[1,1,1,1] row_mask:0xf bank_mask:0xf
  v_mfma_f32_16x16x32_bf16 v[144:147], v[220:223], a[8:11], v[144:147]
  v_add_f32_dpp v154, v10, v154 quad_perm:[2,2,2,2] row_mask:0xf bank_mask:0xf
  v_add_f32_dpp v224, v22, v224 quad_perm:[2,2,2,2] row_mask:0xf bank_mask:0xf
  v_mfma_f32_16x16x32_bf16 v[148:151], v[220:223], a[20:23], v[148:151]
  v_add_f32_dpp v154, v11, v154 quad_perm:[3,3,3,3] row_mask:0xf bank_mask:0xf
  s_nop 1
  v_add_f32_dpp v154, v23, v224 quad_perm:[3,3,3,3] row_mask:0xc bank_mask:0xf
  buffer_load_dwordx4 a[0:3], v1, s[8:11], s57 offen offset:384 nt
  buffer_load_dwordx4 a[4:7], v1, s[8:11], s57 offen offset:512 nt
  v_mfma_f32_16x16x32_bf16 v[8:11], v[212:215], a[24:27], 0
  v_mfma_f32_16x16x32_bf16 v[20:23], v[212:215], a[68:71], 0
  v_mfma_f32_16x16x32_bf16 v[8:11], v[216:219], a[28:31], v[8:11]
  v_mov_b32_dpp v155, v144 quad_perm:[0,0,0,0] row_mask:0xf bank_mask:0xf
  v_mov_b32_dpp v224, v148 quad_perm:[0,0,0,0] row_mask:0xf bank_mask:0xf
  v_mfma_f32_16x16x32_bf16 v[20:23], v[216:219], a[72:75], v[20:23]
  v_add_f32_dpp v155, v145, v155 quad_perm:[1,1,1,1] row_mask:0xf bank_mask:0xf
  v_add_f32_dpp v224, v149, v224 quad_perm:[1,1,1,1] row_mask:0xf bank_mask:0xf
  v_mfma_f32_16x16x32_bf16 v[8:11], v[220:223], a[32:35], v[8:11]
  v_add_f32_dpp v155, v146, v155 quad_perm:[2,2,2,2] row_mask:0xf bank_mask:0xf
  v_add_f32_dpp v224, v150, v224 quad_perm:[2,2,2,2] row_mask:0xf bank_mask:0xf
  v_mfma_f32_16x16x32_bf16 v[20:23], v[220:223], a[76:79], v[20:23]
  v_add_f32_dpp v155, v147, v155 quad_perm:[3,3,3,3] row_mask:0xf bank_mask:0xf
  s_nop 1
  v_add_f32_dpp v155, v151, v224 quad_perm:[3,3,3,3] row_mask:0xc bank_mask:0xf
  buffer_load_dwordx4 a[8:11], v1, s[8:11], s57 offen offset:640 nt
  v_mfma_f32_16x16x32_bf16 v[144:147], v[212:215], a[80:83], 0
  v_mfma_f32_16x16x32_bf16 v[148:151], v[212:215], a[100:103], 0
  v_mfma_f32_16x16x32_bf16 v[144:147], v[216:219], a[84:87], v[144:147]
  v_mov_b32_dpp v156, v8 quad_perm:[0,0,0,0] row_mask:0xf bank_mask:0xf
  v_mov_b32_dpp v224, v20 quad_perm:[0,0,0,0] row_mask:0xf bank_mask:0xf
  v_mfma_f32_16x16x32_bf16 v[148:151], v[216:219], a[104:107], v[148:151]
  v_add_f32_dpp v156, v9, v156 quad_perm:[1,1,1,1] row_mask:0xf bank_mask:0xf
  v_add_f32_dpp v224, v21, v224 quad_perm:[1,1,1,1] row_mask:0xf bank_mask:0xf
  v_mfma_f32_16x16x32_bf16 v[144:147], v[220:223], a[96:99], v[144:147]
  v_add_f32_dpp v156, v10, v156 quad_perm:[2,2,2,2] row_mask:0xf bank_mask:0xf
  v_add_f32_dpp v224, v22, v224 quad_perm:[2,2,2,2] row_mask:0xf bank_mask:0xf
  v_mfma_f32_16x16x32_bf16 v[148:151], v[220:223], a[108:111], v[148:151]
  v_add_f32_dpp v156, v11, v156 quad_perm:[3,3,3,3] row_mask:0xf bank_mask:0xf
  s_nop 1
  v_add_f32_dpp v156, v23, v224 quad_perm:[3,3,3,3] row_mask:0xc bank_mask:0xf
  v_mfma_f32_16x16x32_bf16 v[8:11], v[212:215], a[112:115], 0
  v_mfma_f32_16x16x32_bf16 v[20:23], v[212:215], a[124:127], 0
  v_mfma_f32_16x16x32_bf16 v[8:11], v[216:219], a[116:119], v[8:11]
  v_mov_b32_dpp v157, v144 quad_perm:[0,0,0,0] row_mask:0xf bank_mask:0xf
  v_mov_b32_dpp v224, v148 quad_perm:[0,0,0,0] row_mask:0xf bank_mask:0xf
  v_mfma_f32_16x16x32_bf16 v[20:23], v[216:219], a[128:131], v[20:23]
  v_add_f32_dpp v157, v145, v157 quad_perm:[1,1,1,1] row_mask:0xf bank_mask:0xf
  v_add_f32_dpp v224, v149, v224 quad_perm:[1,1,1,1] row_mask:0xf bank_mask:0xf
  v_mfma_f32_16x16x32_bf16 v[8:11], v[220:223], a[120:123], v[8:11]
  v_add_f32_dpp v157, v146, v157 quad_perm:[2,2,2,2] row_mask:0xf bank_mask:0xf
  v_add_f32_dpp v224, v150, v224 quad_perm:[2,2,2,2] row_mask:0xf bank_mask:0xf
  v_mfma_f32_16x16x32_bf16 v[20:23], v[220:223], a[132:135], v[20:23]
  v_add_f32_dpp v157, v147, v157 quad_perm:[3,3,3,3] row_mask:0xf bank_mask:0xf
  s_nop 1
  v_add_f32_dpp v157, v151, v224 quad_perm:[3,3,3,3] row_mask:0xc bank_mask:0xf
  v_mfma_f32_16x16x32_bf16 v[144:147], v[212:215], a[136:139], 0
  v_mfma_f32_16x16x32_bf16 v[148:151], v[212:215], a[148:151], 0
  v_mfma_f32_16x16x32_bf16 v[144:147], v[216:219], a[140:143], v[144:147]
  v_mov_b32_dpp v158, v8 quad_perm:[0,0,0,0] row_mask:0xf bank_mask:0xf
  v_mov_b32_dpp v224, v20 quad_perm:[0,0,0,0] row_mask:0xf bank_mask:0xf
  v_mfma_f32_16x16x32_bf16 v[148:151], v[216:219], a[152:155], v[148:151]
  v_add_f32_dpp v158, v9, v158 quad_perm:[1,1,1,1] row_mask:0xf bank_mask:0xf
  v_add_f32_dpp v224, v21, v224 quad_perm:[1,1,1,1] row_mask:0xf bank_mask:0xf
  v_mfma_f32_16x16x32_bf16 v[144:147], v[220:223], a[144:147], v[144:147]
  v_add_f32_dpp v158, v10, v158 quad_perm:[2,2,2,2] row_mask:0xf bank_mask:0xf
  v_add_f32_dpp v224, v22, v224 quad_perm:[2,2,2,2] row_mask:0xf bank_mask:0xf
  v_mfma_f32_16x16x32_bf16 v[148:151], v[220:223], a[156:159], v[148:151]
  v_add_f32_dpp v158, v11, v158 quad_perm:[3,3,3,3] row_mask:0xf bank_mask:0xf
  s_nop 1
  v_add_f32_dpp v158, v23, v224 quad_perm:[3,3,3,3] row_mask:0xc bank_mask:0xf
  s_nop 0
  v_mov_b32_dpp v159, v144 quad_perm:[0,0,0,0] row_mask:0xf bank_mask:0xf
  s_nop 1
  v_mov_b32_dpp v224, v148 quad_perm:[0,0,0,0] row_mask:0xf bank_mask:0xf
  v_add_f32_dpp v159, v145, v159 quad_perm:[1,1,1,1] row_mask:0xf bank_mask:0xf
  s_nop 0
  v_add_f32_dpp v224, v149, v224 quad_perm:[1,1,1,1] row_mask:0xf bank_mask:0xf
  v_add_f32_dpp v159, v146, v159 quad_perm:[2,2,2,2] row_mask:0xf bank_mask:0xf
  s_nop 0
  v_add_f32_dpp v224, v150, v224 quad_perm:[2,2,2,2] row_mask:0xf bank_mask:0xf
  v_add_f32_dpp v159, v147, v159 quad_perm:[3,3,3,3] row_mask:0xf bank_mask:0xf
  s_nop 1
  v_add_f32_dpp v159, v151, v224 quad_perm:[3,3,3,3] row_mask:0xc bank_mask:0xf
  v_max_f32 v224, v152, v153
  v_max3_f32 v224, v224, v154, v155
  v_max3_f32 v224, v224, v156, v157
  v_max3_f32 v224, v224, v158, v159
  s_nop 1
  v_max_f32_dpp v224, v224, v224 row_ror:4 row_mask:0xf bank_mask:0xf
  s_nop 1
  v_max_f32_dpp v224, v224, v224 row_ror:8 row_mask:0xf bank_mask:0xf
  s_nop 1
  v_max_f32_dpp v224, v224, v224 row_bcast:15 row_mask:0xa bank_mask:0xf
  s_nop 1
  v_max_f32_dpp v224, v224, v224 row_bcast:31 row_mask:0xc bank_mask:0xf
  s_nop 0
  v_readlane_b32 s58, v224, 63
  s_nop 1
  v_mul_f32_e64 v224, -s58, v226
  v_fma_f32 v152, v152, v226, v224
  v_fma_f32 v153, v153, v226, v224
  v_fma_f32 v154, v154, v226, v224
  v_fma_f32 v155, v155, v226, v224
  v_fma_f32 v156, v156, v226, v224
  v_fma_f32 v157, v157, v226, v224
  v_fma_f32 v158, v158, v226, v224
  v_fma_f32 v159, v159, v226, v224
  v_exp_f32 v152, v152
  v_exp_f32 v153, v153
  v_exp_f32 v154, v154
  v_exp_f32 v155, v155
  v_exp_f32 v156, v156
  v_exp_f32 v157, v157
  v_exp_f32 v158, v158
  v_exp_f32 v159, v159
  v_add_f32 v225, v152, v153
  v_add_f32 v225, v225, v154
  v_add_f32 v225, v225, v155
  v_add_f32 v225, v225, v156
  v_add_f32 v225, v225, v157
  v_add_f32 v225, v225, v158
  v_add_f32 v225, v225, v159
  v_cvt_pk_bf16_f32 v152, v152, v152
  v_cvt_pk_bf16_f32 v153, v153, v153
  v_cvt_pk_bf16_f32 v154, v154, v154
  v_cvt_pk_bf16_f32 v155, v155, v155
  v_cvt_pk_bf16_f32 v156, v156, v156
  v_cvt_pk_bf16_f32 v157, v157, v157
  v_cvt_pk_bf16_f32 v158, v158, v158
  v_cvt_pk_bf16_f32 v159, v159, v159
  v_and_b32 v10, v153, v230
  v_and_b32 v11, v153, v231
  v_and_b32_dpp v8, v153, v228 row_shl:4 row_mask:0xf bank_mask:0xf bound_ctrl:0
  v_and_b32_dpp v9, v153, v229 row_shl:4 row_mask:0xf bank_mask:0xf bound_ctrl:0
  ds_read_b128 a[12:15], v233 offset:0
  ds_read_b128 a[16:19], v233 offset:1024
  ds_read_b128 a[20:23], v233 offset:2048
  v_mfma_f32_16x16x32_bf16 v[20:23], a[160:163], v[8:11], 0
  v_and_b32 v144, v154, v228
  v_and_b32 v145, v154, v229
  v_mfma_f32_16x16x32_bf16 v[148:151], a[164:167], v[8:11], 0
  v_and_b32_dpp v146, v154, v230 row_shr:4 row_mask:0xf bank_mask:0xf bound_ctrl:0
  v_and_b32_dpp v147, v154, v231 row_shr:4 row_mask:0xf bank_mask:0xf bound_ctrl:0
  v_add_f32_dpp v225, v225, v225 row_ror:4 row_mask:0xf bank_mask:0xf
  v_mfma_f32_16x16x32_bf16 v[160:163], a[168:171], v[8:11], 0
  s_nop 0
  v_add_f32_dpp v225, v225, v225 row_ror:8 row_mask:0xf bank_mask:0xf
  ds_read_b128 a[24:27], v233 offset:3072
  ds_read_b128 a[28:31], v233 offset:4096
  ds_read_b128 a[32:35], v233 offset:5120
  v_mfma_f32_16x16x32_bf16 v[20:23], a[172:175], v[144:147], v[20:23]
  v_and_b32 v10, v154, v230
  v_and_b32 v11, v154, v231
  v_mfma_f32_16x16x32_bf16 v[148:151], a[176:179], v[144:147], v[148:151]
  v_and_b32_dpp v8, v154, v228 row_shl:4 row_mask:0xf bank_mask:0xf bound_ctrl:0
  v_and_b32_dpp v9, v154, v229 row_shl:4 row_mask:0xf bank_mask:0xf bound_ctrl:0
  v_add_f32_dpp v225, v225, v225 row_bcast:15 row_mask:0xa bank_mask:0xf
  v_mfma_f32_16x16x32_bf16 v[160:163], a[180:183], v[144:147], v[160:163]
  s_nop 0
  v_add_f32_dpp v225, v225, v225 row_bcast:31 row_mask:0xc bank_mask:0xf
  ds_read_b128 a[52:55], v233 offset:6144
  ds_read_b128 a[56:59], v233 offset:7168
  ds_read_b128 a[60:63], v233 offset:8192
  v_mfma_f32_16x16x32_bf16 v[20:23], a[184:187], v[8:11], v[20:23]
  v_and_b32 v144, v152, v228
  v_and_b32 v145, v152, v229
  v_mfma_f32_16x16x32_bf16 v[148:151], a[188:191], v[8:11], v[148:151]
  v_and_b32_dpp v146, v152, v230 row_shr:4 row_mask:0xf bank_mask:0xf bound_ctrl:0
  v_and_b32_dpp v147, v152, v231 row_shr:4 row_mask:0xf bank_mask:0xf bound_ctrl:0
  v_mfma_f32_16x16x32_bf16 v[160:163], a[192:195], v[8:11], v[160:163]
  s_mov_b32 exec_lo, 0x0
  s_mov_b32 exec_hi, 0x80000000
  ds_write_b64 v235, v[224:225]
  s_mov_b64 exec, -1
  s_waitcnt lgkmcnt(7)
  v_mfma_f32_16x16x32_bf16 v[20:23], a[12:15], v[144:147], v[20:23]
  v_and_b32 v10, v152, v230
  v_and_b32 v11, v152, v231
  v_mfma_f32_16x16x32_bf16 v[148:151], a[16:19], v[144:147], v[148:151]
  v_and_b32_dpp v8, v152, v228 row_shl:4 row_mask:0xf bank_mask:0xf bound_ctrl:0
  v_and_b32_dpp v9, v152, v229 row_shl:4 row_mask:0xf bank_mask:0xf bound_ctrl:0
  v_mfma_f32_16x16x32_bf16 v[160:163], a[20:23], v[144:147], v[160:163]
  s_waitcnt lgkmcnt(4)
  v_mfma_f32_16x16x32_bf16 v[20:23], a[24:27], v[8:11], v[20:23]
  v_and_b32 v144, v153, v228
  v_and_b32 v145, v153, v229
  v_mfma_f32_16x16x32_bf16 v[148:151], a[28:31], v[8:11], v[148:151]
  v_and_b32_dpp v146, v153, v230 row_shr:4 row_mask:0xf bank_mask:0xf bound_ctrl:0
  v_and_b32_dpp v147, v153, v231 row_shr:4 row_mask:0xf bank_mask:0xf bound_ctrl:0
  v_mfma_f32_16x16x32_bf16 v[160:163], a[32:35], v[8:11], v[160:163]
  s_waitcnt lgkmcnt(1)
  v_mfma_f32_16x16x32_bf16 v[20:23], a[52:55], v[144:147], v[20:23]
  v_and_b32 v8, v155, v228
  v_and_b32 v9, v155, v229
  v_mfma_f32_16x16x32_bf16 v[148:151], a[56:59], v[144:147], v[148:151]
  v_and_b32_dpp v10, v155, v230 row_shr:4 row_mask:0xf bank_mask:0xf bound_ctrl:0
  v_and_b32_dpp v11, v155, v231 row_shr:4 row_mask:0xf bank_mask:0xf bound_ctrl:0
  v_mfma_f32_16x16x32_bf16 v[160:163], a[60:63], v[144:147], v[160:163]
  s_nop 0
  v_mfma_f32_16x16x32_bf16 v[20:23], a[196:199], v[8:11], v[20:23]
  v_and_b32 v146, v155, v230
  v_and_b32 v147, v155, v231
  v_mfma_f32_16x16x32_bf16 v[148:151], a[200:203], v[8:11], v[148:151]
  v_and_b32_dpp v144, v155, v228 row_shl:4 row_mask:0xf bank_mask:0xf bound_ctrl:0
  v_and_b32_dpp v145, v155, v229 row_shl:4 row_mask:0xf bank_mask:0xf bound_ctrl:0
  v_mfma_f32_16x16x32_bf16 v[160:163], a[204:207], v[8:11], v[160:163]
  s_nop 0
  v_mfma_f32_16x16x32_bf16 v[20:23], a[208:211], v[144:147], v[20:23]
  v_and_b32 v8, v156, v228
  v_and_b32 v9, v156, v229
  v_mfma_f32_16x16x32_bf16 v[148:151], a[212:215], v[144:147], v[148:151]
  v_and_b32_dpp v10, v156, v230 row_shr:4 row_mask:0xf bank_mask:0xf bound_ctrl:0
  v_and_b32_dpp v11, v156, v231 row_shr:4 row_mask:0xf bank_mask:0xf bound_ctrl:0
  v_mfma_f32_16x16x32_bf16 v[160:163], a[216:219], v[144:147], v[160:163]
  s_nop 0
  v_mfma_f32_16x16x32_bf16 v[20:23], a[220:223], v[8:11], v[20:23]
  v_and_b32 v146, v156, v230
  v_and_b32 v147, v156, v231
  v_mfma_f32_16x16x32_bf16 v[148:151], a[224:227], v[8:11], v[148:151]
  v_and_b32_dpp v144, v156, v228 row_shl:4 row_mask:0xf bank_mask:0xf bound_ctrl:0
  v_and_b32_dpp v145, v156, v229 row_shl:4 row_mask:0xf bank_mask:0xf bound_ctrl:0
  v_mfma_f32_16x16x32_bf16 v[160:163], a[228:231], v[8:11], v[160:163]
  s_nop 0
  v_mfma_f32_16x16x32_bf16 v[20:23], a[232:235], v[144:147], v[20:23]
  v_and_b32 v8, v157, v228
  v_and_b32 v9, v157, v229
  v_mfma_f32_16x16x32_bf16 v[148:151], a[236:239], v[144:147], v[148:151]
  v_and_b32_dpp v10, v157, v230 row_shr:4 row_mask:0xf bank_mask:0xf bound_ctrl:0
  v_and_b32_dpp v11, v157, v231 row_shr:4 row_mask:0xf bank_mask:0xf bound_ctrl:0
  v_mfma_f32_16x16x32_bf16 v[160:163], a[240:243], v[144:147], v[160:163]
  s_nop 0
  v_mfma_f32_16x16x32_bf16 v[20:23], a[244:247], v[8:11], v[20:23]
  v_and_b32 v146, v157, v230
  v_and_b32 v147, v157, v231
  v_mfma_f32_16x16x32_bf16 v[148:151], a[248:251], v[8:11], v[148:151]
  v_and_b32_dpp v144, v157, v228 row_shl:4 row_mask:0xf bank_mask:0xf bound_ctrl:0
  v_and_b32_dpp v145, v157, v229 row_shl:4 row_mask:0xf bank_mask:0xf bound_ctrl:0
  v_mfma_f32_16x16x32_bf16 v[160:163], a[252:255], v[8:11], v[160:163]
  s_nop 0
  v_mfma_f32_16x16x32_bf16 v[20:23], v[64:67], v[144:147], v[20:23]
  v_and_b32 v8, v158, v228
  v_and_b32 v9, v158, v229
  v_mfma_f32_16x16x32_bf16 v[148:151], v[28:31], v[144:147], v[148:151]
  v_and_b32_dpp v10, v158, v230 row_shr:4 row_mask:0xf bank_mask:0xf bound_ctrl:0
  v_and_b32_dpp v11, v158, v231 row_shr:4 row_mask:0xf bank_mask:0xf bound_ctrl:0
  v_mfma_f32_16x16x32_bf16 v[160:163], v[40:43], v[144:147], v[160:163]
  s_nop 0
  v_mfma_f32_16x16x32_bf16 v[20:23], v[32:35], v[8:11], v[20:23]
  v_and_b32 v30, v158, v230
  v_and_b32 v31, v158, v231
  v_mfma_f32_16x16x32_bf16 v[148:151], v[44:47], v[8:11], v[148:151]
  v_and_b32_dpp v28, v158, v228 row_shl:4 row_mask:0xf bank_mask:0xf bound_ctrl:0
  v_and_b32_dpp v29, v158, v229 row_shl:4 row_mask:0xf bank_mask:0xf bound_ctrl:0
  v_mfma_f32_16x16x32_bf16 v[160:163], v[36:39], v[8:11], v[160:163]
  s_waitcnt vmcnt(6)
  v_mfma_f32_16x16x32_bf16 v[20:23], v[120:123], v[28:31], v[20:23]
  v_and_b32 v8, v159, v228
  v_and_b32 v9, v159, v229
  v_mfma_f32_16x16x32_bf16 v[148:151], v[140:143], v[28:31], v[148:151]
  v_and_b32_dpp v10, v159, v230 row_shr:4 row_mask:0xf bank_mask:0xf bound_ctrl:0
  v_and_b32_dpp v11, v159, v231 row_shr:4 row_mask:0xf bank_mask:0xf bound_ctrl:0
  v_mfma_f32_16x16x32_bf16 v[160:163], a[36:39], v[28:31], v[160:163]
  s_waitcnt vmcnt(3)
  v_mfma_f32_16x16x32_bf16 v[20:23], a[40:43], v[8:11], v[20:23]
  v_and_b32 v30, v159, v230
  v_and_b32 v31, v159, v231
  v_mfma_f32_16x16x32_bf16 v[148:151], a[44:47], v[8:11], v[148:151]
  v_and_b32_dpp v28, v159, v228 row_shl:4 row_mask:0xf bank_mask:0xf bound_ctrl:0
  v_and_b32_dpp v29, v159, v229 row_shl:4 row_mask:0xf bank_mask:0xf bound_ctrl:0
  v_mfma_f32_16x16x32_bf16 v[160:163], a[48:51], v[8:11], v[160:163]
  s_waitcnt vmcnt(0)
  v_mfma_f32_16x16x32_bf16 v[20:23], a[0:3], v[28:31], v[20:23]
  v_mfma_f32_16x16x32_bf16 v[148:151], a[4:7], v[28:31], v[148:151]
  v_mfma_f32_16x16x32_bf16 v[160:163], a[8:11], v[28:31], v[160:163]
  v_mov_b32 v8, 162848
  v_add_u32 v9, 159744, v5
  s_add_u32 s73, s64, 655360
  s_nop 2
  v_permlane32_swap_b32 v20, v21
  v_permlane32_swap_b32 v22, v23
  v_permlane32_swap_b32 v148, v149
  v_permlane32_swap_b32 v150, v151
  v_permlane32_swap_b32 v160, v161
  v_permlane32_swap_b32 v162, v163
  v_add_f32_dpp v28, v21, v20 row_shl:8 row_mask:0xf bank_mask:0x3
  v_add_f32_dpp v29, v149, v148 row_shl:8 row_mask:0xf bank_mask:0x3
  v_add_f32_dpp v30, v161, v160 row_shl:8 row_mask:0xf bank_mask:0x3
  v_add_f32_dpp v28, v22, v23 row_shr:8 row_mask:0xf bank_mask:0xc
  v_add_f32_dpp v29, v150, v151 row_shr:8 row_mask:0xf bank_mask:0xc
  v_add_f32_dpp v30, v162, v163 row_shr:8 row_mask:0xf bank_mask:0xc
  ds_write_b32 v232, v28 offset:0
  ds_write_b32 v232, v29 offset:256
  ds_write_b32 v232, v30 offset:512
  s_waitcnt lgkmcnt(0)
  s_barrier
  s_cmp_eq_u32 s56, 3
  s_cbranch_scc0 L_w_139
  ds_read_b128 v[20:23], v8
  ds_read_b128 v[28:31], v8 offset:16
  ds_read_b128 v[32:35], v9 offset:0
  ds_read_b128 v[36:39], v9 offset:768
  ds_read_b128 v[40:43], v9 offset:1536
  ds_read_b128 v[44:47], v9 offset:2304
  s_mov_b32 vcc_lo, 0
  s_mov_b32 vcc_hi, 0xffff0000
  s_mov_b32 exec_hi, 0x1ffff
  s_waitcnt lgkmcnt(4)
  v_min3_f32 v8, v20, v22, v28
  v_min_f32 v8, v8, v30
  v_sub_f32 v20, v8, v20
  v_sub_f32 v22, v8, v22
  v_sub_f32 v28, v8, v28
  v_sub_f32 v30, v8, v30
  v_exp_f32 v20, v20
  v_exp_f32 v22, v22
  v_exp_f32 v28, v28
  v_exp_f32 v30, v30
  s_waitcnt lgkmcnt(0)
  v_pk_mul_f32 v[32:33], v[32:33], v[20:21] op_sel_hi:[1,0]
  v_pk_mul_f32 v[34:35], v[34:35], v[20:21] op_sel_hi:[1,0]
  v_mul_f32 v21, v20, v21
  v_pk_mul_f32 v[40:41], v[40:41], v[28:29] op_sel_hi:[1,0]
  v_pk_mul_f32 v[42:43], v[42:43], v[28:29] op_sel_hi:[1,0]
  v_mul_f32 v29, v28, v29
  v_pk_fma_f32 v[32:33], v[36:37], v[22:23], v[32:33] op_sel_hi:[1,0,1]
  v_pk_fma_f32 v[34:35], v[38:39], v[22:23], v[34:35] op_sel_hi:[1,0,1]
  v_fmac_f32 v21, v22, v23
  v_pk_fma_f32 v[40:41], v[44:45], v[30:31], v[40:41] op_sel_hi:[1,0,1]
  v_pk_fma_f32 v[42:43], v[46:47], v[30:31], v[42:43] op_sel_hi:[1,0,1]
  v_fmac_f32 v29, v30, v31
  v_pk_add_f32 v[32:33], v[32:33], v[40:41]
  v_pk_add_f32 v[34:35], v[34:35], v[42:43]
  v_add_f32 v9, v21, v29
  v_cvt_pk_bf16_f32 v36, v32, v33
  v_cvt_pk_bf16_f32 v37, v34, v35
  v_cndmask_b32 v36, v36, v8, vcc
  v_cndmask_b32 v37, v37, v9, vcc
  s_cmp_eq_u32 s75, 0
  s_cbranch_scc1 L_slow_140
  buffer_store_dwordx2 v[36:37], v234, s[36:39], s73 offen
  s_branch L_pub_141
L_slow_140:
  buffer_store_dwordx2 v[36:37], v234, s[36:39], s73 offen sc1
L_pub_141:
  s_mov_b64 exec, -1
L_w_139:
  v_and_b32 v8, 0x70, v5
  s_sleep 3
  v_lshrrev_b32 v9, 8, v5
  v_bfe_u32 v10, v5, 7, 1
  v_mul_u32_u24 v10, 192, v10
  v_lshl_add_u32 v9, v9, 4, v10
  v_lshrrev_b32 v10, 6, v5
  v_mul_u32_u24 v10, 160, v10
  v_bfe_u32 v11, v5, 4, 2
  v_lshl_add_u32 v10, v11, 3, v10
  s_lshl_b32 s58, s56, 5
  s_add_u32 s58, s58, 30720
  v_add_u32 v10, s58, v10
  s_cmp_lt_u32 s56, 3
  s_cbranch_scc0 L_w_142
  ds_read_b64_tr_b16 v[20:21], v10 offset:0
  ds_read_b64_tr_b16 v[22:23], v10 offset:2560
  ds_read_b64_tr_b16 v[28:29], v10 offset:5120
  ds_read_b64_tr_b16 v[30:31], v10 offset:7680
  ds_read_b64_tr_b16 v[32:33], v10 offset:10240
  ds_read_b64_tr_b16 v[34:35], v10 offset:12800
  ds_read_b64_tr_b16 v[36:37], v10 offset:15360
  ds_read_b64_tr_b16 v[38:39], v10 offset:17920
  ds_read_b64_tr_b16 v[40:41], v10 offset:20480
  ds_read_b64_tr_b16 v[42:43], v10 offset:23040
  ds_read_b64_tr_b16 v[44:45], v10 offset:25600
  ds_read_b64_tr_b16 v[46:47], v10 offset:28160
  ds_read_b64_tr_b16 v[64:65], v10 offset:96
  ds_read_b64_tr_b16 v[66:67], v10 offset:2656
  ds_read_b64_tr_b16 v[120:121], v10 offset:5216
  ds_read_b64_tr_b16 v[122:123], v10 offset:7776
  ds_read_b64_tr_b16 v[140:141], v10 offset:10336
  ds_read_b64_tr_b16 v[142:143], v10 offset:12896
  ds_read_b64_tr_b16 v[144:145], v10 offset:15456
  ds_read_b64_tr_b16 v[146:147], v10 offset:18016
  ds_read_b64_tr_b16 v[148:149], v10 offset:20576
  ds_read_b64_tr_b16 v[150:151], v10 offset:23136
  ds_read_b64_tr_b16 v[152:153], v10 offset:25696
  ds_read_b64_tr_b16 v[154:155], v10 offset:28256
L_w_142:
  s_lshl_b32 s58, s56, 6
  s_add_u32 s74, s66, s58
  s_add_u32 s74, s74, 655360
  s_cmp_lt_u32 s56, 3
  s_cbranch_scc0 L_w_143
  s_mov_b32 s72, 0
L_poll_144:
  s_add_u32 s73, s65, 655360
  buffer_load_dwordx2 v[156:157], v8, s[36:39], s73 offen offset:3072 sc1
  buffer_load_dwordx4 v[160:163], v5, s[36:39], s73 offen offset:0 sc1
  buffer_load_dwordx4 v[164:167], v5, s[36:39], s73 offen offset:1024 sc1
  buffer_load_dwordx4 v[168:171], v5, s[36:39], s73 offen offset:2048 sc1
  s_add_u32 s72, s72, 1
  s_cmp_lt_u32 s72, 65536
  s_cselect_b64 s[60:61], -1, 0
  s_waitcnt vmcnt(0)
  v_max3_u32 v158, v156, v157, v160
  v_max3_u32 v159, v161, v162, v163
  v_max3_u32 v158, v158, v164, v165
  v_max3_u32 v159, v159, v166, v167
  v_max3_u32 v158, v158, v168, v169
  v_max3_u32 v159, v159, v170, v171
  v_max_u32 v158, v158, v159
  v_cmp_eq_u32 vcc, -1, v158
  s_and_b64 vcc, vcc, s[60:61]
  s_cbranch_vccnz L_poll_144
  s_waitcnt lgkmcnt(0)
  v_mfma_f32_16x16x32_bf16 v[172:175], v[20:23], v[160:163], 0
  v_min_f32_dpp v158, v156, v156 quad_perm:[1,0,3,2] row_mask:0xf bank_mask:0xf
  v_mfma_f32_16x16x32_bf16 v[20:23], v[28:31], v[160:163], 0
  s_nop 0
  v_min_f32_dpp v158, v158, v158 quad_perm:[2,3,0,1] row_mask:0xf bank_mask:0xf
  v_mfma_f32_16x16x32_bf16 v[172:175], v[32:35], v[164:167], v[172:175]
  s_nop 0
  v_min_f32_dpp v158, v158, v158 row_half_mirror row_mask:0xf bank_mask:0xf
  v_mfma_f32_16x16x32_bf16 v[20:23], v[36:39], v[164:167], v[20:23]
  v_sub_f32 v156, v158, v156
  v_exp_f32 v156, v156
  v_mfma_f32_16x16x32_bf16 v[172:175], v[40:43], v[168:171], v[172:175]
  v_mul_f32 v157, v156, v157
  v_mfma_f32_16x16x32_bf16 v[20:23], v[44:47], v[168:171], v[20:23]
  s_nop 0
  v_add_f32_dpp v157, v157, v157 quad_perm:[1,0,3,2] row_mask:0xf bank_mask:0xf
  v_mfma_f32_16x16x32_bf16 v[28:31], v[64:67], v[160:163], 0
  s_nop 0
  v_add_f32_dpp v157, v157, v157 quad_perm:[2,3,0,1] row_mask:0xf bank_mask:0xf
  v_mfma_f32_16x16x32_bf16 v[32:35], v[120:123], v[160:163], 0
  s_nop 0
  v_add_f32_dpp v157, v157, v157 row_half_mirror row_mask:0xf bank_mask:0xf
  v_mfma_f32_16x16x32_bf16 v[28:31], v[140:143], v[164:167], v[28:31]
  v_rcp_f32 v157, v157
  s_nop 0
  v_mul_f32 v156, v156, v157
  v_mfma_f32_16x16x32_bf16 v[32:35], v[144:147], v[164:167], v[32:35]
  v_add_f32_dpp v36, v20, v172 row_shl:8 row_mask:0xf bank_mask:0x3
  v_add_f32_dpp v37, v21, v173 row_shl:8 row_mask:0xf bank_mask:0x3
  v_mfma_f32_16x16x32_bf16 v[28:31], v[148:151], v[168:171], v[28:31]
  v_add_f32_dpp v38, v22, v174 row_shl:8 row_mask:0xf bank_mask:0x3
  v_add_f32_dpp v39, v23, v175 row_shl:8 row_mask:0xf bank_mask:0x3
  v_mfma_f32_16x16x32_bf16 v[32:35], v[152:155], v[168:171], v[32:35]
  s_cmp_lt_u32 s56, 2
  s_mov_b32 s58, 0x00010001
  s_cselect_b32 s58, 0x01010101, s58
  s_nop 4
  v_add_f32_dpp v36, v28, v32 row_shr:8 row_mask:0xf bank_mask:0xc
  v_add_f32_dpp v37, v29, v33 row_shr:8 row_mask:0xf bank_mask:0xc
  v_add_f32_dpp v38, v30, v34 row_shr:8 row_mask:0xf bank_mask:0xc
  v_add_f32_dpp v39, v31, v35 row_shr:8 row_mask:0xf bank_mask:0xc
  v_mul_f32 v36, v156, v36
  v_mul_f32 v37, v156, v37
  v_mul_f32 v38, v156, v38
  v_mul_f32 v39, v156, v39
  v_add_f32_dpp v36, v36, v36 quad_perm:[1,0,3,2] row_mask:0xf bank_mask:0xf
  v_add_f32_dpp v37, v37, v37 quad_perm:[1,0,3,2] row_mask:0xf bank_mask:0xf
  v_add_f32_dpp v38, v38, v38 quad_perm:[1,0,3,2] row_mask:0xf bank_mask:0xf
  v_add_f32_dpp v39, v39, v39 quad_perm:[1,0,3,2] row_mask:0xf bank_mask:0xf
  v_add_f32_dpp v36, v36, v36 quad_perm:[2,3,0,1] row_mask:0xf bank_mask:0xf
  v_add_f32_dpp v37, v37, v37 quad_perm:[2,3,0,1] row_mask:0xf bank_mask:0xf
  v_add_f32_dpp v38, v38, v38 quad_perm:[2,3,0,1] row_mask:0xf bank_mask:0xf
  v_add_f32_dpp v39, v39, v39 quad_perm:[2,3,0,1] row_mask:0xf bank_mask:0xf
  v_add_f32_dpp v36, v36, v36 row_half_mirror row_mask:0xf bank_mask:0xf
  v_add_f32_dpp v37, v37, v37 row_half_mirror row_mask:0xf bank_mask:0xf
  v_add_f32_dpp v38, v38, v38 row_half_mirror row_mask:0xf bank_mask:0xf
  v_add_f32_dpp v39, v39, v39 row_half_mirror row_mask:0xf bank_mask:0xf
  s_mov_b32 exec_lo, s58
  s_mov_b32 exec_hi, s58
  buffer_store_dwordx4 v[36:39], v9, s[36:39], s74 offen sc1
  s_mov_b64 exec, -1
L_w_143:
  s_barrier
  v_lshrrev_b32 v9, 2, v5
  s_lshl_b32 s73, s56, 8
  s_add_u32 s73, s73, s70
  s_add_u32 s73, s73, 262144
  buffer_load_dword v8, v9, s[36:39], s73 offen sc1
  v_lshlrev_b32 v10, 3, v5
  s_add_u32 s58, s68, 2367488
  s_add_u32 s59, s77, 917504
  s_cmp_eq_u32 s56, 1
  s_cselect_b32 s58, s59, s58
  s_mov_b32 exec_lo, 0x7f
  s_mov_b32 exec_hi, 0x0
  buffer_load_dword v11, v10, s[36:39], s58 offen sc1
  s_mov_b64 exec, -1
  v_bfe_u32 v20, v5, 5, 3
  v_add_u32 v21, -1, v20
  v_and_b32 v21, 3, v21
  v_add_u32 v21, 1, v21
  v_min_u32 v20, v21, v20
  v_lshrrev_b32 v21, 8, v5
  v_lshl_add_u32 v20, v20, 2, v21
  v_mul_u32_u24 v20, 16, v20
  v_add_u32 v20, 159744, v20
  v_and_b32 v21, 0x1f0, v5
  v_lshrrev_b32 v22, 9, v5
  v_lshl_add_u32 v21, v22, 2, v21
  s_mul_i32 s58, s56, 320
  s_add_u32 s58, s58, 159744
  v_add_u32 v21, s58, v21
  v_lshrrev_b32 v22, 9, v5
  v_mul_u32_u24 v22, 3072, v22
  v_bfe_u32 v23, v5, 6, 3
  v_lshl_add_u32 v22, v23, 7, v22
  v_bfe_u32 v23, v5, 4, 2
  v_lshl_add_u32 v22, v23, 3, v22
  s_max_u32 s58, s56, 1
  s_lshl_b32 s58, s58, 10
  s_add_u32 s58, s58, 0xec00
  v_add_u32 v22, s58, v22
  v_bfe_u32 v23, v5, 7, 2
  v_lshl_add_u32 v28, v23, 5, v22
  v_xor_b32 v29, 32, v28
  v_xor_b32 v30, 64, v28
  v_xor_b32 v31, 96, v28
  ds_read_b64_tr_b16 v[32:33], v28 offset:24576
  ds_read_b64_tr_b16 v[34:35], v29 offset:24576
  ds_read_b64_tr_b16 v[36:37], v30 offset:24576
  ds_read_b64_tr_b16 v[38:39], v31 offset:24576
  ds_read_b64_tr_b16 v[40:41], v28 offset:0
  ds_read_b64_tr_b16 v[44:45], v29 offset:0
  ds_read_b64_tr_b16 v[64:65], v30 offset:0
  ds_read_b64_tr_b16 v[120:121], v31 offset:0
  ds_read_b64_tr_b16 v[42:43], v28 offset:6144
  ds_read_b64_tr_b16 v[46:47], v29 offset:6144
  ds_read_b64_tr_b16 v[66:67], v30 offset:6144
  ds_read_b64_tr_b16 v[122:123], v31 offset:6144
  ds_read_b64_tr_b16 v[140:141], v28 offset:12288
  ds_read_b64_tr_b16 v[144:145], v29 offset:12288
  ds_read_b64_tr_b16 v[148:149], v30 offset:12288
  ds_read_b64_tr_b16 v[152:153], v31 offset:12288
  ds_read_b64_tr_b16 v[142:143], v28 offset:18432
  ds_read_b64_tr_b16 v[146:147], v29 offset:18432
  ds_read_b64_tr_b16 v[150:151], v30 offset:18432
  ds_read_b64_tr_b16 v[154:155], v31 offset:18432
  v_lshrrev_b32 v22, 2, v5
  v_mov_b32 v23, 0x3f803f80
  v_lshlrev_b32 v28, 16, v2
  v_and_b32 v29, 0xffff0000, v2
  v_lshlrev_b32 v30, 16, v3
  v_and_b32 v31, 0xffff0000, v3
  v_mov_b32 v156, 0
  v_mov_b32 v157, 0
  v_mov_b32 v158, 0
  v_mov_b32 v159, 0
  v_mov_b32 v160, 0
  v_mov_b32 v161, 0
  v_mov_b32 v162, 0
  v_mov_b32 v163, 0
  v_mov_b32 v164, 0
  v_mov_b32 v165, 0
  v_mov_b32 v166, 0
  v_mov_b32 v167, 0
  v_and_b32 v168, 0x30, v5
  v_bfe_u32 v169, v5, 8, 1
  v_lshl_add_u32 v168, v169, 6, v168
  v_add_u32 v168, 163280, v168
  v_mov_b32 v169, 163664
  v_and_b32 v170, 16, v5
  v_mov_b32 v171, 0xffff
  v_lshlrev_b32 v170, v170, v171
  v_bfe_u32 v171, v5, 5, 2
  v_cmp_eq_u32 vcc, 0, v171
  s_nop 1
  v_cndmask_b32 v172, 0, v170, vcc
  v_cmp_eq_u32 vcc, 1, v171
  s_nop 1
  v_cndmask_b32 v173, 0, v170, vcc
  v_cmp_eq_u32 vcc, 2, v171
  s_nop 1
  v_cndmask_b32 v174, 0, v170, vcc
  v_cmp_eq_u32 vcc, 3, v171
  s_nop 1
  v_cndmask_b32 v175, 0, v170, vcc
  v_bfe_u32 v176, v5, 7, 2
  v_lshlrev_b32 v176, 4, v176
  v_lshrrev_b32 v177, 9, v5
  v_lshl_add_u32 v176, v177, 3, v176
  v_bfe_u32 v177, v5, 4, 3
  v_add_lshl_u32 v176, v176, v177, 2
  s_mul_i32 s58, s56, 768
  s_add_u32 s58, s58, 159744
  v_add_u32 v176, s58, v176
  v_lshrrev_b32 v178, 8, v5
  v_bfe_u32 v177, v5, 4, 2
  v_lshl_add_u32 v178, v178, 2, v177
  v_bfe_u32 v177, v5, 7, 1
  v_lshl_add_u32 v178, v178, 1, v177
  v_lshlrev_b32 v178, 7, v178
  v_bfe_u32 v177, v5, 6, 1
  v_lshl_add_u32 v178, v177, 3, v178
  v_add_u32 v177, s71, v5
  s_lshl_b32 s58, s56, 3
  s_add_u32 s58, s58, 162848
  v_mov_b32 v179, s58
  s_sleep 2
  s_mov_b32 exec_lo, 0xfffff
  s_mov_b32 exec_hi, 0xfffff
  s_lshl_b32 s73, s56, 12
  s_add_u32 s73, s73, s67
  s_add_u32 s73, s73, 655360
  buffer_load_dwordx4 v[180:183], v5, s[36:39], s73 offen offset:0 sc1
  buffer_load_dwordx4 v[184:187], v5, s[36:39], s73 offen offset:1024 sc1
  buffer_load_dwordx4 v[188:191], v5, s[36:39], s73 offen offset:2048 sc1
  buffer_load_dwordx4 v[192:195], v5, s[36:39], s73 offen offset:3072 sc1
  s_mov_b64 exec, -1
  s_mov_b32 s72, 0
  s_waitcnt vmcnt(0)
L_chk_146:
  s_mov_b32 exec_lo, 0xfffff
  s_mov_b32 exec_hi, 0xfffff
  v_pk_add_f32 v[180:181], v[180:181], v[184:185]
  v_pk_add_f32 v[182:183], v[182:183], v[186:187]
  v_pk_add_f32 v[188:189], v[188:189], v[192:193]
  v_pk_add_f32 v[190:191], v[190:191], v[194:195]
  v_pk_add_f32 v[180:181], v[180:181], v[188:189]
  v_pk_add_f32 v[182:183], v[182:183], v[190:191]
  s_nop 0
  v_permlane32_swap_b32 v180, v181
  v_permlane32_swap_b32 v182, v183
  v_add_f32 v180, v180, v181
  v_add_f32 v182, v182, v183
  v_cmp_u_f32 vcc, v180, v182
  s_cbranch_vccz L_ok_147
  s_add_u32 s72, s72, 1
  s_cmp_ge_u32 s72, 65536
  s_cbranch_scc1 L_ok_147
  s_sleep 1
  s_mov_b32 exec_lo, 0xfffff
  s_mov_b32 exec_hi, 0xfffff
  s_lshl_b32 s73, s56, 12
  s_add_u32 s73, s73, s67
  s_add_u32 s73, s73, 655360
  buffer_load_dwordx4 v[180:183], v5, s[36:39], s73 offen offset:0 sc1
  buffer_load_dwordx4 v[184:187], v5, s[36:39], s73 offen offset:1024 sc1
  buffer_load_dwordx4 v[188:191], v5, s[36:39], s73 offen offset:2048 sc1
  buffer_load_dwordx4 v[192:195], v5, s[36:39], s73 offen offset:3072 sc1
  s_waitcnt vmcnt(0)
  s_branch L_chk_146
L_ok_147:
  ds_write2_b32 v21, v180, v182 offset0:0 offset1:2
  s_mov_b64 exec, -1
  s_waitcnt lgkmcnt(0)
  s_barrier
  ds_read_b128 v[180:183], v20 offset:0
  ds_read_b128 v[184:187], v20 offset:320
  ds_read_b128 v[188:191], v20 offset:640
  ds_read_b128 v[192:195], v20 offset:960
  s_mov_b32 exec_lo, 0xaaaaaaaa
  s_mov_b32 exec_hi, 0xaaaaaaaa
  s_mov_b32 vcc_lo, 0x44444444
  s_mov_b32 vcc_hi, 0x44444444
  s_waitcnt lgkmcnt(2)
  v_pk_add_f32 v[180:181], v[180:181], v[184:185]
  v_pk_add_f32 v[182:183], v[182:183], v[186:187]
  v_pk_add_f32 v[28:29], v[28:29], v[180:181]
  v_pk_add_f32 v[30:31], v[30:31], v[182:183]
  s_waitcnt lgkmcnt(0)
  v_pk_add_f32 v[188:189], v[188:189], v[192:193]
  v_pk_add_f32 v[190:191], v[190:191], v[194:195]
  v_pk_add_f32 v[28:29], v[28:29], v[188:189]
  v_pk_add_f32 v[30:31], v[30:31], v[190:191]
  v_cvt_pk_bf16_f32 v2, v28, v29
  v_cvt_pk_bf16_f32 v3, v30, v31
  s_mov_b64 exec, -1
  v_cndmask_b32_dpp v10, v2, v23, vcc row_newbcast:9 row_mask:0xf bank_mask:0xf
  v_cndmask_b32_dpp v11, v3, v23, vcc row_newbcast:9 row_mask:0xf bank_mask:0xf
  v_cndmask_b32_dpp v28, v2, v23, vcc row_newbcast:1 row_mask:0xf bank_mask:0xf
  v_cndmask_b32_dpp v29, v3, v23, vcc row_newbcast:1 row_mask:0xf bank_mask:0xf
  v_cndmask_b32_dpp v30, v2, v23, vcc row_newbcast:3 row_mask:0xf bank_mask:0xf
  v_cndmask_b32_dpp v31, v3, v23, vcc row_newbcast:3 row_mask:0xf bank_mask:0xf
  v_cndmask_b32_dpp v180, v2, v23, vcc row_newbcast:5 row_mask:0xf bank_mask:0xf
  v_cndmask_b32_dpp v181, v3, v23, vcc row_newbcast:5 row_mask:0xf bank_mask:0xf
  v_cndmask_b32_dpp v182, v2, v23, vcc row_newbcast:7 row_mask:0xf bank_mask:0xf
  v_cndmask_b32_dpp v183, v3, v23, vcc row_newbcast:7 row_mask:0xf bank_mask:0xf
  s_waitcnt lgkmcnt(0)
  s_cmp_eq_u32 s56, 0
  s_cbranch_scc1 L_q0_148
  v_mfma_f32_16x16x16_bf16 v[184:187], v[10:11], v[32:33], 0
  v_mfma_f32_16x16x16_bf16 v[188:191], v[10:11], v[34:35], 0
  v_mfma_f32_16x16x16_bf16 v[32:35], v[10:11], v[36:37], 0
  v_mfma_f32_16x16x16_bf16 v[192:195], v[10:11], v[38:39], 0
  s_lshl_b32 s58, s56, 8
  s_add_u32 s73, s68, 0x241f00
  s_add_u32 s73, s73, s58
  s_nop 1
  v_mfma_f32_16x16x32_bf16 v[184:187], v[28:31], v[40:43], v[184:187]
  v_mfma_f32_16x16x32_bf16 v[188:191], v[28:31], v[44:47], v[188:191]
  v_mfma_f32_16x16x32_bf16 v[32:35], v[28:31], v[64:67], v[32:35]
  v_mfma_f32_16x16x32_bf16 v[192:195], v[28:31], v[120:123], v[192:195]
  v_mfma_f32_16x16x32_bf16 v[184:187], v[180:183], v[140:143], v[184:187]
  v_mfma_f32_16x16x32_bf16 v[188:191], v[180:183], v[144:147], v[188:191]
  v_mfma_f32_16x16x32_bf16 v[32:35], v[180:183], v[148:151], v[32:35]
  v_mfma_f32_16x16x32_bf16 v[192:195], v[180:183], v[152:155], v[192:195]
  s_nop 5
  v_mov_b32_dpp v184, v188 quad_perm:[0,1,2,3] row_mask:0x2 bank_mask:0xf
  s_nop 1
  v_mov_b32_dpp v184, v32 quad_perm:[0,1,2,3] row_mask:0x4 bank_mask:0xf
  s_nop 1
  v_mov_b32_dpp v184, v192 quad_perm:[0,1,2,3] row_mask:0x8 bank_mask:0xf
  s_cmp_eq_u32 s75, 0
  s_cbranch_scc1 L_slow_150
  buffer_store_dword v184, v22, s[36:39], s73 offen
  s_branch L_pub_151
L_slow_150:
  buffer_store_dword v184, v22, s[36:39], s73 offen sc1
L_pub_151:
  s_branch L_qe_149
L_q0_148:
  v_mfma_f32_16x16x16_bf16 v[184:187], v[10:11], v[10:11], 0
  v_mfma_f32_16x16x32_bf16 v[188:191], v[28:31], v[28:31], 0
  v_mfma_f32_16x16x32_bf16 v[188:191], v[180:183], v[180:183], v[188:191]
  s_add_u32 s73, s68, 2367488
  s_mov_b64 exec, 1
  s_nop 5
  v_add_f32 v184, v184, v188
  v_add_f32 v185, v186, v190
  s_cmp_eq_u32 s75, 0
  s_cbranch_scc1 L_slow_152
  buffer_store_dwordx2 v[184:185], v22, s[36:39], s73 offen offset:768
  s_branch L_pub_153
L_slow_152:
  buffer_store_dwordx2 v[184:185], v22, s[36:39], s73 offen offset:768 sc1
L_pub_153:
  s_mov_b64 exec, -1
L_qe_149:
  v_lshrrev_b32 v21, 8, v5
  v_and_b32 v20, 0xf0, v5
  v_lshl_add_u32 v20, v21, 10, v20
  v_bfe_u32 v23, v5, 1, 7
  v_lshl_add_u32 v23, v21, 1, v23
  s_lshl_b32 s58, s56, 7
  s_add_u32 s58, s58, 163280
  v_add_u32 v23, s58, v23
  v_lshlrev_b32 v21, 6, v5
  v_mov_b32 v22, 163664
  v_mov_b32 v10, 0
  v_mov_b32 v11, 0
  s_sleep 2
  s_cmp_lt_u32 s56, 3
  s_cbranch_scc0 L_w_154
  s_mov_b32 s72, 0
L_poll_155:
  s_add_u32 s74, s69, 2367488
  s_mov_b32 exec_lo, 0xff
  s_mov_b32 exec_hi, 0x0
  buffer_load_dwordx2 v[10:11], v21, s[36:39], s74 offen offset:768 sc1
  s_mov_b64 exec, -1
  s_lshl_b32 s73, s56, 8
  s_add_u32 s73, s73, s74
  s_add_u32 s74, s73, 4096
  buffer_load_dwordx4 v[28:31], v20, s[36:39], s73 offen sc1
  buffer_load_dwordx4 v[32:35], v20, s[36:39], s74 offen sc1
  s_add_u32 s72, s72, 1
  s_cmp_lt_u32 s72, 65536
  s_cselect_b64 s[60:61], -1, 0
  s_waitcnt vmcnt(0)
  v_pk_add_f32 v[28:29], v[28:29], v[32:33]
  v_pk_add_f32 v[30:31], v[30:31], v[34:35]
  v_add_f32_dpp v11, v11, v11 quad_perm:[1,0,3,2] row_mask:0xf bank_mask:0xf
  v_add_f32_dpp v10, v10, v10 quad_perm:[1,0,3,2] row_mask:0xf bank_mask:0xf
  v_permlane16_swap_b32 v28, v29
  v_permlane16_swap_b32 v30, v31
  v_add_f32 v28, v28, v29
  v_add_f32 v30, v30, v31
  v_add_f32_dpp v11, v11, v11 quad_perm:[2,3,0,1] row_mask:0xf bank_mask:0xf
  v_add_f32_dpp v10, v10, v10 quad_perm:[2,3,0,1] row_mask:0xf bank_mask:0xf
  v_permlane32_swap_b32 v28, v30
  v_add_f32_dpp v11, v11, v11 row_half_mirror row_mask:0xf bank_mask:0xf
  v_add_f32_dpp v10, v10, v10 row_half_mirror row_mask:0xf bank_mask:0xf
  v_add_f32 v28, v28, v30
  v_readfirstlane_b32 s58, v11
  s_nop 1
  v_fmac_f32 v28, s58, v8
  v_cmp_u_f32 vcc, v28, v10
  s_and_b64 vcc, vcc, s[60:61]
  s_cbranch_vccnz L_poll_155
  v_cvt_pk_bf16_f32 v28, v28, v28
  ds_write_b16 v23, v28
  s_mov_b64 exec, 1
  ds_write_b64 v22, v[10:11]
  s_mov_b64 exec, -1
L_w_154:
  s_waitcnt lgkmcnt(0)
  s_barrier
  s_mov_b32 exec_lo, 0xf0f0f0f
  s_mov_b32 exec_hi, 0xf0f0f0f0
  ds_read_b128 v[156:159], v168 offset:0
  ds_read_b128 v[160:163], v168 offset:128
  ds_read_b128 v[164:167], v168 offset:256
  s_mov_b64 exec, -1
  ds_read_b64 v[170:171], v169
  s_waitcnt lgkmcnt(0)
  v_mfma_f32_16x16x32_bf16 v[8:11], v[156:159], v[48:51], 0
  v_mfma_f32_16x16x32_bf16 v[20:23], v[156:159], v[12:15], 0
  v_mfma_f32_16x16x32_bf16 v[8:11], v[160:163], v[56:59], v[8:11]
  v_mul_f32 v171, 0x3acccccd, v171
  v_mul_f32 v170, 0x3acccccd, v170
  v_mfma_f32_16x16x32_bf16 v[20:23], v[160:163], v[16:19], v[20:23]
  v_fma_f32 v170, -v171, v171, v170
  v_max_f32 v170, 0, v170
  v_mfma_f32_16x16x32_bf16 v[8:11], v[164:167], v[60:63], v[8:11]
  v_add_f32 v170, 0x3727c5ac, v170
  v_rsq_f32 v170, v170
  v_mfma_f32_16x16x32_bf16 v[20:23], v[164:167], v[72:75], v[20:23]
  v_mul_f32 v170, 0x3dd53b95, v170
  v_mfma_f32_16x16x32_bf16 v[12:15], v[156:159], v[80:83], 0
  v_mfma_f32_16x16x32_bf16 v[16:19], v[156:159], v[128:131], 0
  v_mfma_f32_16x16x32_bf16 v[12:15], v[160:163], v[24:27], v[12:15]
  s_nop 0
  v_mov_b32_dpp v168, v8 quad_perm:[0,0,0,0] row_mask:0xf bank_mask:0xf
  s_nop 1
  v_mov_b32_dpp v24, v20 quad_perm:[0,0,0,0] row_mask:0xf bank_mask:0xf
  v_mfma_f32_16x16x32_bf16 v[16:19], v[160:163], v[132:135], v[16:19]
  v_add_f32_dpp v168, v9, v168 quad_perm:[1,1,1,1] row_mask:0xf bank_mask:0xf
  v_add_f32_dpp v24, v21, v24 quad_perm:[1,1,1,1] row_mask:0xf bank_mask:0xf
  v_mfma_f32_16x16x32_bf16 v[12:15], v[164:167], v[124:127], v[12:15]
  v_add_f32_dpp v168, v10, v168 quad_perm:[2,2,2,2] row_mask:0xf bank_mask:0xf
  v_add_f32_dpp v24, v22, v24 quad_perm:[2,2,2,2] row_mask:0xf bank_mask:0xf
  v_mfma_f32_16x16x32_bf16 v[16:19], v[164:167], v[136:139], v[16:19]
  v_add_f32_dpp v168, v11, v168 quad_perm:[3,3,3,3] row_mask:0xf bank_mask:0xf
  s_nop 1
  v_add_f32_dpp v168, v23, v24 quad_perm:[3,3,3,3] row_mask:0xc bank_mask:0xf
  s_nop 0
  v_mov_b32_dpp v169, v12 quad_perm:[0,0,0,0] row_mask:0xf bank_mask:0xf
  s_nop 1
  v_mov_b32_dpp v8, v16 quad_perm:[0,0,0,0] row_mask:0xf bank_mask:0xf
  v_add_f32_dpp v169, v13, v169 quad_perm:[1,1,1,1] row_mask:0xf bank_mask:0xf
  s_nop 0
  v_add_f32_dpp v8, v17, v8 quad_perm:[1,1,1,1] row_mask:0xf bank_mask:0xf
  v_add_f32_dpp v169, v14, v169 quad_perm:[2,2,2,2] row_mask:0xf bank_mask:0xf
  s_nop 0
  v_add_f32_dpp v8, v18, v8 quad_perm:[2,2,2,2] row_mask:0xf bank_mask:0xf
  v_add_f32_dpp v169, v15, v169 quad_perm:[3,3,3,3] row_mask:0xf bank_mask:0xf
  s_nop 1
  v_add_f32_dpp v169, v19, v8 quad_perm:[3,3,3,3] row_mask:0xc bank_mask:0xf
  v_max_f32 v8, v168, v169
  s_nop 1
  v_max_f32_dpp v8, v8, v8 row_ror:4 row_mask:0xf bank_mask:0xf
  s_nop 1
  v_max_f32_dpp v8, v8, v8 row_ror:8 row_mask:0xf bank_mask:0xf
  s_nop 1
  v_max_f32_dpp v8, v8, v8 row_bcast:15 row_mask:0xa bank_mask:0xf
  s_nop 1
  v_max_f32_dpp v8, v8, v8 row_bcast:31 row_mask:0xc bank_mask:0xf
  s_nop 0
  v_readlane_b32 s58, v8, 63
  s_nop 1
  v_mul_f32_e64 v8, -s58, v170
  v_fma_f32 v168, v168, v170, v8
  v_fma_f32 v169, v169, v170, v8
  v_exp_f32 v168, v168
  v_exp_f32 v169, v169
  s_nop 0
  v_add_f32 v9, v168, v169
  v_cvt_pk_bf16_f32 v168, v168, v168
  v_cvt_pk_bf16_f32 v169, v169, v169
  v_and_b32 v12, v168, v172
  v_and_b32 v13, v168, v173
  v_and_b32_dpp v14, v168, v174 row_shr:4 row_mask:0xf bank_mask:0xf bound_ctrl:0
  v_and_b32_dpp v15, v168, v175 row_shr:4 row_mask:0xf bank_mask:0xf bound_ctrl:0
  s_nop 1
  v_mfma_f32_16x16x32_bf16 v[16:19], v[52:55], v[12:15], 0
  v_and_b32 v22, v168, v174
  v_and_b32 v23, v168, v175
  v_mfma_f32_16x16x32_bf16 v[24:27], v[68:71], v[12:15], 0
  v_and_b32_dpp v20, v168, v172 row_shl:4 row_mask:0xf bank_mask:0xf bound_ctrl:0
  v_and_b32_dpp v21, v168, v173 row_shl:4 row_mask:0xf bank_mask:0xf bound_ctrl:0
  v_add_f32_dpp v9, v9, v9 row_ror:4 row_mask:0xf bank_mask:0xf
  v_mfma_f32_16x16x32_bf16 v[28:31], v[76:79], v[12:15], 0
  s_nop 0
  v_add_f32_dpp v9, v9, v9 row_ror:8 row_mask:0xf bank_mask:0xf
  v_mfma_f32_16x16x32_bf16 v[16:19], v[84:87], v[20:23], v[16:19]
  v_and_b32 v12, v169, v172
  v_and_b32 v13, v169, v173
  v_mfma_f32_16x16x32_bf16 v[24:27], v[88:91], v[20:23], v[24:27]
  v_and_b32_dpp v14, v169, v174 row_shr:4 row_mask:0xf bank_mask:0xf bound_ctrl:0
  v_and_b32_dpp v15, v169, v175 row_shr:4 row_mask:0xf bank_mask:0xf bound_ctrl:0
  v_add_f32_dpp v9, v9, v9 row_bcast:15 row_mask:0xa bank_mask:0xf
  v_mfma_f32_16x16x32_bf16 v[28:31], v[92:95], v[20:23], v[28:31]
  s_nop 0
  v_add_f32_dpp v9, v9, v9 row_bcast:31 row_mask:0xc bank_mask:0xf
  v_mfma_f32_16x16x32_bf16 v[16:19], v[96:99], v[12:15], v[16:19]
  v_and_b32 v22, v169, v174
  v_and_b32 v23, v169, v175
  v_mfma_f32_16x16x32_bf16 v[24:27], v[100:103], v[12:15], v[24:27]
  v_and_b32_dpp v20, v169, v172 row_shl:4 row_mask:0xf bank_mask:0xf bound_ctrl:0
  v_and_b32_dpp v21, v169, v173 row_shl:4 row_mask:0xf bank_mask:0xf bound_ctrl:0
  v_mfma_f32_16x16x32_bf16 v[28:31], v[104:107], v[12:15], v[28:31]
  s_mov_b32 exec_lo, 0x0
  s_mov_b32 exec_hi, 0x80000000
  ds_write_b64 v179, v[8:9]
  s_mov_b64 exec, -1
  v_mfma_f32_16x16x32_bf16 v[16:19], v[108:111], v[20:23], v[16:19]
  v_mfma_f32_16x16x32_bf16 v[24:27], v[112:115], v[20:23], v[24:27]
  v_mfma_f32_16x16x32_bf16 v[28:31], v[116:119], v[20:23], v[28:31]
  v_mov_b32 v8, 162848
  v_add_u32 v9, 159744, v5
  s_add_u32 s73, s64, 917504
  s_nop 2
  v_permlane32_swap_b32 v16, v17
  v_permlane32_swap_b32 v18, v19
  v_permlane32_swap_b32 v24, v25
  v_permlane32_swap_b32 v26, v27
  v_permlane32_swap_b32 v28, v29
  v_permlane32_swap_b32 v30, v31
  v_add_f32_dpp v12, v17, v16 row_shl:8 row_mask:0xf bank_mask:0x3
  v_add_f32_dpp v13, v25, v24 row_shl:8 row_mask:0xf bank_mask:0x3
  v_add_f32_dpp v14, v29, v28 row_shl:8 row_mask:0xf bank_mask:0x3
  v_add_f32_dpp v12, v18, v19 row_shr:8 row_mask:0xf bank_mask:0xc
  v_add_f32_dpp v13, v26, v27 row_shr:8 row_mask:0xf bank_mask:0xc
  v_add_f32_dpp v14, v30, v31 row_shr:8 row_mask:0xf bank_mask:0xc
  ds_write_b32 v176, v12 offset:0
  ds_write_b32 v176, v13 offset:256
  ds_write_b32 v176, v14 offset:512
  s_waitcnt lgkmcnt(0)
  s_barrier
  s_cmp_eq_u32 s56, 3
  s_cbranch_scc0 L_w_157
  ds_read_b128 v[12:15], v8
  ds_read_b128 v[16:19], v8 offset:16
  ds_read_b128 v[20:23], v9 offset:0
  ds_read_b128 v[24:27], v9 offset:768
  ds_read_b128 v[28:31], v9 offset:1536
  ds_read_b128 v[32:35], v9 offset:2304
  s_mov_b32 vcc_lo, 0
  s_mov_b32 vcc_hi, 0xffff0000
  s_mov_b32 exec_hi, 0x1ffff
  s_waitcnt lgkmcnt(4)
  v_min3_f32 v8, v12, v14, v16
  v_min_f32 v8, v8, v18
  v_sub_f32 v12, v8, v12
  v_sub_f32 v14, v8, v14
  v_sub_f32 v16, v8, v16
  v_sub_f32 v18, v8, v18
  v_exp_f32 v12, v12
  v_exp_f32 v14, v14
  v_exp_f32 v16, v16
  v_exp_f32 v18, v18
  s_waitcnt lgkmcnt(0)
  v_pk_mul_f32 v[20:21], v[20:21], v[12:13] op_sel_hi:[1,0]
  v_pk_mul_f32 v[22:23], v[22:23], v[12:13] op_sel_hi:[1,0]
  v_mul_f32 v13, v12, v13
  v_pk_mul_f32 v[28:29], v[28:29], v[16:17] op_sel_hi:[1,0]
  v_pk_mul_f32 v[30:31], v[30:31], v[16:17] op_sel_hi:[1,0]
  v_mul_f32 v17, v16, v17
  v_pk_fma_f32 v[20:21], v[24:25], v[14:15], v[20:21] op_sel_hi:[1,0,1]
  v_pk_fma_f32 v[22:23], v[26:27], v[14:15], v[22:23] op_sel_hi:[1,0,1]
  v_fmac_f32 v13, v14, v15
  v_pk_fma_f32 v[28:29], v[32:33], v[18:19], v[28:29] op_sel_hi:[1,0,1]
  v_pk_fma_f32 v[30:31], v[34:35], v[18:19], v[30:31] op_sel_hi:[1,0,1]
  v_fmac_f32 v17, v18, v19
  v_pk_add_f32 v[20:21], v[20:21], v[28:29]
  v_pk_add_f32 v[22:23], v[22:23], v[30:31]
  v_add_f32 v9, v13, v17
  v_cvt_pk_bf16_f32 v24, v20, v21
  v_cvt_pk_bf16_f32 v25, v22, v23
  v_cndmask_b32 v24, v24, v8, vcc
  v_cndmask_b32 v25, v25, v9, vcc
  s_cmp_eq_u32 s75, 0
  s_cbranch_scc1 L_slow_158
  buffer_store_dwordx2 v[24:25], v178, s[36:39], s73 offen
  s_branch L_pub_159
L_slow_158:
  buffer_store_dwordx2 v[24:25], v178, s[36:39], s73 offen sc1
L_pub_159:
  s_mov_b64 exec, -1
L_w_157:
  v_and_b32 v8, 0x70, v5
  s_sleep 3
  v_lshrrev_b32 v9, 8, v5
  v_bfe_u32 v10, v5, 7, 1
  v_mul_u32_u24 v10, 192, v10
  v_lshl_add_u32 v9, v9, 4, v10
  v_lshrrev_b32 v10, 6, v5
  v_mul_u32_u24 v10, 160, v10
  v_bfe_u32 v11, v5, 4, 2
  v_lshl_add_u32 v10, v11, 3, v10
  s_lshl_b32 s58, s56, 5
  s_add_u32 s58, s58, 92160
  v_add_u32 v10, s58, v10
  s_cmp_lt_u32 s56, 3
  s_cbranch_scc0 L_w_160
  ds_read_b64_tr_b16 v[12:13], v10 offset:0
  ds_read_b64_tr_b16 v[14:15], v10 offset:2560
  ds_read_b64_tr_b16 v[16:17], v10 offset:5120
  ds_read_b64_tr_b16 v[18:19], v10 offset:7680
  ds_read_b64_tr_b16 v[20:21], v10 offset:10240
  ds_read_b64_tr_b16 v[22:23], v10 offset:12800
  ds_read_b64_tr_b16 v[24:25], v10 offset:15360
  ds_read_b64_tr_b16 v[26:27], v10 offset:17920
  ds_read_b64_tr_b16 v[28:29], v10 offset:20480
  ds_read_b64_tr_b16 v[30:31], v10 offset:23040
  ds_read_b64_tr_b16 v[32:33], v10 offset:25600
  ds_read_b64_tr_b16 v[34:35], v10 offset:28160
  ds_read_b64_tr_b16 v[36:37], v10 offset:96
  ds_read_b64_tr_b16 v[38:39], v10 offset:2656
  ds_read_b64_tr_b16 v[40:41], v10 offset:5216
  ds_read_b64_tr_b16 v[42:43], v10 offset:7776
  ds_read_b64_tr_b16 v[44:45], v10 offset:10336
  ds_read_b64_tr_b16 v[46:47], v10 offset:12896
  ds_read_b64_tr_b16 v[48:49], v10 offset:15456
  ds_read_b64_tr_b16 v[50:51], v10 offset:18016
  ds_read_b64_tr_b16 v[52:53], v10 offset:20576
  ds_read_b64_tr_b16 v[54:55], v10 offset:23136
  ds_read_b64_tr_b16 v[56:57], v10 offset:25696
  ds_read_b64_tr_b16 v[58:59], v10 offset:28256
L_w_160:
  s_lshl_b32 s58, s56, 6
  s_add_u32 s74, s66, s58
  s_add_u32 s74, s74, 917504
  s_cmp_lt_u32 s56, 3
  s_cbranch_scc0 L_w_161
  s_mov_b32 s72, 0
L_poll_162:
  s_add_u32 s73, s65, 917504
  buffer_load_dwordx2 v[60:61], v8, s[36:39], s73 offen offset:3072 sc1
  buffer_load_dwordx4 v[64:67], v5, s[36:39], s73 offen offset:0 sc1
  buffer_load_dwordx4 v[68:71], v5, s[36:39], s73 offen offset:1024 sc1
  buffer_load_dwordx4 v[72:75], v5, s[36:39], s73 offen offset:2048 sc1
  s_add_u32 s72, s72, 1
  s_cmp_lt_u32 s72, 65536
  s_cselect_b64 s[60:61], -1, 0
  s_waitcnt vmcnt(0)
  v_max3_u32 v62, v60, v61, v64
  v_max3_u32 v63, v65, v66, v67
  v_max3_u32 v62, v62, v68, v69
  v_max3_u32 v63, v63, v70, v71
  v_max3_u32 v62, v62, v72, v73
  v_max3_u32 v63, v63, v74, v75
  v_max_u32 v62, v62, v63
  v_cmp_eq_u32 vcc, -1, v62
  s_and_b64 vcc, vcc, s[60:61]
  s_cbranch_vccnz L_poll_162
  s_waitcnt lgkmcnt(0)
  v_mfma_f32_16x16x32_bf16 v[76:79], v[12:15], v[64:67], 0
  v_min_f32_dpp v62, v60, v60 quad_perm:[1,0,3,2] row_mask:0xf bank_mask:0xf
  v_mfma_f32_16x16x32_bf16 v[12:15], v[16:19], v[64:67], 0
  s_nop 0
  v_min_f32_dpp v62, v62, v62 quad_perm:[2,3,0,1] row_mask:0xf bank_mask:0xf
  v_mfma_f32_16x16x32_bf16 v[76:79], v[20:23], v[68:71], v[76:79]
  s_nop 0
  v_min_f32_dpp v62, v62, v62 row_half_mirror row_mask:0xf bank_mask:0xf
  v_mfma_f32_16x16x32_bf16 v[12:15], v[24:27], v[68:71], v[12:15]
  v_sub_f32 v60, v62, v60
  v_exp_f32 v60, v60
  v_mfma_f32_16x16x32_bf16 v[76:79], v[28:31], v[72:75], v[76:79]
  v_mul_f32 v61, v60, v61
  v_mfma_f32_16x16x32_bf16 v[12:15], v[32:35], v[72:75], v[12:15]
  s_nop 0
  v_add_f32_dpp v61, v61, v61 quad_perm:[1,0,3,2] row_mask:0xf bank_mask:0xf
  v_mfma_f32_16x16x32_bf16 v[16:19], v[36:39], v[64:67], 0
  s_nop 0
  v_add_f32_dpp v61, v61, v61 quad_perm:[2,3,0,1] row_mask:0xf bank_mask:0xf
  v_mfma_f32_16x16x32_bf16 v[20:23], v[40:43], v[64:67], 0
  s_nop 0
  v_add_f32_dpp v61, v61, v61 row_half_mirror row_mask:0xf bank_mask:0xf
  v_mfma_f32_16x16x32_bf16 v[16:19], v[44:47], v[68:71], v[16:19]
  v_rcp_f32 v61, v61
  s_nop 0
  v_mul_f32 v60, v60, v61
  v_mfma_f32_16x16x32_bf16 v[20:23], v[48:51], v[68:71], v[20:23]
  v_add_f32_dpp v24, v12, v76 row_shl:8 row_mask:0xf bank_mask:0x3
  v_add_f32_dpp v25, v13, v77 row_shl:8 row_mask:0xf bank_mask:0x3
  v_mfma_f32_16x16x32_bf16 v[16:19], v[52:55], v[72:75], v[16:19]
  v_add_f32_dpp v26, v14, v78 row_shl:8 row_mask:0xf bank_mask:0x3
  v_add_f32_dpp v27, v15, v79 row_shl:8 row_mask:0xf bank_mask:0x3
  v_mfma_f32_16x16x32_bf16 v[20:23], v[56:59], v[72:75], v[20:23]
  s_cmp_lt_u32 s56, 2
  s_mov_b32 s58, 0x00010001
  s_cselect_b32 s58, 0x01010101, s58
  s_nop 4
  v_add_f32_dpp v24, v16, v20 row_shr:8 row_mask:0xf bank_mask:0xc
  v_add_f32_dpp v25, v17, v21 row_shr:8 row_mask:0xf bank_mask:0xc
  v_add_f32_dpp v26, v18, v22 row_shr:8 row_mask:0xf bank_mask:0xc
  v_add_f32_dpp v27, v19, v23 row_shr:8 row_mask:0xf bank_mask:0xc
  v_mul_f32 v24, v60, v24
  v_mul_f32 v25, v60, v25
  v_mul_f32 v26, v60, v26
  v_mul_f32 v27, v60, v27
  v_add_f32_dpp v24, v24, v24 quad_perm:[1,0,3,2] row_mask:0xf bank_mask:0xf
  v_add_f32_dpp v25, v25, v25 quad_perm:[1,0,3,2] row_mask:0xf bank_mask:0xf
  v_add_f32_dpp v26, v26, v26 quad_perm:[1,0,3,2] row_mask:0xf bank_mask:0xf
  v_add_f32_dpp v27, v27, v27 quad_perm:[1,0,3,2] row_mask:0xf bank_mask:0xf
  v_add_f32_dpp v24, v24, v24 quad_perm:[2,3,0,1] row_mask:0xf bank_mask:0xf
  v_add_f32_dpp v25, v25, v25 quad_perm:[2,3,0,1] row_mask:0xf bank_mask:0xf
  v_add_f32_dpp v26, v26, v26 quad_perm:[2,3,0,1] row_mask:0xf bank_mask:0xf
  v_add_f32_dpp v27, v27, v27 quad_perm:[2,3,0,1] row_mask:0xf bank_mask:0xf
  v_add_f32_dpp v24, v24, v24 row_half_mirror row_mask:0xf bank_mask:0xf
  v_add_f32_dpp v25, v25, v25 row_half_mirror row_mask:0xf bank_mask:0xf
  v_add_f32_dpp v26, v26, v26 row_half_mirror row_mask:0xf bank_mask:0xf
  v_add_f32_dpp v27, v27, v27 row_half_mirror row_mask:0xf bank_mask:0xf
  s_mov_b32 exec_lo, s58
  s_mov_b32 exec_hi, s58
  buffer_store_dwordx4 v[24:27], v9, s[36:39], s74 offen sc1
  s_mov_b64 exec, -1
L_w_161:
  s_cmp_lg_u32 s52, 0
  s_cbranch_scc1 L_done
  s_barrier
  v_bfe_u32 v8, v5, 5, 3
  v_add_u32 v9, -1, v8
  v_and_b32 v9, 3, v9
  v_add_u32 v9, 1, v9
  v_min_u32 v8, v9, v8
  v_lshrrev_b32 v9, 8, v5
  v_lshl_add_u32 v8, v8, 2, v9
  v_mul_u32_u24 v8, 16, v8
  v_add_u32 v8, 159744, v8
  v_and_b32 v9, 0x1f0, v5
  v_lshrrev_b32 v10, 9, v5
  v_lshl_add_u32 v9, v10, 2, v9
  s_mul_i32 s58, s56, 320
  s_add_u32 s58, s58, 159744
  v_add_u32 v9, s58, v9
  v_bfe_u32 v10, v5, 5, 3
  v_add_u32 v11, -1, v10
  v_and_b32 v11, 3, v11
  v_add_u32 v11, 1, v11
  v_min_u32 v10, v11, v10
  v_lshrrev_b32 v11, 8, v5
  v_lshl_add_u32 v10, v10, 2, v11
  v_mul_u32_u24 v10, 8, v10
  v_bfe_u32 v11, v5, 4, 1
  v_mul_u32_u24 v11, 1280, v11
  v_add_u32 v10, v10, v11
  s_mul_i32 s74, s53, 160
  v_lshlrev_b32 v12, 16, v2
  v_and_b32 v13, 0xffff0000, v2
  v_lshlrev_b32 v14, 16, v3
  v_and_b32 v15, 0xffff0000, v3
  s_sleep 9
  s_mov_b32 exec_lo, 0xfffff
  s_mov_b32 exec_hi, 0xfffff
  s_lshl_b32 s73, s56, 12
  s_add_u32 s73, s73, s67
  s_add_u32 s73, s73, 917504
  buffer_load_dwordx4 v[16:19], v5, s[36:39], s73 offen offset:0 sc1
  buffer_load_dwordx4 v[20:23], v5, s[36:39], s73 offen offset:1024 sc1
  buffer_load_dwordx4 v[24:27], v5, s[36:39], s73 offen offset:2048 sc1
  buffer_load_dwordx4 v[28:31], v5, s[36:39], s73 offen offset:3072 sc1
  s_mov_b64 exec, -1
  s_mov_b32 s72, 0
  s_waitcnt vmcnt(0)
L_chk_164:
  s_mov_b32 exec_lo, 0xfffff
  s_mov_b32 exec_hi, 0xfffff
  v_pk_add_f32 v[16:17], v[16:17], v[20:21]
  v_pk_add_f32 v[18:19], v[18:19], v[22:23]
  v_pk_add_f32 v[24:25], v[24:25], v[28:29]
  v_pk_add_f32 v[26:27], v[26:27], v[30:31]
  v_pk_add_f32 v[16:17], v[16:17], v[24:25]
  v_pk_add_f32 v[18:19], v[18:19], v[26:27]
  s_nop 0
  v_permlane32_swap_b32 v16, v17
  v_permlane32_swap_b32 v18, v19
  v_add_f32 v16, v16, v17
  v_add_f32 v18, v18, v19
  v_cmp_u_f32 vcc, v16, v18
  s_cbranch_vccz L_ok_165
  s_add_u32 s72, s72, 1
  s_cmp_ge_u32 s72, 65536
  s_cbranch_scc1 L_ok_165
  s_sleep 1
  s_mov_b32 exec_lo, 0xfffff
  s_mov_b32 exec_hi, 0xfffff
  s_lshl_b32 s73, s56, 12
  s_add_u32 s73, s73, s67
  s_add_u32 s73, s73, 917504
  buffer_load_dwordx4 v[16:19], v5, s[36:39], s73 offen offset:0 sc1
  buffer_load_dwordx4 v[20:23], v5, s[36:39], s73 offen offset:1024 sc1
  buffer_load_dwordx4 v[24:27], v5, s[36:39], s73 offen offset:2048 sc1
  buffer_load_dwordx4 v[28:31], v5, s[36:39], s73 offen offset:3072 sc1
  s_waitcnt vmcnt(0)
  s_branch L_chk_164
L_ok_165:
  ds_write2_b32 v9, v16, v18 offset0:0 offset1:2
  s_mov_b64 exec, -1
  s_waitcnt lgkmcnt(0)
  s_barrier
  s_cmp_eq_u32 s56, 0
  s_cbranch_scc0 L_w_166
  ds_read_b128 v[16:19], v8 offset:0
  ds_read_b128 v[20:23], v8 offset:320
  ds_read_b128 v[24:27], v8 offset:640
  ds_read_b128 v[28:31], v8 offset:960
  s_mov_b32 exec_lo, 0xaaaaaaaa
  s_mov_b32 exec_hi, 0xaaaaaaaa
  s_waitcnt lgkmcnt(2)
  v_pk_add_f32 v[16:17], v[16:17], v[20:21]
  v_pk_add_f32 v[18:19], v[18:19], v[22:23]
  v_pk_add_f32 v[12:13], v[12:13], v[16:17]
  v_pk_add_f32 v[14:15], v[14:15], v[18:19]
  s_waitcnt lgkmcnt(0)
  v_pk_add_f32 v[24:25], v[24:25], v[28:29]
  v_pk_add_f32 v[26:27], v[26:27], v[30:31]
  v_pk_add_f32 v[12:13], v[12:13], v[24:25]
  v_pk_add_f32 v[14:15], v[14:15], v[26:27]
  v_cvt_pk_bf16_f32 v2, v12, v13
  v_cvt_pk_bf16_f32 v3, v14, v15
  s_mov_b32 exec_lo, 0x3ff03ff
  s_mov_b32 exec_hi, 0x3ff03ff
  buffer_store_dwordx2 v[2:3], v10, s[44:47], s74 offen
  s_mov_b64 exec, -1
L_w_166:
L_done:
L_exit:
  s_endpgm
.section .rodata,"a"
.p2align 6
.amdhsa_kernel interleave_layers__gqa_block_cached__sliding_block_cached__decode_kernel
  .amdhsa_next_free_vgpr 512
  .amdhsa_next_free_sgpr 102
  .amdhsa_accum_offset 256
  .amdhsa_group_segment_fixed_size 0
  .amdhsa_kernarg_size 104
  .amdhsa_user_sgpr_count 2
  .amdhsa_user_sgpr_kernarg_segment_ptr 1
  .amdhsa_system_sgpr_workgroup_id_x 1
  .amdhsa_float_denorm_mode_32 3
  .amdhsa_float_denorm_mode_16_64 3
.end_amdhsa_kernel
```
